```python
import torch

def _softmax(x, axis=-1):
    return torch.softmax(x, dim=axis)

def _gelu(x):
    return torch.nn.functional.gelu(x, approximate='tanh')

def _silu(x):
    return torch.nn.functional.silu(x)

def _sigmoid(x):
    return torch.sigmoid(x)

def _layernorm(x, axis=-1, eps=1e-05):
    m = x.mean(dim=axis, keepdim=True)
    v = x.var(dim=axis, keepdim=True, unbiased=False)
    return (x - m) / torch.sqrt(v + eps)

def _scatter_add(tgt, idx, src, axis=0):
    return tgt.clone().index_add_(axis, idx, src)

def _segment_sum(src, seg, n):
    out = torch.zeros((n,) + src.shape[1:], dtype=src.dtype)
    return out.index_add_(0, seg, src)

def _pad(x, pw):
    flat = tuple((v for pair in reversed(pw) for v in pair))
    return torch.nn.functional.pad(x, flat)
kernel_name = 'adaLN_cond__sliding_block_cached__mixer_s_mlp__prompt'

def setup_inputs():

    _w = lambda a: (lambda t: t.to(torch.bfloat16) if t.is_floating_point() else t)(torch.as_tensor(a))

    def _A_setup():
        B, Sq, D = (1, 2048, 512)
        Hq, Hkv, Sk, Dh = (32, 8, 2048, 128)
        assert Hq % Hkv == 0, (Hq, Hkv)
        return {'x': _w((lambda *s: torch.randn(*s, dtype=torch.bfloat16) * 0.05)(B, Sq, D)), 'k_cache': _w((lambda *s: torch.randn(*s, dtype=torch.bfloat16) * 3.2)(B, Hkv, Sk, Dh)), 'v_cache': _w((lambda *s: torch.randn(*s, dtype=torch.bfloat16) * 0.4)(B, Hkv, Sk, Dh)), 'wq': _w((lambda *s: torch.randn(*s, dtype=torch.bfloat16) * 3.2)(D, Hq * Dh) * D ** (-0.5)), 'wo': _w((lambda *s: torch.randn(*s, dtype=torch.bfloat16) * 0.4)(Hq * Dh, D) * (Hq * Dh) ** (-0.5))}
    _A_in = _A_setup()

    def _B_setup():
        B, S, D, F = (1, 2048, 512, 1792)
        return {'x': _w((lambda *s: torch.randn(*s, dtype=torch.bfloat16) * 0.05)(B, S, D)), 'w1': _w((lambda *s: torch.randn(*s, dtype=torch.bfloat16) * 3.2)(D, D) * D ** (-0.5)), 'w2': _w((lambda *s: torch.randn(*s, dtype=torch.bfloat16) * 3.2)(D, D) * D ** (-0.5)), 'w3': _w((lambda *s: torch.randn(*s, dtype=torch.bfloat16) * 3.2)(D, F) * D ** (-0.5)), 'w4': _w((lambda *s: torch.randn(*s, dtype=torch.bfloat16) * 3.2)(F, D) * F ** (-0.5))}
    _B_in = _B_setup()
    return {'A_x': _A_in['x'], 'A_k_cache': _A_in['k_cache'], 'A_v_cache': _A_in['v_cache'], 'A_wq': _A_in['wq'], 'A_wo': _A_in['wo'], 'B_x': _B_in['x'], 'B_w1': _B_in['w1'], 'B_w2': _B_in['w2'], 'B_w3': _B_in['w3'], 'B_w4': _B_in['w4'], 'c': _w((lambda *s: torch.randn(*s, dtype=torch.bfloat16) * 0.1)(1, 512) * 8.0), 'w_mod': _w((lambda *s: torch.randn(*s, dtype=torch.bfloat16) * 0.1)(512, 6 * 512) * 512 ** (-0.5) * 8.0)}

def reference(A_x, A_k_cache, A_v_cache, A_wq, A_wo, B_x, B_w1, B_w2, B_w3, B_w4, c, w_mod):

    def _A_ref(x, k_cache, v_cache, wq, wo):
        B, Sq, D = x.shape
        Hq, Dh = (32, 128)
        Hkv, Sk = (k_cache.shape[1], k_cache.shape[2])
        W = min(4096, max(256, Sk // 4))
        rep = Hq // Hkv
        q = (lambda x, *d: x.permute(*d))((x @ wq).reshape(B, Sq, Hq, Dh), 0, 2, 1, 3)
        k = (lambda x, n, axis: torch.repeat_interleave(x, n, dim=axis))(k_cache[:, :, Sk - W:, :], rep, axis=1)
        v = (lambda x, n, axis: torch.repeat_interleave(x, n, dim=axis))(v_cache[:, :, Sk - W:, :], rep, axis=1)
        scores = torch.einsum('bhqd,bhkd->bhqk', q, k) * Dh ** (-0.5)
        p = _softmax(scores, axis=-1)
        o = torch.einsum('bhqk,bhkd->bhqd', p, v)
        return (lambda x, *d: x.permute(*d))(o, 0, 2, 1, 3).reshape(B, Sq, Hq * Dh) @ wo

    def _B_ref(x, w1, w2, w3, w4):
        B, S, D = x.shape
        h = _gelu(_layernorm(x, axis=-1) @ w1)
        c = D // 4
        g0 = _pad(h[:, :, 0 * c:1 * c], ((0, 0), (1, 0), (0, 0)))[:, :S, :]
        g1 = _pad(h[:, :, 1 * c:2 * c], ((0, 0), (0, 1), (0, 0)))[:, 1:, :]
        g2 = _pad(h[:, :, 2 * c:3 * c], ((0, 0), (2, 0), (0, 0)))[:, :S, :]
        g3 = _pad(h[:, :, 3 * c:], ((0, 0), (0, 2), (0, 0)))[:, 2:, :]
        hs = torch.concatenate([g0, g1, g2, g3], axis=-1) @ w2
        x1 = x + hs
        h2 = _gelu(_layernorm(x1, axis=-1) @ w3) @ w4
        return x1 + h2
    x = A_x
    mod = (_silu(c) @ w_mod).reshape(c.shape[0], 6, 1, -1)
    sa, ca, ga, sb, cb, gb = (mod[:, 0].clone(), mod[:, 1].clone(), mod[:, 2].clone(), mod[:, 3].clone(), mod[:, 4].clone(), mod[:, 5].clone())
    h = _layernorm(x, axis=-1) * (1 + ca) + sa
    x = x + ga * _A_ref(h, A_k_cache, A_v_cache, A_wq, A_wo)
    h = _layernorm(x, axis=-1) * (1 + cb) + sb
    x = x + gb * _B_ref(h, B_w1, B_w2, B_w3, B_w4)
    return x
```

```asm
; @launch grid=(256,1,1) block=(512,1,1) lds=163840
.amdgcn_target "amdgcn-amd-amdhsa--gfx950"
.text
.globl adaLN_cond__sliding_block_cached__mixer_s_mlp__prompt_kernel
.p2align 8
.type adaLN_cond__sliding_block_cached__mixer_s_mlp__prompt_kernel,@function
adaLN_cond__sliding_block_cached__mixer_s_mlp__prompt_kernel:
    s_cmp_lt_u32 s2, 256
    s_cbranch_scc1 .Lk1_go
    s_endpgm
.Lk1_go:
    s_load_dwordx2 s[4:5], s[0:1], 0
    s_load_dwordx4 s[72:75], s[0:1], 80
    s_load_dwordx2 s[6:7], s[0:1], 104
    s_memrealtime s[70:71]
    s_getpc_b64 s[76:77]
.Lpc0:
    s_mov_b32 s78, .Lcode_end-.Lpc0
    s_mov_b32 s79, 0x00020000
    s_lshr_b32 s3, s2, 3
    s_mul_i32 s3, s3, 2304
    v_lshlrev_b32 v2, 6, v0
    v_cmp_gt_u32 vcc, 36, v0
    s_and_b64 exec, exec, vcc
    buffer_load_dword v62, v2, s[76:79], s3 offen
    s_mov_b64 exec, -1
    s_load_dwordx4 s[60:63], s[0:1], 8
    s_load_dwordx4 s[64:67], s[0:1], 24
    s_load_dwordx2 s[68:69], s[0:1], 112
    s_load_dwordx8 s[92:99], s[0:1], 48
    v_and_b32 v1, 63, v0
    v_lshrrev_b32 v2, 6, v0
    s_nop 0
    v_readfirstlane_b32 s40, v2
    s_and_b32 s41, s2, 6
    s_lshr_b32 s42, s2, 7
    s_or_b32 s41, s41, s42
    s_bfe_u32 s42, s2, 0x40003
    s_lshl_b32 s42, s42, 1
    s_and_b32 s56, s2, 1
    s_or_b32 s42, s42, s56
    s_mov_b32 s45, 0xffff0000
    v_lshlrev_b32 v12, 4, v1
    v_mov_b32 v58, 81920
    v_mov_b32 v4, 0
    v_mov_b32 v5, 0
    v_mov_b32 v6, 0
    v_mov_b32 v7, 0
    ds_write_b128 v58, v[4:7]
    ds_write_b128 v58, v[4:7] offset:16
    s_getreg_b32 s57, hwreg(HW_REG_XCC_ID)
    s_and_b32 s3, s2, 1
    s_lshl_b32 s3, s3, 5
    s_lshr_b32 s56, s2, 3
    s_add_u32 s3, s3, s56
    s_bitcmp1_b32 s2, 1
    s_cselect_b32 s56, 0, 192
    s_cselect_b32 s58, 64, 128
    s_bitcmp1_b32 s57, 2
    s_cselect_b32 s56, s58, s56
    s_add_u32 s3, s3, s56
    s_cmp_lt_u32 s40, 4
    s_cselect_b32 s36, s3, 128
    v_lshrrev_b32 v3, 3, v0
    s_cmp_lt_u32 s36, 192
    s_cbranch_scc1 .Lp4a_l
    v_and_b32 v2, 1, v1
    v_lshl_or_b32 v2, v3, 1, v2
    v_lshlrev_b32 v61, 3, v2
    v_mul_u32_u24 v60, 24576, v2
    v_bfe_u32 v3, v1, 1, 2
    v_lshl_add_u32 v60, v3, 4, v60
    s_bfe_u32 s59, s3, 0x10005
    s_and_b32 s58, s3, 31
    s_lshl_b32 s58, s58, 6
    s_mul_i32 s57, s59, 1572864
    s_add_u32 s58, s58, s57
    s_lshl_b32 s59, s59, 9
    s_waitcnt lgkmcnt(0)
    s_mov_b32 s76, s72
    s_mov_b32 s77, s73
    s_mov_b32 s78, 0x400
    s_mov_b32 s79, 0x00020000
    s_mov_b32 s80, s74
    s_mov_b32 s81, s75
    s_mov_b32 s82, 0x300000
    s_mov_b32 s83, 0x00020000
    buffer_load_dwordx2 v[224:225], v61, s[76:79], s59 offen
    buffer_load_dwordx4 v[128:131], v60, s[80:83], s58 offen
    s_add_u32 s58, s58, 6144
    buffer_load_dwordx4 v[132:135], v60, s[80:83], s58 offen
    s_add_u32 s58, s58, 6144
    buffer_load_dwordx4 v[136:139], v60, s[80:83], s58 offen
    s_add_u32 s58, s58, 6144
    buffer_load_dwordx4 v[140:143], v60, s[80:83], s58 offen
    s_branch .Lp4a_x
.Lp4a_l:
    s_cmp_ge_u32 s36, 64
    s_cbranch_scc1 .Lp4a_w
    s_and_b32 s37, s3, 1
    s_lshr_b32 s56, s3, 1
    s_add_u32 s57, s56, 16
    s_sub_u32 s56, s56, 32
    s_cmp_lt_u32 s3, 64
    s_cselect_b32 s56, s57, s56
    s_movk_i32 s57, 8192
    s_cselect_b32 s59, 12288, s57
    s_movk_i32 s57, 3584
    s_cselect_b32 s46, 6144, s57
    s_cselect_b32 s47, 0, 65536
    s_mul_i32 s59, s59, s37
    s_add_u32 s59, s59, s47
    s_lshl_b32 s57, s56, 8
    s_add_u32 s59, s59, s57
    s_lshl_b32 s58, s37, 8
    s_mul_i32 s58, s58, s46
    s_lshl_b32 s56, s56, 7
    s_add_u32 s58, s58, s56
    s_lshl_b32 s57, s37, 9
    s_lshl_b32 s56, s46, 3
    v_and_b32 v2, 7, v1
    v_mul_lo_u32 v60, v3, s56
    v_lshl_add_u32 v60, v2, 4, v60
    v_lshlrev_b32 v61, 4, v3
    s_cmp_lt_u32 s3, 64
    s_waitcnt lgkmcnt(0)
    s_mov_b32 s76, s72
    s_mov_b32 s77, s73
    s_mov_b32 s78, 0x400
    s_mov_b32 s79, 0x00020000
    s_cselect_b32 s80, s74, s96
    s_cselect_b32 s81, s75, s97
    s_lshl_b32 s82, s46, 9
    s_mov_b32 s83, 0x00020000
    buffer_load_dwordx4 v[224:227], v61, s[76:79], s57 offen
    buffer_load_dwordx4 v[128:131], v60, s[80:83], s58 offen
    s_add_u32 s58, s58, s46
    buffer_load_dwordx4 v[132:135], v60, s[80:83], s58 offen
    s_add_u32 s58, s58, s46
    buffer_load_dwordx4 v[136:139], v60, s[80:83], s58 offen
    s_add_u32 s58, s58, s46
    buffer_load_dwordx4 v[140:143], v60, s[80:83], s58 offen
    s_add_u32 s58, s58, s46
    buffer_load_dwordx4 v[144:147], v60, s[80:83], s58 offen
    s_add_u32 s58, s58, s46
    buffer_load_dwordx4 v[148:151], v60, s[80:83], s58 offen
    s_add_u32 s58, s58, s46
    buffer_load_dwordx4 v[152:155], v60, s[80:83], s58 offen
    s_add_u32 s58, s58, s46
    buffer_load_dwordx4 v[156:159], v60, s[80:83], s58 offen
.Lp4a_w:
    s_waitcnt lgkmcnt(0)
.Lp4a_x:
    s_mov_b32 s88, s6
    s_mov_b32 s89, s7
    s_mov_b32 s90, 0x100
    s_mov_b32 s91, 0x00020000
    s_xor_b32 s57, s40, 4
    s_lshr_b32 s56, s2, 3
    s_or_b32 s57, s56, s57
    s_cmp_lg_u32 s57, 0
    s_cbranch_scc1 .Lp4a_non
    s_or_b32 s70, s70, 1
    v_mov_b32 v2, s70
    v_mov_b32 v3, s71
    s_mov_b64 exec, 1
    buffer_atomic_cmpswap_x2 v[2:5], v6, s[88:91], 0 offen sc1
    s_mov_b64 exec, -1
.Lp4a_non:
    s_mov_b32 s84, s4
    s_mov_b32 s85, s5
    s_mov_b32 s86, 0x200000
    s_mov_b32 s87, 0x00020000
    s_mov_b32 s70, s3
    s_sub_u32 s72, s36, 192
    s_cmp_lt_u32 s36, 64
    s_cselect_b32 s73, s36, 255
    s_add_u32 s71, s40, s41
    s_and_b32 s71, s71, 7
    s_lshl_b32 s71, s71, 3
    s_lshl_b32 s3, s42, 16
    s_lshl_b32 s4, s71, 10
    s_add_u32 s3, s3, s4
    s_barrier
    s_sub_u32 s37, s70, 0
    s_cmp_lt_u32 s37, 192
    s_cselect_b32 s37, s40, 0
    s_cmp_ge_u32 s37, 4
    s_cbranch_scc1 .Lp4a_nx
    s_cmp_lt_u32 s73, 120
    s_cbranch_scc1 .Lp4a_nx
    s_cmp_lt_u32 s72, 64
    s_cbranch_scc1 .Lp4a_nx
    s_add_u32 s4, s3, 4096
    buffer_load_dwordx4 v[160:163], v12, s[84:87], s3 offen offset:0
    buffer_load_dwordx4 v[164:167], v12, s[84:87], s3 offen offset:1024
    buffer_load_dwordx4 v[168:171], v12, s[84:87], s3 offen offset:2048
    buffer_load_dwordx4 v[172:175], v12, s[84:87], s3 offen offset:3072
    buffer_load_dwordx4 v[176:179], v12, s[84:87], s4 offen offset:0
    buffer_load_dwordx4 v[180:183], v12, s[84:87], s4 offen offset:1024
    buffer_load_dwordx4 v[184:187], v12, s[84:87], s4 offen offset:2048
    buffer_load_dwordx4 v[188:191], v12, s[84:87], s4 offen offset:3072
    s_cmp_lg_u32 s40, 0
    s_cbranch_scc1 .Lp4a_nx
    s_cmp_ge_u32 s70, 192
    s_cbranch_scc1 .Lp4a_nx
    v_mov_b32 v2, 0
    s_mov_b64 exec, 1
    buffer_load_dwordx2 v[232:233], v2, s[88:91], 0 offen sc1
    s_mov_b64 exec, -1
.Lp4a_nx:
    v_lshrrev_b32 v5, 3, v1
    v_and_b32 v6, 7, v1
    v_lshlrev_b32 v7, 1, v5
    v_and_b32 v7, 4, v7
    v_xor_b32 v6, v6, v7
    v_lshlrev_b32 v6, 4, v6
    v_lshl_add_u32 v26, v5, 13, v6
    v_lshl_add_u32 v27, v5, 10, v6
    s_lshl_b32 s43, s40, 11
    s_add_u32 s43, s43, 65536
    s_lshl_b32 s44, s41, 10
    s_lshl_b32 s56, s40, 7
    s_add_u32 s44, s44, s56
    v_lshrrev_b32 v5, 4, v1
    v_and_b32 v6, 15, v1
    s_lshl_b32 s56, s40, 3
    v_add_u32 v7, s56, v5
    v_xor_b32 v9, v7, v1
    v_and_b32 v9, 15, v9
    v_lshlrev_b32 v9, 4, v9
    v_lshl_add_u32 v40, v7, 8, v9
    v_xor_b32 v41, 64, v40
    v_lshlrev_b32 v9, 2, v5
    v_xor_b32 v9, v6, v9
    v_lshlrev_b32 v9, 4, v9
    v_lshl_add_u32 v42, v7, 8, v9
    s_lshl_b32 s47, s40, 11
    v_lshrrev_b32 v5, 5, v1
    v_bfe_u32 v6, v1, 4, 1
    v_bfe_u32 v7, v1, 2, 2
    v_and_b32 v8, 1, v1
    v_bfe_u32 v9, v1, 1, 1
    v_lshl_or_b32 v8, v8, 1, v9
    v_lshlrev_b32 v8, 3, v8
    v_lshl_add_u32 v8, v6, 5, v8
    v_lshl_add_u32 v10, v5, 3, v7
    v_lshrrev_b32 v11, 1, v7
    v_lshl_add_u32 v9, v11, 6, v8
    v_lshl_add_u32 v9, v10, 7, v9
    v_add_u32 v24, s43, v9
    v_xor_b32 v25, 64, v24
    v_add_u32 v43, 65536, v24
    v_add_u32 v45, 65536, v25
    v_lshl_add_u32 v9, v7, 6, v8
    v_lshl_add_u32 v9, v10, 8, v9
    v_add_u32 v36, 65536, v9
    v_xor_b32 v37, 64, v36
    v_xor_b32 v38, 128, v36
    v_xor_b32 v39, 192, v36
    v_and_b32 v6, 31, v1
    v_xor_b32 v7, v5, v6
    v_and_b32 v7, 15, v7
    v_lshlrev_b32 v7, 4, v7
    v_lshl_add_u32 v16, v6, 10, v7
    v_xor_b32 v17, 32, v16
    v_xor_b32 v18, 64, v16
    v_xor_b32 v19, 96, v16
    v_xor_b32 v20, 128, v16
    v_xor_b32 v21, 160, v16
    v_xor_b32 v22, 192, v16
    v_xor_b32 v23, 224, v16
    v_and_b32 v7, 0x13, v6
    v_bfe_u32 v8, v6, 2, 1
    v_lshl_or_b32 v7, v8, 3, v7
    v_bfe_u32 v8, v6, 3, 1
    v_lshl_or_b32 v7, v8, 2, v7
    v_xor_b32 v8, v5, v7
    v_and_b32 v8, 15, v8
    v_lshlrev_b32 v8, 4, v8
    v_lshl_add_u32 v8, v7, 8, v8
    v_add_u32 v28, 114688, v8
    v_xor_b32 v29, 32, v28
    v_xor_b32 v30, 64, v28
    v_xor_b32 v31, 96, v28
    v_xor_b32 v32, 128, v28
    v_xor_b32 v33, 160, v28
    v_xor_b32 v34, 192, v28
    v_xor_b32 v35, 224, v28
    v_and_b32 v14, 48, v1
    v_xor_b32 v15, s71, v1
    v_and_or_b32 v15, v15, 15, v14
    v_lshlrev_b32 v15, 4, v15
    s_lshl_b32 s57, s71, 10
    v_add_u32 v50, s57, v15
    v_xor_b32 v51, 1040, v50
    v_xor_b32 v52, 2080, v50
    v_xor_b32 v53, 3120, v50
    v_xor_b32 v54, 4160, v50
    v_xor_b32 v55, 5200, v50
    v_xor_b32 v56, 6240, v50
    v_xor_b32 v57, 7280, v50
    v_lshlrev_b32 v13, 5, v1
    v_mov_b32 v10, 0x3f80
    v_mov_b32 v11, 1.0
    s_mov_b32 s16, s64
    s_mov_b32 s17, s65
    s_mov_b32 s18, 0x400000
    s_mov_b32 s19, 0x00020000
    s_lshl_b32 s56, s41, 19
    s_add_u32 s57, s56, 393216
    s_add_u32 s20, s60, s57
    s_addc_u32 s21, s61, 0
    s_mov_b32 s22, 0x20000
    s_mov_b32 s23, 0x00020000
    s_add_u32 s24, s62, s57
    s_addc_u32 s25, s63, 0
    s_mov_b32 s26, 0x20000
    s_mov_b32 s27, 0x00020000
    s_add_u32 s28, s66, s56
    s_addc_u32 s29, s67, 0
    s_mov_b32 s30, 0x80000
    s_mov_b32 s31, 0x00020000
    s_mov_b32 s66, 0x3e0293ee
    s_lshl_b32 s58, s42, 3
    s_add_u32 s58, s58, s41
    s_lshl_b32 s58, s58, 16
    s_add_u32 s58, s58, 33554432
    s_add_u32 s32, s68, s58
    s_addc_u32 s33, s69, 0
    s_mov_b32 s34, 0x10000
    s_mov_b32 s35, 0x00020000
    s_mov_b32 s6, 0
    s_cmp_lt_u32 s37, 4
    s_cbranch_scc1 .Lp4_xl0
    s_add_u32 s4, s3, 4096
    buffer_load_dwordx4 v[160:163], v12, s[84:87], s3 offen offset:0
    buffer_load_dwordx4 v[164:167], v12, s[84:87], s3 offen offset:1024
    buffer_load_dwordx4 v[168:171], v12, s[84:87], s3 offen offset:2048
    buffer_load_dwordx4 v[172:175], v12, s[84:87], s3 offen offset:3072
    buffer_load_dwordx4 v[176:179], v12, s[84:87], s4 offen offset:0
    buffer_load_dwordx4 v[180:183], v12, s[84:87], s4 offen offset:1024
    buffer_load_dwordx4 v[184:187], v12, s[84:87], s4 offen offset:2048
    buffer_load_dwordx4 v[188:191], v12, s[84:87], s4 offen offset:3072
.Lp4_xl0:
    s_cmp_ge_u32 s72, 64
    s_cbranch_scc1 .Lp4_nc
    v_mov_b32 v2, 0
    s_mov_b64 exec, 1
    buffer_load_dwordx2 v[232:233], v2, s[88:91], 0 offen sc1
    s_mov_b64 exec, -1
    s_add_u32 s76, s68, 0x1a40000
    s_addc_u32 s77, s69, 0
    s_mov_b32 s78, 0x20000
    s_mov_b32 s79, 0x00020000
    v_and_b32 v2, 15, v1
    v_lshrrev_b32 v4, 4, v1
    v_lshlrev_b32 v4, 14, v4
    v_lshl_add_u32 v4, v2, 4, v4
    v_lshlrev_b32 v2, 5, v2
    v_add_u32 v5, 82176, v2
    s_lshl_b32 s57, s72, 8
    v_lshrrev_b32 v2, 3, v1
    v_bfe_u32 v3, v1, 1, 2
    v_lshl_add_u32 v2, v3, 3, v2
    s_lshl_b32 s4, s40, 2
    s_add_u32 s4, s4, 82176
    v_lshlrev_b32 v2, 4, v2
    v_add_u32 v6, s4, v2
    s_waitcnt vmcnt(5)
    v_lshlrev_b32 v64, 16, v224
    v_and_b32 v65, s45, v224
    v_lshlrev_b32 v66, 16, v225
    v_and_b32 v67, s45, v225
    v_mul_f32 v68, 0xbfb8aa3b, v64
    v_mul_f32 v69, 0xbfb8aa3b, v65
    v_mul_f32 v70, 0xbfb8aa3b, v66
    v_mul_f32 v71, 0xbfb8aa3b, v67
    v_exp_f32 v68, v68
    v_exp_f32 v69, v69
    v_exp_f32 v70, v70
    v_exp_f32 v71, v71
    s_nop 0
    v_add_f32 v68, 1.0, v68
    v_add_f32 v69, 1.0, v69
    v_add_f32 v70, 1.0, v70
    v_add_f32 v71, 1.0, v71
    v_rcp_f32 v80, v68
    v_rcp_f32 v81, v69
    v_rcp_f32 v82, v70
    v_rcp_f32 v83, v71
    s_nop 0
    v_mul_f32 v84, v64, v80
    v_mul_f32 v85, v65, v81
    v_mul_f32 v86, v66, v82
    v_mul_f32 v87, v67, v83
    v_fma_f32 v68, -v84, v68, v64
    v_fma_f32 v69, -v85, v69, v65
    v_fma_f32 v70, -v86, v70, v66
    v_fma_f32 v71, -v87, v71, v67
    v_fma_f32 v64, v68, v80, v84
    v_fma_f32 v65, v69, v81, v85
    v_fma_f32 v66, v70, v82, v86
    v_fma_f32 v67, v71, v83, v87
    v_cvt_pk_bf16_f32 v64, v64, v65
    v_cvt_pk_bf16_f32 v65, v66, v67
    v_and_b32 v80, 0xffff, v64
    v_lshlrev_b32 v81, 16, v64
    v_lshrrev_b32 v82, 16, v64
    v_and_b32 v83, s45, v64
    v_and_b32 v84, 0xffff, v65
    v_lshlrev_b32 v85, 16, v65
    v_lshrrev_b32 v86, 16, v65
    v_and_b32 v87, s45, v65
    s_waitcnt vmcnt(4)
    v_dot2_f32_bf16 v72, v128, v80, 0
    v_dot2_f32_bf16 v73, v128, v81, 0
    v_dot2_f32_bf16 v74, v129, v80, 0
    v_dot2_f32_bf16 v75, v129, v81, 0
    v_dot2_f32_bf16 v76, v130, v80, 0
    v_dot2_f32_bf16 v77, v130, v81, 0
    v_dot2_f32_bf16 v78, v131, v80, 0
    v_dot2_f32_bf16 v79, v131, v81, 0
    s_waitcnt vmcnt(3)
    v_dot2_f32_bf16 v72, v132, v82, v72
    v_dot2_f32_bf16 v73, v132, v83, v73
    v_dot2_f32_bf16 v74, v133, v82, v74
    v_dot2_f32_bf16 v75, v133, v83, v75
    v_dot2_f32_bf16 v76, v134, v82, v76
    v_dot2_f32_bf16 v77, v134, v83, v77
    v_dot2_f32_bf16 v78, v135, v82, v78
    v_dot2_f32_bf16 v79, v135, v83, v79
    s_waitcnt vmcnt(2)
    v_dot2_f32_bf16 v72, v136, v84, v72
    v_dot2_f32_bf16 v73, v136, v85, v73
    v_dot2_f32_bf16 v74, v137, v84, v74
    v_dot2_f32_bf16 v75, v137, v85, v75
    v_dot2_f32_bf16 v76, v138, v84, v76
    v_dot2_f32_bf16 v77, v138, v85, v77
    v_dot2_f32_bf16 v78, v139, v84, v78
    v_dot2_f32_bf16 v79, v139, v85, v79
    s_waitcnt vmcnt(1)
    v_dot2_f32_bf16 v72, v140, v86, v72
    v_dot2_f32_bf16 v73, v140, v87, v73
    v_dot2_f32_bf16 v74, v141, v86, v74
    v_dot2_f32_bf16 v75, v141, v87, v75
    v_dot2_f32_bf16 v76, v142, v86, v76
    v_dot2_f32_bf16 v77, v142, v87, v77
    v_dot2_f32_bf16 v78, v143, v86, v78
    v_dot2_f32_bf16 v79, v143, v87, v79
    s_nop 0
    v_permlane32_swap_b32 v72, v76
    v_permlane32_swap_b32 v73, v77
    v_permlane32_swap_b32 v74, v78
    v_permlane32_swap_b32 v75, v79
    s_nop 0
    v_add_f32 v72, v72, v76
    v_add_f32 v73, v73, v77
    v_add_f32 v74, v74, v78
    v_add_f32 v75, v75, v79
    s_nop 1
    v_permlane16_swap_b32 v72, v74
    v_permlane16_swap_b32 v73, v75
    s_nop 1
    v_add_f32 v72, v72, v74
    v_add_f32 v73, v73, v75
    s_nop 1
    v_add_f32_dpp v74, v72, v72 row_ror:8 row_mask:0xf bank_mask:0x3
    v_add_f32_dpp v74, v73, v73 row_ror:8 row_mask:0xf bank_mask:0xc
    s_nop 1
    v_add_f32_dpp v72, v74, v74 quad_perm:[1,0,3,2] row_mask:0xf bank_mask:0xf
    ds_write_b32 v6, v72
    v_mov_b32 v3, 1
    s_waitcnt lgkmcnt(0)
    s_mov_b64 exec, 1
    ds_add_rtn_u32 v3, v58, v3 offset:16
    s_mov_b64 exec, -1
    s_waitcnt lgkmcnt(0)
    v_readfirstlane_b32 s4, v3
    s_cmp_lg_u32 s4, 3
    s_cbranch_scc1 .Lp4_cw
    ds_read_b128 v[64:67], v5 offset:0
    ds_read_b128 v[68:71], v5 offset:16
    s_waitcnt vmcnt(0)
    s_mov_b32 s4, 0
.Lp4_nla:
    v_readfirstlane_b32 s100, v232
    v_readfirstlane_b32 s101, v233
    s_add_u32 s4, s4, 1
    s_cmp_lg_u32 s100, 0
    s_cbranch_scc1 .Lp4_nda
    s_cmp_lt_u32 s4, 0x40000
    s_cbranch_scc0 .Lp4_nda
    v_mov_b32 v2, 0
    s_mov_b64 exec, 1
    buffer_load_dwordx2 v[232:233], v2, s[88:91], 0 offen sc1
    s_mov_b64 exec, -1
    s_waitcnt vmcnt(0)
    s_branch .Lp4_nla
.Lp4_nda:
    s_or_b32 s100, s100, 1
    v_mov_b32 v232, s100
    v_mov_b32 v233, s101
    ds_write_b64 v58, v[232:233]
    s_waitcnt lgkmcnt(0)
    v_pk_add_f32 v[64:65], v[64:65], v[66:67]
    v_pk_add_f32 v[68:69], v[68:69], v[70:71]
    v_add_f32 v64, v64, v65
    v_add_f32 v66, v68, v69
    v_mov_b32 v65, s100
    v_mov_b32 v67, s100
    buffer_store_dwordx4 v[64:67], v4, s[76:79], s57 offen sc1
    s_add_u32 s57, s57, 65536
    buffer_store_dwordx4 v[64:67], v4, s[76:79], s57 offen sc1
    v_mov_b32 v3, 1
    s_mov_b64 exec, 1
    ds_add_u32 v58, v3 offset:16
    s_mov_b64 exec, -1
    s_branch .Lp4_cx
.Lp4_cw:
.Lp4_spc:
    s_sleep 2
    ds_read_b32 v3, v58 offset:16
    s_waitcnt lgkmcnt(0)
    v_readfirstlane_b32 s4, v3
    s_cmp_lt_u32 s4, 5
    s_cbranch_scc1 .Lp4_spc
    s_branch .Lp4_cx
.Lp4_nc:
    s_cmp_ge_u32 s73, 120
    s_cbranch_scc1 .Lp4_nl
    s_mov_b32 s76, s68
    s_mov_b32 s77, s69
    s_mov_b32 s78, 0x20000
    s_mov_b32 s79, 0x00020000
    v_and_b32 v2, 7, v1
    v_lshrrev_b32 v3, 3, v1
    v_lshl_add_u32 v2, v2, 3, v3
    s_lshl_b32 s4, s40, 8
    s_add_u32 s4, s4, 82176
    v_lshlrev_b32 v2, 2, v2
    v_add_u32 v6, s4, v2
    v_lshlrev_b32 v4, 2, v1
    v_add_u32 v5, 82176, v4
    s_cmp_lt_u32 s73, 64
    s_cbranch_scc1 .Lp4_silu
    v_mov_b32 v96, v10
    v_mov_b32 v97, v11
    v_mov_b32 v98, v10
    v_mov_b32 v99, v11
    v_mov_b32 v100, v10
    v_mov_b32 v101, v11
    v_mov_b32 v102, v10
    v_mov_b32 v103, v11
    v_mov_b32 v104, v10
    v_mov_b32 v105, v11
    v_mov_b32 v106, v10
    v_mov_b32 v107, v11
    v_mov_b32 v108, v10
    v_mov_b32 v109, v11
    v_mov_b32 v110, v10
    v_mov_b32 v111, v11
    s_branch .Lp4_fma
.Lp4_silu:
    s_waitcnt vmcnt(8)
    v_lshlrev_b32 v64, 16, v224
    v_and_b32 v65, s45, v224
    v_lshlrev_b32 v66, 16, v225
    v_and_b32 v67, s45, v225
    v_lshlrev_b32 v68, 16, v226
    v_and_b32 v69, s45, v226
    v_lshlrev_b32 v70, 16, v227
    v_and_b32 v71, s45, v227
    v_mul_f32 v72, 0xbfb8aa3b, v64
    v_mul_f32 v73, 0xbfb8aa3b, v65
    v_mul_f32 v74, 0xbfb8aa3b, v66
    v_mul_f32 v75, 0xbfb8aa3b, v67
    v_mul_f32 v76, 0xbfb8aa3b, v68
    v_mul_f32 v77, 0xbfb8aa3b, v69
    v_mul_f32 v78, 0xbfb8aa3b, v70
    v_mul_f32 v79, 0xbfb8aa3b, v71
    v_exp_f32 v72, v72
    v_exp_f32 v73, v73
    v_exp_f32 v74, v74
    v_exp_f32 v75, v75
    v_exp_f32 v76, v76
    v_exp_f32 v77, v77
    v_exp_f32 v78, v78
    v_exp_f32 v79, v79
    s_nop 0
    v_add_f32 v72, 1.0, v72
    v_add_f32 v73, 1.0, v73
    v_add_f32 v74, 1.0, v74
    v_add_f32 v75, 1.0, v75
    v_add_f32 v76, 1.0, v76
    v_add_f32 v77, 1.0, v77
    v_add_f32 v78, 1.0, v78
    v_add_f32 v79, 1.0, v79
    v_rcp_f32 v80, v72
    v_rcp_f32 v81, v73
    v_rcp_f32 v82, v74
    v_rcp_f32 v83, v75
    v_rcp_f32 v84, v76
    v_rcp_f32 v85, v77
    v_rcp_f32 v86, v78
    v_rcp_f32 v87, v79
    s_nop 0
    v_mul_f32 v88, v64, v80
    v_mul_f32 v89, v65, v81
    v_mul_f32 v90, v66, v82
    v_mul_f32 v91, v67, v83
    v_mul_f32 v92, v68, v84
    v_mul_f32 v93, v69, v85
    v_mul_f32 v94, v70, v86
    v_mul_f32 v95, v71, v87
    v_fma_f32 v72, -v88, v72, v64
    v_fma_f32 v73, -v89, v73, v65
    v_fma_f32 v74, -v90, v74, v66
    v_fma_f32 v75, -v91, v75, v67
    v_fma_f32 v76, -v92, v76, v68
    v_fma_f32 v77, -v93, v77, v69
    v_fma_f32 v78, -v94, v78, v70
    v_fma_f32 v79, -v95, v79, v71
    v_fma_f32 v64, v72, v80, v88
    v_fma_f32 v65, v73, v81, v89
    v_fma_f32 v66, v74, v82, v90
    v_fma_f32 v67, v75, v83, v91
    v_fma_f32 v68, v76, v84, v92
    v_fma_f32 v69, v77, v85, v93
    v_fma_f32 v70, v78, v86, v94
    v_fma_f32 v71, v79, v87, v95
    v_cvt_pk_bf16_f32 v72, v64, v65
    v_cvt_pk_bf16_f32 v73, v66, v67
    v_cvt_pk_bf16_f32 v74, v68, v69
    v_cvt_pk_bf16_f32 v75, v70, v71
    v_and_b32 v96, 0xffff, v72
    v_lshlrev_b32 v97, 16, v72
    v_lshrrev_b32 v98, 16, v72
    v_and_b32 v99, s45, v72
    v_and_b32 v100, 0xffff, v73
    v_lshlrev_b32 v101, 16, v73
    v_lshrrev_b32 v102, 16, v73
    v_and_b32 v103, s45, v73
    v_and_b32 v104, 0xffff, v74
    v_lshlrev_b32 v105, 16, v74
    v_lshrrev_b32 v106, 16, v74
    v_and_b32 v107, s45, v74
    v_and_b32 v108, 0xffff, v75
    v_lshlrev_b32 v109, 16, v75
    v_lshrrev_b32 v110, 16, v75
    v_and_b32 v111, s45, v75
.Lp4_fma:
    s_waitcnt vmcnt(7)
    v_dot2_f32_bf16 v72, v128, v96, 0
    v_dot2_f32_bf16 v73, v128, v97, 0
    v_dot2_f32_bf16 v74, v129, v96, 0
    v_dot2_f32_bf16 v75, v129, v97, 0
    v_dot2_f32_bf16 v76, v130, v96, 0
    v_dot2_f32_bf16 v77, v130, v97, 0
    v_dot2_f32_bf16 v78, v131, v96, 0
    v_dot2_f32_bf16 v79, v131, v97, 0
    s_waitcnt vmcnt(6)
    v_dot2_f32_bf16 v72, v132, v98, v72
    v_dot2_f32_bf16 v73, v132, v99, v73
    v_dot2_f32_bf16 v74, v133, v98, v74
    v_dot2_f32_bf16 v75, v133, v99, v75
    v_dot2_f32_bf16 v76, v134, v98, v76
    v_dot2_f32_bf16 v77, v134, v99, v77
    v_dot2_f32_bf16 v78, v135, v98, v78
    v_dot2_f32_bf16 v79, v135, v99, v79
    s_waitcnt vmcnt(5)
    v_dot2_f32_bf16 v72, v136, v100, v72
    v_dot2_f32_bf16 v73, v136, v101, v73
    v_dot2_f32_bf16 v74, v137, v100, v74
    v_dot2_f32_bf16 v75, v137, v101, v75
    v_dot2_f32_bf16 v76, v138, v100, v76
    v_dot2_f32_bf16 v77, v138, v101, v77
    v_dot2_f32_bf16 v78, v139, v100, v78
    v_dot2_f32_bf16 v79, v139, v101, v79
    s_waitcnt vmcnt(4)
    v_dot2_f32_bf16 v72, v140, v102, v72
    v_dot2_f32_bf16 v73, v140, v103, v73
    v_dot2_f32_bf16 v74, v141, v102, v74
    v_dot2_f32_bf16 v75, v141, v103, v75
    v_dot2_f32_bf16 v76, v142, v102, v76
    v_dot2_f32_bf16 v77, v142, v103, v77
    v_dot2_f32_bf16 v78, v143, v102, v78
    v_dot2_f32_bf16 v79, v143, v103, v79
    s_waitcnt vmcnt(3)
    v_dot2_f32_bf16 v72, v144, v104, v72
    v_dot2_f32_bf16 v73, v144, v105, v73
    v_dot2_f32_bf16 v74, v145, v104, v74
    v_dot2_f32_bf16 v75, v145, v105, v75
    v_dot2_f32_bf16 v76, v146, v104, v76
    v_dot2_f32_bf16 v77, v146, v105, v77
    v_dot2_f32_bf16 v78, v147, v104, v78
    v_dot2_f32_bf16 v79, v147, v105, v79
    s_waitcnt vmcnt(2)
    v_dot2_f32_bf16 v72, v148, v106, v72
    v_dot2_f32_bf16 v73, v148, v107, v73
    v_dot2_f32_bf16 v74, v149, v106, v74
    v_dot2_f32_bf16 v75, v149, v107, v75
    v_dot2_f32_bf16 v76, v150, v106, v76
    v_dot2_f32_bf16 v77, v150, v107, v77
    v_dot2_f32_bf16 v78, v151, v106, v78
    v_dot2_f32_bf16 v79, v151, v107, v79
    s_waitcnt vmcnt(1)
    v_dot2_f32_bf16 v72, v152, v108, v72
    v_dot2_f32_bf16 v73, v152, v109, v73
    v_dot2_f32_bf16 v74, v153, v108, v74
    v_dot2_f32_bf16 v75, v153, v109, v75
    v_dot2_f32_bf16 v76, v154, v108, v76
    v_dot2_f32_bf16 v77, v154, v109, v77
    v_dot2_f32_bf16 v78, v155, v108, v78
    v_dot2_f32_bf16 v79, v155, v109, v79
    s_waitcnt vmcnt(0)
    v_dot2_f32_bf16 v72, v156, v110, v72
    v_dot2_f32_bf16 v73, v156, v111, v73
    v_dot2_f32_bf16 v74, v157, v110, v74
    v_dot2_f32_bf16 v75, v157, v111, v75
    v_dot2_f32_bf16 v76, v158, v110, v76
    v_dot2_f32_bf16 v77, v158, v111, v77
    v_dot2_f32_bf16 v78, v159, v110, v78
    v_dot2_f32_bf16 v79, v159, v111, v79
    s_add_u32 s4, s3, 4096
    buffer_load_dwordx4 v[160:163], v12, s[84:87], s3 offen offset:0
    buffer_load_dwordx4 v[164:167], v12, s[84:87], s3 offen offset:1024
    buffer_load_dwordx4 v[168:171], v12, s[84:87], s3 offen offset:2048
    buffer_load_dwordx4 v[172:175], v12, s[84:87], s3 offen offset:3072
    buffer_load_dwordx4 v[176:179], v12, s[84:87], s4 offen offset:0
    buffer_load_dwordx4 v[180:183], v12, s[84:87], s4 offen offset:1024
    buffer_load_dwordx4 v[184:187], v12, s[84:87], s4 offen offset:2048
    buffer_load_dwordx4 v[188:191], v12, s[84:87], s4 offen offset:3072
    v_permlane32_swap_b32 v72, v76
    v_permlane32_swap_b32 v73, v77
    v_permlane32_swap_b32 v74, v78
    v_permlane32_swap_b32 v75, v79
    s_nop 0
    v_add_f32 v72, v72, v76
    v_add_f32 v73, v73, v77
    v_add_f32 v74, v74, v78
    v_add_f32 v75, v75, v79
    s_nop 1
    v_permlane16_swap_b32 v72, v74
    v_permlane16_swap_b32 v73, v75
    s_nop 1
    v_add_f32 v72, v72, v74
    v_add_f32 v73, v73, v75
    s_nop 1
    v_add_f32_dpp v74, v72, v72 row_ror:8 row_mask:0xf bank_mask:0x3
    v_add_f32_dpp v74, v73, v73 row_ror:8 row_mask:0xf bank_mask:0xc
    ds_write_b32 v6, v74
    s_mov_b32 s5, s73
    s_movk_i32 s73, 255
    v_mov_b32 v3, 1
    s_waitcnt lgkmcnt(0)
    s_mov_b64 exec, 1
    ds_add_rtn_u32 v3, v58, v3 offset:16
    s_mov_b64 exec, -1
    s_waitcnt lgkmcnt(0)
    v_readfirstlane_b32 s4, v3
    s_cmp_lg_u32 s4, 3
    s_cbranch_scc1 .Lp4_nl
    s_mov_b32 s73, s5
    ds_read_b32 v64, v5 offset:0
    ds_read_b32 v65, v5 offset:256
    ds_read_b32 v66, v5 offset:512
    ds_read_b32 v67, v5 offset:768
    s_waitcnt lgkmcnt(0)
    v_add_f32 v64, v64, v65
    v_add_f32 v66, v66, v67
    v_add_f32 v64, v64, v66
    buffer_store_dword v64, v4, s[76:79], s59 offen sc1
    s_waitcnt vmcnt(1)
    s_branch .Lp4_xd
.Lp4_cx:
    s_add_u32 s4, s3, 4096
    buffer_load_dwordx4 v[160:163], v12, s[84:87], s3 offen offset:0
    buffer_load_dwordx4 v[164:167], v12, s[84:87], s3 offen offset:1024
    buffer_load_dwordx4 v[168:171], v12, s[84:87], s3 offen offset:2048
    buffer_load_dwordx4 v[172:175], v12, s[84:87], s3 offen offset:3072
    buffer_load_dwordx4 v[176:179], v12, s[84:87], s4 offen offset:0
    buffer_load_dwordx4 v[180:183], v12, s[84:87], s4 offen offset:1024
    buffer_load_dwordx4 v[184:187], v12, s[84:87], s4 offen offset:2048
    buffer_load_dwordx4 v[188:191], v12, s[84:87], s4 offen offset:3072
.Lp4_nl:
    s_cmp_ge_u32 s70, 192
    s_cbranch_scc1 .Lp4_e1
    s_cmp_lt_u32 s70, 64
    s_cbranch_scc1 .Lp4_e0
    s_cmp_lg_u32 s40, 0
    s_cbranch_scc1 .Lp4_e1
    s_branch .Lp4_e2
.Lp4_e0:
    s_cmp_lg_u32 s40, 4
    s_cbranch_scc1 .Lp4_e1
    v_mov_b32 v2, 0
    s_mov_b64 exec, 1
    buffer_load_dwordx2 v[232:233], v2, s[88:91], 0 offen sc1
    s_mov_b64 exec, -1
.Lp4_e2:
    s_mov_b32 s6, 1
    s_waitcnt vmcnt(1)
    s_branch .Lp4_xd
.Lp4_e1:
    s_waitcnt vmcnt(0)
.Lp4_xd:
    s_mov_b32 s7, 0x3f803f80
    v_dot2_f32_bf16 v80, v160, s7, 0
    v_dot2_f32_bf16 v88, v160, v160, 0
    v_dot2_f32_bf16 v80, v161, s7, v80
    v_dot2_f32_bf16 v88, v161, v161, v88
    v_dot2_f32_bf16 v80, v162, s7, v80
    v_dot2_f32_bf16 v88, v162, v162, v88
    v_dot2_f32_bf16 v80, v163, s7, v80
    v_dot2_f32_bf16 v88, v163, v163, v88
    v_dot2_f32_bf16 v81, v164, s7, 0
    v_dot2_f32_bf16 v89, v164, v164, 0
    v_dot2_f32_bf16 v81, v165, s7, v81
    v_dot2_f32_bf16 v89, v165, v165, v89
    v_dot2_f32_bf16 v81, v166, s7, v81
    v_dot2_f32_bf16 v89, v166, v166, v89
    v_dot2_f32_bf16 v81, v167, s7, v81
    v_dot2_f32_bf16 v89, v167, v167, v89
    v_dot2_f32_bf16 v82, v168, s7, 0
    v_dot2_f32_bf16 v90, v168, v168, 0
    v_dot2_f32_bf16 v82, v169, s7, v82
    v_dot2_f32_bf16 v90, v169, v169, v90
    v_dot2_f32_bf16 v82, v170, s7, v82
    v_dot2_f32_bf16 v90, v170, v170, v90
    v_dot2_f32_bf16 v82, v171, s7, v82
    v_dot2_f32_bf16 v90, v171, v171, v90
    v_dot2_f32_bf16 v83, v172, s7, 0
    v_dot2_f32_bf16 v91, v172, v172, 0
    v_dot2_f32_bf16 v83, v173, s7, v83
    v_dot2_f32_bf16 v91, v173, v173, v91
    v_dot2_f32_bf16 v83, v174, s7, v83
    v_dot2_f32_bf16 v91, v174, v174, v91
    v_dot2_f32_bf16 v83, v175, s7, v83
    v_dot2_f32_bf16 v91, v175, v175, v91
    v_dot2_f32_bf16 v84, v176, s7, 0
    v_dot2_f32_bf16 v92, v176, v176, 0
    v_dot2_f32_bf16 v84, v177, s7, v84
    v_dot2_f32_bf16 v92, v177, v177, v92
    v_dot2_f32_bf16 v84, v178, s7, v84
    v_dot2_f32_bf16 v92, v178, v178, v92
    v_dot2_f32_bf16 v84, v179, s7, v84
    v_dot2_f32_bf16 v92, v179, v179, v92
    v_dot2_f32_bf16 v85, v180, s7, 0
    v_dot2_f32_bf16 v93, v180, v180, 0
    v_dot2_f32_bf16 v85, v181, s7, v85
    v_dot2_f32_bf16 v93, v181, v181, v93
    v_dot2_f32_bf16 v85, v182, s7, v85
    v_dot2_f32_bf16 v93, v182, v182, v93
    v_dot2_f32_bf16 v85, v183, s7, v85
    v_dot2_f32_bf16 v93, v183, v183, v93
    v_dot2_f32_bf16 v86, v184, s7, 0
    v_dot2_f32_bf16 v94, v184, v184, 0
    v_dot2_f32_bf16 v86, v185, s7, v86
    v_dot2_f32_bf16 v94, v185, v185, v94
    v_dot2_f32_bf16 v86, v186, s7, v86
    v_dot2_f32_bf16 v94, v186, v186, v94
    v_dot2_f32_bf16 v86, v187, s7, v86
    v_dot2_f32_bf16 v94, v187, v187, v94
    v_dot2_f32_bf16 v87, v188, s7, 0
    v_dot2_f32_bf16 v95, v188, v188, 0
    v_dot2_f32_bf16 v87, v189, s7, v87
    v_dot2_f32_bf16 v95, v189, v189, v95
    v_dot2_f32_bf16 v87, v190, s7, v87
    v_dot2_f32_bf16 v95, v190, v190, v95
    v_dot2_f32_bf16 v87, v191, s7, v87
    v_dot2_f32_bf16 v95, v191, v191, v95
    s_add_u32 s76, s68, 0x1a40000
    s_addc_u32 s77, s69, 0
    s_mov_b32 s78, 0x20000
    s_mov_b32 s79, 0x00020000
    s_and_b32 s57, s42, 7
    s_lshl_b32 s57, s57, 14
    s_lshl_b32 s4, s40, 10
    s_add_u32 s57, s57, s4
    s_add_u32 s58, s57, 8192
    v_permlane32_swap_b32 v80, v84
    v_permlane32_swap_b32 v81, v85
    v_permlane32_swap_b32 v82, v86
    v_permlane32_swap_b32 v83, v87
    v_permlane32_swap_b32 v88, v92
    v_permlane32_swap_b32 v89, v93
    v_permlane32_swap_b32 v90, v94
    v_permlane32_swap_b32 v91, v95
    v_add_f32 v80, v80, v84
    v_add_f32 v81, v81, v85
    v_add_f32 v82, v82, v86
    v_add_f32 v83, v83, v87
    v_add_f32 v88, v88, v92
    v_add_f32 v89, v89, v93
    v_add_f32 v90, v90, v94
    v_add_f32 v91, v91, v95
    s_nop 0
    v_permlane16_swap_b32 v80, v82
    v_permlane16_swap_b32 v81, v83
    v_permlane16_swap_b32 v88, v90
    v_permlane16_swap_b32 v89, v91
    s_nop 1
    v_add_f32 v80, v80, v82
    v_add_f32 v81, v81, v83
    v_add_f32 v88, v88, v90
    v_add_f32 v89, v89, v91
    s_nop 1
    v_add_f32_dpp v82, v80, v80 row_ror:8 row_mask:0xf bank_mask:0x3
    v_add_f32_dpp v82, v81, v81 row_ror:8 row_mask:0xf bank_mask:0xc
    v_add_f32_dpp v90, v88, v88 row_ror:8 row_mask:0xf bank_mask:0x3
    v_add_f32_dpp v90, v89, v89 row_ror:8 row_mask:0xf bank_mask:0xc
    s_nop 0
    v_add_f32_dpp v80, v82, v82 row_half_mirror row_mask:0xf bank_mask:0xf
    v_add_f32_dpp v88, v90, v90 row_half_mirror row_mask:0xf bank_mask:0xf
    s_nop 0
    v_add_f32_dpp v80, v80, v80 quad_perm:[1,0,3,2] row_mask:0xf bank_mask:0xf
    v_add_f32_dpp v88, v88, v88 quad_perm:[1,0,3,2] row_mask:0xf bank_mask:0xf
    s_nop 0
    v_add_f32_dpp v80, v80, v80 quad_perm:[2,3,0,1] row_mask:0xf bank_mask:0xf
    v_add_f32_dpp v88, v88, v88 quad_perm:[2,3,0,1] row_mask:0xf bank_mask:0xf
    v_mul_f32 v80, 0x3b000000, v80
    v_mul_f32 v88, 0x3b000000, v88
    v_fma_f32 v88, -v80, v80, v88
    v_cvt_pk_bf16_f32 v80, 0, -v80
    v_max_f32 v88, 0, v88
    v_cvt_pk_bf16_f32 v88, 0, v88
    v_add_f32 v88, 0x3727c5ac, v88
    v_cvt_pk_bf16_f32 v88, 0, v88
    v_sqrt_f32 v88, v88
    v_readlane_b32 s8, v80, 0
    v_readlane_b32 s9, v80, 8
    v_readlane_b32 s10, v80, 16
    v_readlane_b32 s11, v80, 24
    v_cvt_pk_bf16_f32 v88, 0, v88
    v_rcp_f32 v88, v88
    v_readlane_b32 s12, v80, 32
    v_readlane_b32 s13, v80, 40
    v_readlane_b32 s14, v80, 48
    v_readlane_b32 s15, v80, 56
    v_readlane_b32 s48, v88, 0
    v_readlane_b32 s49, v88, 8
    v_readlane_b32 s50, v88, 16
    v_readlane_b32 s51, v88, 24
    v_readlane_b32 s52, v88, 32
    v_readlane_b32 s53, v88, 40
    v_readlane_b32 s54, v88, 48
    v_readlane_b32 s55, v88, 56
    s_cmp_eq_u32 s6, 0
    s_cbranch_scc1 .Lp4_e3
    s_waitcnt vmcnt(0)
    s_mov_b32 s4, 0
.Lp4_nlb:
    v_readfirstlane_b32 s100, v232
    v_readfirstlane_b32 s101, v233
    s_add_u32 s4, s4, 1
    s_cmp_lg_u32 s100, 0
    s_cbranch_scc1 .Lp4_ndb
    s_cmp_lt_u32 s4, 0x40000
    s_cbranch_scc0 .Lp4_ndb
    v_mov_b32 v2, 0
    s_mov_b64 exec, 1
    buffer_load_dwordx2 v[232:233], v2, s[88:91], 0 offen sc1
    s_mov_b64 exec, -1
    s_waitcnt vmcnt(0)
    s_branch .Lp4_nlb
.Lp4_ndb:
    s_or_b32 s100, s100, 1
    v_mov_b32 v232, s100
    v_mov_b32 v233, s101
    ds_write_b64 v58, v[232:233]
.Lp4_e3:
    s_sub_u32 s72, s70, 128
    s_cmp_eq_u32 s40, 0
    s_cselect_b32 s72, s72, 255
    s_lshl_b32 s59, s72, 8
    s_and_b32 s4, s42, 7
    s_lshl_b32 s4, s4, 14
    s_add_u32 s59, s59, s4
    v_and_b32 v7, 31, v1
    v_lshlrev_b32 v7, 3, v7
    s_sub_u32 s6, s70, 64
    s_cmp_ge_u32 s6, 128
    s_cbranch_scc1 .Lp4_p0
    s_cmp_ge_u32 s72, 64
    s_cbranch_scc1 .Lp4_g1_
    buffer_load_dwordx2 v[244:245], v7, s[76:79], s59 offen sc1
.Lp4_g1_:
    buffer_load_dwordx4 v[236:239], v12, s[76:79], s57 offen sc1
    buffer_load_dwordx4 v[240:243], v12, s[76:79], s58 offen sc1
    s_add_u32 m0, s43, 32768
    s_nop 0
    buffer_load_dwordx4 v26, s[16:19], s44 offen  lds
    s_add_u32 s44, s44, 65536
    s_add_u32 m0, s43, 33792
    s_nop 0
    buffer_load_dwordx4 v26, s[16:19], s44 offen  lds
    s_add_u32 s44, s44, 65536
    s_add_u32 m0, s43, 49152
    s_nop 0
    buffer_load_dwordx4 v26, s[16:19], s44 offen  lds
    s_add_u32 s44, s44, 65536
    s_add_u32 m0, s43, 50176
    s_nop 0
    buffer_load_dwordx4 v26, s[16:19], s44 offen  lds
    s_add_u32 s44, s44, 65536
.Lp4_p0:
    v_dot2_f32_bf16 v96, v160, v10, s8
    v_dot2_f32_bf16 v97, v160, v11, s8
    v_dot2_f32_bf16 v98, v161, v10, s8
    v_dot2_f32_bf16 v99, v161, v11, s8
    v_dot2_f32_bf16 v100, v162, v10, s8
    v_dot2_f32_bf16 v101, v162, v11, s8
    v_dot2_f32_bf16 v102, v163, v10, s8
    v_dot2_f32_bf16 v103, v163, v11, s8
    v_cvt_pk_bf16_f32 v96, 0, v96
    v_cvt_pk_bf16_f32 v97, 0, v97
    v_cvt_pk_bf16_f32 v98, 0, v98
    v_cvt_pk_bf16_f32 v99, 0, v99
    v_cvt_pk_bf16_f32 v100, 0, v100
    v_cvt_pk_bf16_f32 v101, 0, v101
    v_cvt_pk_bf16_f32 v102, 0, v102
    v_cvt_pk_bf16_f32 v103, 0, v103
    v_pk_mul_f32 v[96:97], v[96:97], s[48:49] op_sel_hi:[1,0]
    v_pk_mul_f32 v[98:99], v[98:99], s[48:49] op_sel_hi:[1,0]
    v_pk_mul_f32 v[100:101], v[100:101], s[48:49] op_sel_hi:[1,0]
    v_pk_mul_f32 v[102:103], v[102:103], s[48:49] op_sel_hi:[1,0]
    v_cvt_pk_bf16_f32 v160, v96, v97
    v_cvt_pk_bf16_f32 v161, v98, v99
    v_cvt_pk_bf16_f32 v162, v100, v101
    v_cvt_pk_bf16_f32 v163, v102, v103
    v_dot2_f32_bf16 v112, v164, v10, s9
    v_dot2_f32_bf16 v113, v164, v11, s9
    v_dot2_f32_bf16 v114, v165, v10, s9
    v_dot2_f32_bf16 v115, v165, v11, s9
    v_dot2_f32_bf16 v116, v166, v10, s9
    v_dot2_f32_bf16 v117, v166, v11, s9
    v_dot2_f32_bf16 v118, v167, v10, s9
    v_dot2_f32_bf16 v119, v167, v11, s9
    v_cvt_pk_bf16_f32 v112, 0, v112
    v_cvt_pk_bf16_f32 v113, 0, v113
    v_cvt_pk_bf16_f32 v114, 0, v114
    v_cvt_pk_bf16_f32 v115, 0, v115
    v_cvt_pk_bf16_f32 v116, 0, v116
    v_cvt_pk_bf16_f32 v117, 0, v117
    v_cvt_pk_bf16_f32 v118, 0, v118
    v_cvt_pk_bf16_f32 v119, 0, v119
    v_pk_mul_f32 v[112:113], v[112:113], s[48:49] op_sel:[0,1]
    v_pk_mul_f32 v[114:115], v[114:115], s[48:49] op_sel:[0,1]
    v_pk_mul_f32 v[116:117], v[116:117], s[48:49] op_sel:[0,1]
    v_pk_mul_f32 v[118:119], v[118:119], s[48:49] op_sel:[0,1]
    v_cvt_pk_bf16_f32 v164, v112, v113
    v_cvt_pk_bf16_f32 v165, v114, v115
    v_cvt_pk_bf16_f32 v166, v116, v117
    v_cvt_pk_bf16_f32 v167, v118, v119
    v_dot2_f32_bf16 v96, v168, v10, s10
    v_dot2_f32_bf16 v97, v168, v11, s10
    v_dot2_f32_bf16 v98, v169, v10, s10
    v_dot2_f32_bf16 v99, v169, v11, s10
    v_dot2_f32_bf16 v100, v170, v10, s10
    v_dot2_f32_bf16 v101, v170, v11, s10
    v_dot2_f32_bf16 v102, v171, v10, s10
    v_dot2_f32_bf16 v103, v171, v11, s10
    v_cvt_pk_bf16_f32 v96, 0, v96
    v_cvt_pk_bf16_f32 v97, 0, v97
    v_cvt_pk_bf16_f32 v98, 0, v98
    v_cvt_pk_bf16_f32 v99, 0, v99
    v_cvt_pk_bf16_f32 v100, 0, v100
    v_cvt_pk_bf16_f32 v101, 0, v101
    v_cvt_pk_bf16_f32 v102, 0, v102
    v_cvt_pk_bf16_f32 v103, 0, v103
    v_pk_mul_f32 v[96:97], v[96:97], s[50:51] op_sel_hi:[1,0]
    v_pk_mul_f32 v[98:99], v[98:99], s[50:51] op_sel_hi:[1,0]
    v_pk_mul_f32 v[100:101], v[100:101], s[50:51] op_sel_hi:[1,0]
    v_pk_mul_f32 v[102:103], v[102:103], s[50:51] op_sel_hi:[1,0]
    v_cvt_pk_bf16_f32 v168, v96, v97
    v_cvt_pk_bf16_f32 v169, v98, v99
    v_cvt_pk_bf16_f32 v170, v100, v101
    v_cvt_pk_bf16_f32 v171, v102, v103
    v_dot2_f32_bf16 v112, v172, v10, s11
    v_dot2_f32_bf16 v113, v172, v11, s11
    v_dot2_f32_bf16 v114, v173, v10, s11
    v_dot2_f32_bf16 v115, v173, v11, s11
    v_dot2_f32_bf16 v116, v174, v10, s11
    v_dot2_f32_bf16 v117, v174, v11, s11
    v_dot2_f32_bf16 v118, v175, v10, s11
    v_dot2_f32_bf16 v119, v175, v11, s11
    v_cvt_pk_bf16_f32 v112, 0, v112
    v_cvt_pk_bf16_f32 v113, 0, v113
    v_cvt_pk_bf16_f32 v114, 0, v114
    v_cvt_pk_bf16_f32 v115, 0, v115
    v_cvt_pk_bf16_f32 v116, 0, v116
    v_cvt_pk_bf16_f32 v117, 0, v117
    v_cvt_pk_bf16_f32 v118, 0, v118
    v_cvt_pk_bf16_f32 v119, 0, v119
    v_pk_mul_f32 v[112:113], v[112:113], s[50:51] op_sel:[0,1]
    v_pk_mul_f32 v[114:115], v[114:115], s[50:51] op_sel:[0,1]
    v_pk_mul_f32 v[116:117], v[116:117], s[50:51] op_sel:[0,1]
    v_pk_mul_f32 v[118:119], v[118:119], s[50:51] op_sel:[0,1]
    v_cvt_pk_bf16_f32 v172, v112, v113
    v_cvt_pk_bf16_f32 v173, v114, v115
    v_cvt_pk_bf16_f32 v174, v116, v117
    v_cvt_pk_bf16_f32 v175, v118, v119
    v_dot2_f32_bf16 v96, v176, v10, s12
    v_dot2_f32_bf16 v97, v176, v11, s12
    v_dot2_f32_bf16 v98, v177, v10, s12
    v_dot2_f32_bf16 v99, v177, v11, s12
    v_dot2_f32_bf16 v100, v178, v10, s12
    v_dot2_f32_bf16 v101, v178, v11, s12
    v_dot2_f32_bf16 v102, v179, v10, s12
    v_dot2_f32_bf16 v103, v179, v11, s12
    v_cvt_pk_bf16_f32 v96, 0, v96
    v_cvt_pk_bf16_f32 v97, 0, v97
    v_cvt_pk_bf16_f32 v98, 0, v98
    v_cvt_pk_bf16_f32 v99, 0, v99
    v_cvt_pk_bf16_f32 v100, 0, v100
    v_cvt_pk_bf16_f32 v101, 0, v101
    v_cvt_pk_bf16_f32 v102, 0, v102
    v_cvt_pk_bf16_f32 v103, 0, v103
    v_pk_mul_f32 v[96:97], v[96:97], s[52:53] op_sel_hi:[1,0]
    v_pk_mul_f32 v[98:99], v[98:99], s[52:53] op_sel_hi:[1,0]
    v_pk_mul_f32 v[100:101], v[100:101], s[52:53] op_sel_hi:[1,0]
    v_pk_mul_f32 v[102:103], v[102:103], s[52:53] op_sel_hi:[1,0]
    v_cvt_pk_bf16_f32 v176, v96, v97
    v_cvt_pk_bf16_f32 v177, v98, v99
    v_cvt_pk_bf16_f32 v178, v100, v101
    v_cvt_pk_bf16_f32 v179, v102, v103
    v_dot2_f32_bf16 v112, v180, v10, s13
    v_dot2_f32_bf16 v113, v180, v11, s13
    v_dot2_f32_bf16 v114, v181, v10, s13
    v_dot2_f32_bf16 v115, v181, v11, s13
    v_dot2_f32_bf16 v116, v182, v10, s13
    v_dot2_f32_bf16 v117, v182, v11, s13
    v_dot2_f32_bf16 v118, v183, v10, s13
    v_dot2_f32_bf16 v119, v183, v11, s13
    v_cvt_pk_bf16_f32 v112, 0, v112
    v_cvt_pk_bf16_f32 v113, 0, v113
    v_cvt_pk_bf16_f32 v114, 0, v114
    v_cvt_pk_bf16_f32 v115, 0, v115
    v_cvt_pk_bf16_f32 v116, 0, v116
    v_cvt_pk_bf16_f32 v117, 0, v117
    v_cvt_pk_bf16_f32 v118, 0, v118
    v_cvt_pk_bf16_f32 v119, 0, v119
    v_pk_mul_f32 v[112:113], v[112:113], s[52:53] op_sel:[0,1]
    v_pk_mul_f32 v[114:115], v[114:115], s[52:53] op_sel:[0,1]
    v_pk_mul_f32 v[116:117], v[116:117], s[52:53] op_sel:[0,1]
    v_pk_mul_f32 v[118:119], v[118:119], s[52:53] op_sel:[0,1]
    v_cvt_pk_bf16_f32 v180, v112, v113
    v_cvt_pk_bf16_f32 v181, v114, v115
    v_cvt_pk_bf16_f32 v182, v116, v117
    v_cvt_pk_bf16_f32 v183, v118, v119
    v_dot2_f32_bf16 v96, v184, v10, s14
    v_dot2_f32_bf16 v97, v184, v11, s14
    v_dot2_f32_bf16 v98, v185, v10, s14
    v_dot2_f32_bf16 v99, v185, v11, s14
    v_dot2_f32_bf16 v100, v186, v10, s14
    v_dot2_f32_bf16 v101, v186, v11, s14
    v_dot2_f32_bf16 v102, v187, v10, s14
    v_dot2_f32_bf16 v103, v187, v11, s14
    v_cvt_pk_bf16_f32 v96, 0, v96
    v_cvt_pk_bf16_f32 v97, 0, v97
    v_cvt_pk_bf16_f32 v98, 0, v98
    v_cvt_pk_bf16_f32 v99, 0, v99
    v_cvt_pk_bf16_f32 v100, 0, v100
    v_cvt_pk_bf16_f32 v101, 0, v101
    v_cvt_pk_bf16_f32 v102, 0, v102
    v_cvt_pk_bf16_f32 v103, 0, v103
    v_pk_mul_f32 v[96:97], v[96:97], s[54:55] op_sel_hi:[1,0]
    v_pk_mul_f32 v[98:99], v[98:99], s[54:55] op_sel_hi:[1,0]
    v_pk_mul_f32 v[100:101], v[100:101], s[54:55] op_sel_hi:[1,0]
    v_pk_mul_f32 v[102:103], v[102:103], s[54:55] op_sel_hi:[1,0]
    v_cvt_pk_bf16_f32 v184, v96, v97
    v_cvt_pk_bf16_f32 v185, v98, v99
    v_cvt_pk_bf16_f32 v186, v100, v101
    v_cvt_pk_bf16_f32 v187, v102, v103
    v_dot2_f32_bf16 v112, v188, v10, s15
    v_dot2_f32_bf16 v113, v188, v11, s15
    v_dot2_f32_bf16 v114, v189, v10, s15
    v_dot2_f32_bf16 v115, v189, v11, s15
    v_dot2_f32_bf16 v116, v190, v10, s15
    v_dot2_f32_bf16 v117, v190, v11, s15
    v_dot2_f32_bf16 v118, v191, v10, s15
    v_dot2_f32_bf16 v119, v191, v11, s15
    v_cvt_pk_bf16_f32 v112, 0, v112
    v_cvt_pk_bf16_f32 v113, 0, v113
    v_cvt_pk_bf16_f32 v114, 0, v114
    v_cvt_pk_bf16_f32 v115, 0, v115
    v_cvt_pk_bf16_f32 v116, 0, v116
    v_cvt_pk_bf16_f32 v117, 0, v117
    v_cvt_pk_bf16_f32 v118, 0, v118
    v_cvt_pk_bf16_f32 v119, 0, v119
    v_pk_mul_f32 v[112:113], v[112:113], s[54:55] op_sel:[0,1]
    v_pk_mul_f32 v[114:115], v[114:115], s[54:55] op_sel:[0,1]
    v_pk_mul_f32 v[116:117], v[116:117], s[54:55] op_sel:[0,1]
    v_pk_mul_f32 v[118:119], v[118:119], s[54:55] op_sel:[0,1]
    v_cvt_pk_bf16_f32 v188, v112, v113
    v_cvt_pk_bf16_f32 v189, v114, v115
    v_cvt_pk_bf16_f32 v190, v116, v117
    v_cvt_pk_bf16_f32 v191, v118, v119
    s_cmp_lt_u32 s6, 128
    s_cbranch_scc1 .Lp4_p1
    s_cmp_ge_u32 s72, 64
    s_cbranch_scc1 .Lp4_g2_
    buffer_load_dwordx2 v[244:245], v7, s[76:79], s59 offen sc1
.Lp4_g2_:
    buffer_load_dwordx4 v[236:239], v12, s[76:79], s57 offen sc1
    buffer_load_dwordx4 v[240:243], v12, s[76:79], s58 offen sc1
    s_add_u32 m0, s43, 32768
    s_nop 0
    buffer_load_dwordx4 v26, s[16:19], s44 offen  lds
    s_add_u32 s44, s44, 65536
    s_add_u32 m0, s43, 33792
    s_nop 0
    buffer_load_dwordx4 v26, s[16:19], s44 offen  lds
    s_add_u32 s44, s44, 65536
    s_add_u32 m0, s43, 49152
    s_nop 0
    buffer_load_dwordx4 v26, s[16:19], s44 offen  lds
    s_add_u32 s44, s44, 65536
    s_add_u32 m0, s43, 50176
    s_nop 0
    buffer_load_dwordx4 v26, s[16:19], s44 offen  lds
    s_add_u32 s44, s44, 65536
.Lp4_p1:
    s_waitcnt vmcnt(4)
.Lp4_ng1:
    ds_read_b64 v[2:3], v58
    s_waitcnt lgkmcnt(0)
    v_readfirstlane_b32 s100, v2
    v_readfirstlane_b32 s101, v3
    s_cmp_eq_u32 s100, 0
    s_cbranch_scc1 .Lp4_ng1
    s_cmp_ge_u32 s72, 64
    s_cbranch_scc1 .Lp4_gd
    s_mov_b32 s4, 0
.Lp4_gl:
    v_cmp_ne_u32 vcc, s100, v245
    s_add_u32 s4, s4, 1
    s_cbranch_vccz .Lp4_gd
    s_cmp_ge_u32 s4, 6
    s_cbranch_scc1 .Lp4_gf
    buffer_load_dwordx2 v[244:245], v7, s[76:79], s59 offen sc1
    s_waitcnt vmcnt(0)
    s_branch .Lp4_gl
.Lp4_gf:
    s_lshr_b32 s5, s72, 5
    s_bfe_u32 s6, s72, 0x40001
    s_lshl_b32 s7, s6, 7
    s_load_dwordx4 s[48:51], s[0:1], 80
    v_and_b32 v2, 7, v1
    v_lshrrev_b32 v3, 3, v1
    v_mul_u32_u24 v60, 49152, v3
    v_lshl_add_u32 v60, v2, 4, v60
    v_lshlrev_b32 v61, 4, v3
    v_lshl_add_u32 v2, v2, 3, v3
    v_mov_b32 v112, 0
    v_mov_b32 v113, 0
    v_mov_b32 v114, 0
    v_mov_b32 v115, 0
    v_mov_b32 v116, 0
    v_mov_b32 v117, 0
    v_mov_b32 v118, 0
    v_mov_b32 v119, 0
    s_waitcnt lgkmcnt(0)
    s_mov_b32 s80, s48
    s_mov_b32 s81, s49
    s_mov_b32 s82, 0x400
    s_mov_b32 s83, 0x00020000
    s_mov_b32 s84, s50
    s_mov_b32 s85, s51
    s_mov_b32 s86, 0x300000
    s_mov_b32 s87, 0x00020000
    s_mul_i32 s48, s5, 1572864
    s_add_u32 s48, s48, s7
    s_lshl_b32 s49, s5, 9
    s_mov_b32 s50, 4
.Lp4s_c:
    buffer_load_dwordx4 v[224:227], v61, s[80:83], s49 offen
    buffer_load_dwordx4 v[128:131], v60, s[84:87], s48 offen
    s_add_u32 s48, s48, 6144
    buffer_load_dwordx4 v[132:135], v60, s[84:87], s48 offen
    s_add_u32 s48, s48, 6144
    buffer_load_dwordx4 v[136:139], v60, s[84:87], s48 offen
    s_add_u32 s48, s48, 6144
    buffer_load_dwordx4 v[140:143], v60, s[84:87], s48 offen
    s_add_u32 s48, s48, 6144
    buffer_load_dwordx4 v[144:147], v60, s[84:87], s48 offen
    s_add_u32 s48, s48, 6144
    buffer_load_dwordx4 v[148:151], v60, s[84:87], s48 offen
    s_add_u32 s48, s48, 6144
    buffer_load_dwordx4 v[152:155], v60, s[84:87], s48 offen
    s_add_u32 s48, s48, 6144
    buffer_load_dwordx4 v[156:159], v60, s[84:87], s48 offen
    s_add_u32 s48, s48, 350208
    s_add_u32 s49, s49, 128
    s_waitcnt vmcnt(8)
    v_lshlrev_b32 v64, 16, v224
    v_and_b32 v65, s45, v224
    v_lshlrev_b32 v66, 16, v225
    v_and_b32 v67, s45, v225
    v_lshlrev_b32 v68, 16, v226
    v_and_b32 v69, s45, v226
    v_lshlrev_b32 v70, 16, v227
    v_and_b32 v71, s45, v227
    v_mul_f32 v72, 0xbfb8aa3b, v64
    v_mul_f32 v73, 0xbfb8aa3b, v65
    v_mul_f32 v74, 0xbfb8aa3b, v66
    v_mul_f32 v75, 0xbfb8aa3b, v67
    v_mul_f32 v76, 0xbfb8aa3b, v68
    v_mul_f32 v77, 0xbfb8aa3b, v69
    v_mul_f32 v78, 0xbfb8aa3b, v70
    v_mul_f32 v79, 0xbfb8aa3b, v71
    v_exp_f32 v72, v72
    v_exp_f32 v73, v73
    v_exp_f32 v74, v74
    v_exp_f32 v75, v75
    v_exp_f32 v76, v76
    v_exp_f32 v77, v77
    v_exp_f32 v78, v78
    v_exp_f32 v79, v79
    s_nop 0
    v_add_f32 v72, 1.0, v72
    v_add_f32 v73, 1.0, v73
    v_add_f32 v74, 1.0, v74
    v_add_f32 v75, 1.0, v75
    v_add_f32 v76, 1.0, v76
    v_add_f32 v77, 1.0, v77
    v_add_f32 v78, 1.0, v78
    v_add_f32 v79, 1.0, v79
    v_rcp_f32 v80, v72
    v_rcp_f32 v81, v73
    v_rcp_f32 v82, v74
    v_rcp_f32 v83, v75
    v_rcp_f32 v84, v76
    v_rcp_f32 v85, v77
    v_rcp_f32 v86, v78
    v_rcp_f32 v87, v79
    s_nop 0
    v_mul_f32 v88, v64, v80
    v_mul_f32 v89, v65, v81
    v_mul_f32 v90, v66, v82
    v_mul_f32 v91, v67, v83
    v_mul_f32 v92, v68, v84
    v_mul_f32 v93, v69, v85
    v_mul_f32 v94, v70, v86
    v_mul_f32 v95, v71, v87
    v_fma_f32 v72, -v88, v72, v64
    v_fma_f32 v73, -v89, v73, v65
    v_fma_f32 v74, -v90, v74, v66
    v_fma_f32 v75, -v91, v75, v67
    v_fma_f32 v76, -v92, v76, v68
    v_fma_f32 v77, -v93, v77, v69
    v_fma_f32 v78, -v94, v78, v70
    v_fma_f32 v79, -v95, v79, v71
    v_fma_f32 v64, v72, v80, v88
    v_fma_f32 v65, v73, v81, v89
    v_fma_f32 v66, v74, v82, v90
    v_fma_f32 v67, v75, v83, v91
    v_fma_f32 v68, v76, v84, v92
    v_fma_f32 v69, v77, v85, v93
    v_fma_f32 v70, v78, v86, v94
    v_fma_f32 v71, v79, v87, v95
    v_cvt_pk_bf16_f32 v72, v64, v65
    v_cvt_pk_bf16_f32 v73, v66, v67
    v_cvt_pk_bf16_f32 v74, v68, v69
    v_cvt_pk_bf16_f32 v75, v70, v71
    v_and_b32 v96, 0xffff, v72
    v_lshlrev_b32 v97, 16, v72
    v_lshrrev_b32 v98, 16, v72
    v_and_b32 v99, s45, v72
    v_and_b32 v100, 0xffff, v73
    v_lshlrev_b32 v101, 16, v73
    v_lshrrev_b32 v102, 16, v73
    v_and_b32 v103, s45, v73
    v_and_b32 v104, 0xffff, v74
    v_lshlrev_b32 v105, 16, v74
    v_lshrrev_b32 v106, 16, v74
    v_and_b32 v107, s45, v74
    v_and_b32 v108, 0xffff, v75
    v_lshlrev_b32 v109, 16, v75
    v_lshrrev_b32 v110, 16, v75
    v_and_b32 v111, s45, v75
    s_waitcnt vmcnt(0)
    v_dot2_f32_bf16 v112, v128, v96, v112
    v_dot2_f32_bf16 v113, v128, v97, v113
    v_dot2_f32_bf16 v114, v129, v96, v114
    v_dot2_f32_bf16 v115, v129, v97, v115
    v_dot2_f32_bf16 v116, v130, v96, v116
    v_dot2_f32_bf16 v117, v130, v97, v117
    v_dot2_f32_bf16 v118, v131, v96, v118
    v_dot2_f32_bf16 v119, v131, v97, v119
    v_dot2_f32_bf16 v112, v132, v98, v112
    v_dot2_f32_bf16 v113, v132, v99, v113
    v_dot2_f32_bf16 v114, v133, v98, v114
    v_dot2_f32_bf16 v115, v133, v99, v115
    v_dot2_f32_bf16 v116, v134, v98, v116
    v_dot2_f32_bf16 v117, v134, v99, v117
    v_dot2_f32_bf16 v118, v135, v98, v118
    v_dot2_f32_bf16 v119, v135, v99, v119
    v_dot2_f32_bf16 v112, v136, v100, v112
    v_dot2_f32_bf16 v113, v136, v101, v113
    v_dot2_f32_bf16 v114, v137, v100, v114
    v_dot2_f32_bf16 v115, v137, v101, v115
    v_dot2_f32_bf16 v116, v138, v100, v116
    v_dot2_f32_bf16 v117, v138, v101, v117
    v_dot2_f32_bf16 v118, v139, v100, v118
    v_dot2_f32_bf16 v119, v139, v101, v119
    v_dot2_f32_bf16 v112, v140, v102, v112
    v_dot2_f32_bf16 v113, v140, v103, v113
    v_dot2_f32_bf16 v114, v141, v102, v114
    v_dot2_f32_bf16 v115, v141, v103, v115
    v_dot2_f32_bf16 v116, v142, v102, v116
    v_dot2_f32_bf16 v117, v142, v103, v117
    v_dot2_f32_bf16 v118, v143, v102, v118
    v_dot2_f32_bf16 v119, v143, v103, v119
    v_dot2_f32_bf16 v112, v144, v104, v112
    v_dot2_f32_bf16 v113, v144, v105, v113
    v_dot2_f32_bf16 v114, v145, v104, v114
    v_dot2_f32_bf16 v115, v145, v105, v115
    v_dot2_f32_bf16 v116, v146, v104, v116
    v_dot2_f32_bf16 v117, v146, v105, v117
    v_dot2_f32_bf16 v118, v147, v104, v118
    v_dot2_f32_bf16 v119, v147, v105, v119
    v_dot2_f32_bf16 v112, v148, v106, v112
    v_dot2_f32_bf16 v113, v148, v107, v113
    v_dot2_f32_bf16 v114, v149, v106, v114
    v_dot2_f32_bf16 v115, v149, v107, v115
    v_dot2_f32_bf16 v116, v150, v106, v116
    v_dot2_f32_bf16 v117, v150, v107, v117
    v_dot2_f32_bf16 v118, v151, v106, v118
    v_dot2_f32_bf16 v119, v151, v107, v119
    v_dot2_f32_bf16 v112, v152, v108, v112
    v_dot2_f32_bf16 v113, v152, v109, v113
    v_dot2_f32_bf16 v114, v153, v108, v114
    v_dot2_f32_bf16 v115, v153, v109, v115
    v_dot2_f32_bf16 v116, v154, v108, v116
    v_dot2_f32_bf16 v117, v154, v109, v117
    v_dot2_f32_bf16 v118, v155, v108, v118
    v_dot2_f32_bf16 v119, v155, v109, v119
    v_dot2_f32_bf16 v112, v156, v110, v112
    v_dot2_f32_bf16 v113, v156, v111, v113
    v_dot2_f32_bf16 v114, v157, v110, v114
    v_dot2_f32_bf16 v115, v157, v111, v115
    v_dot2_f32_bf16 v116, v158, v110, v116
    v_dot2_f32_bf16 v117, v158, v111, v117
    v_dot2_f32_bf16 v118, v159, v110, v118
    v_dot2_f32_bf16 v119, v159, v111, v119
    s_sub_u32 s50, s50, 1
    s_cmp_lg_u32 s50, 0
    s_cbranch_scc1 .Lp4s_c
    v_permlane32_swap_b32 v112, v116
    v_permlane32_swap_b32 v113, v117
    v_permlane32_swap_b32 v114, v118
    v_permlane32_swap_b32 v115, v119
    s_nop 0
    v_add_f32 v112, v112, v116
    v_add_f32 v113, v113, v117
    v_add_f32 v114, v114, v118
    v_add_f32 v115, v115, v119
    s_nop 1
    v_permlane16_swap_b32 v112, v114
    v_permlane16_swap_b32 v113, v115
    s_nop 1
    v_add_f32 v112, v112, v114
    v_add_f32 v113, v113, v115
    s_nop 1
    v_add_f32_dpp v114, v112, v112 row_ror:8 row_mask:0xf bank_mask:0x3
    v_add_f32_dpp v114, v113, v113 row_ror:8 row_mask:0xf bank_mask:0xc
    s_lshl_b32 s5, s5, 13
    s_lshl_b32 s6, s6, 9
    s_add_u32 s5, s5, s6
    v_lshlrev_b32 v2, 3, v2
    v_mov_b32 v115, s100
    buffer_store_dwordx2 v[114:115], v2, s[76:79], s5 offen sc1
    s_add_u32 s5, s5, 16384
    buffer_store_dwordx2 v[114:115], v2, s[76:79], s5 offen sc1
    s_add_u32 s5, s5, 16384
    buffer_store_dwordx2 v[114:115], v2, s[76:79], s5 offen sc1
    s_add_u32 s5, s5, 16384
    buffer_store_dwordx2 v[114:115], v2, s[76:79], s5 offen sc1
    s_add_u32 s5, s5, 16384
    buffer_store_dwordx2 v[114:115], v2, s[76:79], s5 offen sc1
    s_add_u32 s5, s5, 16384
    buffer_store_dwordx2 v[114:115], v2, s[76:79], s5 offen sc1
    s_add_u32 s5, s5, 16384
    buffer_store_dwordx2 v[114:115], v2, s[76:79], s5 offen sc1
    s_add_u32 s5, s5, 16384
    buffer_store_dwordx2 v[114:115], v2, s[76:79], s5 offen sc1
.Lp4_gd:
    s_mov_b32 s4, 0
    s_cmp_ge_u32 s40, 4
    s_cselect_b32 s71, 1.0, 0
    s_cselect_b32 s7, 0, 16
    s_lshl_b32 s6, s40, 9
    s_add_u32 s6, s6, 86016
    v_lshlrev_b32 v6, 3, v1
    v_add_u32 v6, s6, v6
.Lp4_chk:
    v_xor_b32 v2, s100, v237
    v_xor_b32 v3, s100, v239
    v_xor_b32 v4, s100, v241
    v_xor_b32 v5, s100, v243
    v_or_b32 v2, v2, v3
    v_or_b32 v4, v4, v5
    v_cmp_ne_u32 s[12:13], 0, v2
    v_cmp_ne_u32 vcc, 0, v4
    s_add_u32 s4, s4, 1
    s_or_b64 s[14:15], s[12:13], vcc
    s_cbranch_scc0 .Lp4_ok
    s_cmp_lt_u32 s4, 0x40000
    s_cbranch_scc0 .Lp4_ok
    s_mov_b64 exec, s[12:13]
    buffer_load_dwordx4 v[236:239], v12, s[76:79], s57 offen sc1
    s_mov_b64 exec, vcc
    buffer_load_dwordx4 v[240:243], v12, s[76:79], s58 offen sc1
    s_mov_b64 exec, -1
    s_waitcnt vmcnt(0)
    s_branch .Lp4_chk
.Lp4_ok:
    v_add_f32 v236, v236, v240
    v_add_f32 v238, v238, v242
    v_cvt_pk_bf16_f32 v236, 0, v236
    v_cvt_pk_bf16_f32 v238, 0, v238
    v_add_f32 v236, s71, v236
    v_add_f32 v238, s71, v238
    v_cvt_pk_bf16_f32 v2, v236, v238
    v_and_b32 v236, 0xffff, v2
    v_and_b32 v237, s45, v2
    v_lshlrev_b32 v236, s7, v236
    ds_write_b64 v6, v[236:237]
    v_and_b32 v4, 255, v0
    v_lshrrev_b32 v2, 4, v4
    v_and_b32 v3, 15, v4
    v_lshlrev_b32 v3, 6, v3
    v_lshl_add_u32 v2, v2, 13, v3
    s_add_u32 s36, s70, 64
    s_cmp_lt_u32 s70, 128
    s_cselect_b32 s36, 256, s36
    s_cmp_lt_u32 s70, 192
    s_cselect_b32 s37, s70, 256
    s_cmp_lt_u32 s40, 4
    s_cselect_b32 s36, s36, s37
    s_cmp_ge_u32 s36, 256
    s_cbranch_scc1 .Lp4_wq
    s_and_b32 s37, s36, 7
    s_lshr_b32 s36, s36, 3
    s_lshl_b32 s36, s36, 17
    s_lshl_b32 s37, s37, 10
    s_add_u32 s36, s36, s37
    buffer_load_dword v63, v2, s[16:19], s36 offen
.Lp4_wq:
    s_waitcnt lgkmcnt(0)
    s_barrier
    v_add_u32 v2, 86016, v13
    ds_read_b128 v[200:203], v2 offset:2048
    ds_read_b128 v[204:207], v2 offset:2064
    ds_read_b128 v[192:195], v2
    ds_read_b128 v[196:199], v2 offset:16
    s_waitcnt lgkmcnt(0)
    v_dot2_f32_bf16 v64, v160, v200, 0
    v_dot2_f32_bf16 v65, v160, v201, 0
    v_dot2_f32_bf16 v66, v161, v202, 0
    v_dot2_f32_bf16 v67, v161, v203, 0
    v_dot2_f32_bf16 v68, v162, v204, 0
    v_dot2_f32_bf16 v69, v162, v205, 0
    v_dot2_f32_bf16 v70, v163, v206, 0
    v_dot2_f32_bf16 v71, v163, v207, 0
    v_cvt_pk_bf16_f32 v160, v64, v65
    v_cvt_pk_bf16_f32 v161, v66, v67
    v_cvt_pk_bf16_f32 v162, v68, v69
    v_cvt_pk_bf16_f32 v163, v70, v71
    v_dot2_f32_bf16 v72, v160, v10, v192
    v_dot2_f32_bf16 v73, v160, v11, v193
    v_dot2_f32_bf16 v74, v161, v10, v194
    v_dot2_f32_bf16 v75, v161, v11, v195
    v_dot2_f32_bf16 v76, v162, v10, v196
    v_dot2_f32_bf16 v77, v162, v11, v197
    v_dot2_f32_bf16 v78, v163, v10, v198
    v_dot2_f32_bf16 v79, v163, v11, v199
    v_cvt_pk_bf16_f32 v160, v72, v73
    v_cvt_pk_bf16_f32 v161, v74, v75
    v_cvt_pk_bf16_f32 v162, v76, v77
    v_cvt_pk_bf16_f32 v163, v78, v79
    ds_write_b128 v50, v[160:163]
    s_add_u32 m0, s43, 65536
    s_nop 0
    buffer_load_dwordx4 v26, s[16:19], s44 offen  lds
    s_add_u32 s44, s44, 65536
    s_add_u32 m0, s43, 66560
    s_nop 0
    buffer_load_dwordx4 v26, s[16:19], s44 offen  lds
    s_add_u32 s44, s44, 65536
    v_dot2_f32_bf16 v80, v164, v200, 0
    v_dot2_f32_bf16 v81, v164, v201, 0
    v_dot2_f32_bf16 v82, v165, v202, 0
    v_dot2_f32_bf16 v83, v165, v203, 0
    v_dot2_f32_bf16 v84, v166, v204, 0
    v_dot2_f32_bf16 v85, v166, v205, 0
    v_dot2_f32_bf16 v86, v167, v206, 0
    v_dot2_f32_bf16 v87, v167, v207, 0
    v_cvt_pk_bf16_f32 v164, v80, v81
    v_cvt_pk_bf16_f32 v165, v82, v83
    v_cvt_pk_bf16_f32 v166, v84, v85
    v_cvt_pk_bf16_f32 v167, v86, v87
    v_dot2_f32_bf16 v88, v164, v10, v192
    v_dot2_f32_bf16 v89, v164, v11, v193
    v_dot2_f32_bf16 v90, v165, v10, v194
    v_dot2_f32_bf16 v91, v165, v11, v195
    v_dot2_f32_bf16 v92, v166, v10, v196
    v_dot2_f32_bf16 v93, v166, v11, v197
    v_dot2_f32_bf16 v94, v167, v10, v198
    v_dot2_f32_bf16 v95, v167, v11, v199
    v_cvt_pk_bf16_f32 v164, v88, v89
    v_cvt_pk_bf16_f32 v165, v90, v91
    v_cvt_pk_bf16_f32 v166, v92, v93
    v_cvt_pk_bf16_f32 v167, v94, v95
    ds_write_b128 v51, v[164:167]
    s_add_u32 m0, s43, 81920
    s_nop 0
    buffer_load_dwordx4 v26, s[16:19], s44 offen  lds
    s_add_u32 s44, s44, 65536
    s_add_u32 m0, s43, 82944
    s_nop 0
    buffer_load_dwordx4 v26, s[16:19], s44 offen  lds
    s_add_u32 s44, s44, 65536
    v_dot2_f32_bf16 v64, v168, v200, 0
    v_dot2_f32_bf16 v65, v168, v201, 0
    v_dot2_f32_bf16 v66, v169, v202, 0
    v_dot2_f32_bf16 v67, v169, v203, 0
    v_dot2_f32_bf16 v68, v170, v204, 0
    v_dot2_f32_bf16 v69, v170, v205, 0
    v_dot2_f32_bf16 v70, v171, v206, 0
    v_dot2_f32_bf16 v71, v171, v207, 0
    v_cvt_pk_bf16_f32 v168, v64, v65
    v_cvt_pk_bf16_f32 v169, v66, v67
    v_cvt_pk_bf16_f32 v170, v68, v69
    v_cvt_pk_bf16_f32 v171, v70, v71
    v_dot2_f32_bf16 v72, v168, v10, v192
    v_dot2_f32_bf16 v73, v168, v11, v193
    v_dot2_f32_bf16 v74, v169, v10, v194
    v_dot2_f32_bf16 v75, v169, v11, v195
    v_dot2_f32_bf16 v76, v170, v10, v196
    v_dot2_f32_bf16 v77, v170, v11, v197
    v_dot2_f32_bf16 v78, v171, v10, v198
    v_dot2_f32_bf16 v79, v171, v11, v199
    v_cvt_pk_bf16_f32 v168, v72, v73
    v_cvt_pk_bf16_f32 v169, v74, v75
    v_cvt_pk_bf16_f32 v170, v76, v77
    v_cvt_pk_bf16_f32 v171, v78, v79
    ds_write_b128 v52, v[168:171]
    s_add_u32 m0, s43, 0
    s_nop 0
    buffer_load_dwordx4 v26, s[16:19], s44 offen  lds
    s_add_u32 s44, s44, 65536
    s_add_u32 m0, s43, 1024
    s_nop 0
    buffer_load_dwordx4 v26, s[16:19], s44 offen  lds
    s_add_u32 s44, s44, 65536
    v_dot2_f32_bf16 v80, v172, v200, 0
    v_dot2_f32_bf16 v81, v172, v201, 0
    v_dot2_f32_bf16 v82, v173, v202, 0
    v_dot2_f32_bf16 v83, v173, v203, 0
    v_dot2_f32_bf16 v84, v174, v204, 0
    v_dot2_f32_bf16 v85, v174, v205, 0
    v_dot2_f32_bf16 v86, v175, v206, 0
    v_dot2_f32_bf16 v87, v175, v207, 0
    v_cvt_pk_bf16_f32 v172, v80, v81
    v_cvt_pk_bf16_f32 v173, v82, v83
    v_cvt_pk_bf16_f32 v174, v84, v85
    v_cvt_pk_bf16_f32 v175, v86, v87
    v_dot2_f32_bf16 v88, v172, v10, v192
    v_dot2_f32_bf16 v89, v172, v11, v193
    v_dot2_f32_bf16 v90, v173, v10, v194
    v_dot2_f32_bf16 v91, v173, v11, v195
    v_dot2_f32_bf16 v92, v174, v10, v196
    v_dot2_f32_bf16 v93, v174, v11, v197
    v_dot2_f32_bf16 v94, v175, v10, v198
    v_dot2_f32_bf16 v95, v175, v11, v199
    v_cvt_pk_bf16_f32 v172, v88, v89
    v_cvt_pk_bf16_f32 v173, v90, v91
    v_cvt_pk_bf16_f32 v174, v92, v93
    v_cvt_pk_bf16_f32 v175, v94, v95
    ds_write_b128 v53, v[172:175]
    v_dot2_f32_bf16 v64, v176, v200, 0
    v_dot2_f32_bf16 v65, v176, v201, 0
    v_dot2_f32_bf16 v66, v177, v202, 0
    v_dot2_f32_bf16 v67, v177, v203, 0
    v_dot2_f32_bf16 v68, v178, v204, 0
    v_dot2_f32_bf16 v69, v178, v205, 0
    v_dot2_f32_bf16 v70, v179, v206, 0
    v_dot2_f32_bf16 v71, v179, v207, 0
    v_cvt_pk_bf16_f32 v176, v64, v65
    v_cvt_pk_bf16_f32 v177, v66, v67
    v_cvt_pk_bf16_f32 v178, v68, v69
    v_cvt_pk_bf16_f32 v179, v70, v71
    v_dot2_f32_bf16 v72, v176, v10, v192
    v_dot2_f32_bf16 v73, v176, v11, v193
    v_dot2_f32_bf16 v74, v177, v10, v194
    v_dot2_f32_bf16 v75, v177, v11, v195
    v_dot2_f32_bf16 v76, v178, v10, v196
    v_dot2_f32_bf16 v77, v178, v11, v197
    v_dot2_f32_bf16 v78, v179, v10, v198
    v_dot2_f32_bf16 v79, v179, v11, v199
    v_cvt_pk_bf16_f32 v176, v72, v73
    v_cvt_pk_bf16_f32 v177, v74, v75
    v_cvt_pk_bf16_f32 v178, v76, v77
    v_cvt_pk_bf16_f32 v179, v78, v79
    ds_write_b128 v54, v[176:179]
    v_dot2_f32_bf16 v80, v180, v200, 0
    v_dot2_f32_bf16 v81, v180, v201, 0
    v_dot2_f32_bf16 v82, v181, v202, 0
    v_dot2_f32_bf16 v83, v181, v203, 0
    v_dot2_f32_bf16 v84, v182, v204, 0
    v_dot2_f32_bf16 v85, v182, v205, 0
    v_dot2_f32_bf16 v86, v183, v206, 0
    v_dot2_f32_bf16 v87, v183, v207, 0
    v_cvt_pk_bf16_f32 v180, v80, v81
    v_cvt_pk_bf16_f32 v181, v82, v83
    v_cvt_pk_bf16_f32 v182, v84, v85
    v_cvt_pk_bf16_f32 v183, v86, v87
    v_dot2_f32_bf16 v88, v180, v10, v192
    v_dot2_f32_bf16 v89, v180, v11, v193
    v_dot2_f32_bf16 v90, v181, v10, v194
    v_dot2_f32_bf16 v91, v181, v11, v195
    v_dot2_f32_bf16 v92, v182, v10, v196
    v_dot2_f32_bf16 v93, v182, v11, v197
    v_dot2_f32_bf16 v94, v183, v10, v198
    v_dot2_f32_bf16 v95, v183, v11, v199
    v_cvt_pk_bf16_f32 v180, v88, v89
    v_cvt_pk_bf16_f32 v181, v90, v91
    v_cvt_pk_bf16_f32 v182, v92, v93
    v_cvt_pk_bf16_f32 v183, v94, v95
    ds_write_b128 v55, v[180:183]
    v_dot2_f32_bf16 v64, v184, v200, 0
    v_dot2_f32_bf16 v65, v184, v201, 0
    v_dot2_f32_bf16 v66, v185, v202, 0
    v_dot2_f32_bf16 v67, v185, v203, 0
    v_dot2_f32_bf16 v68, v186, v204, 0
    v_dot2_f32_bf16 v69, v186, v205, 0
    v_dot2_f32_bf16 v70, v187, v206, 0
    v_dot2_f32_bf16 v71, v187, v207, 0
    v_cvt_pk_bf16_f32 v184, v64, v65
    v_cvt_pk_bf16_f32 v185, v66, v67
    v_cvt_pk_bf16_f32 v186, v68, v69
    v_cvt_pk_bf16_f32 v187, v70, v71
    v_dot2_f32_bf16 v72, v184, v10, v192
    v_dot2_f32_bf16 v73, v184, v11, v193
    v_dot2_f32_bf16 v74, v185, v10, v194
    v_dot2_f32_bf16 v75, v185, v11, v195
    v_dot2_f32_bf16 v76, v186, v10, v196
    v_dot2_f32_bf16 v77, v186, v11, v197
    v_dot2_f32_bf16 v78, v187, v10, v198
    v_dot2_f32_bf16 v79, v187, v11, v199
    v_cvt_pk_bf16_f32 v184, v72, v73
    v_cvt_pk_bf16_f32 v185, v74, v75
    v_cvt_pk_bf16_f32 v186, v76, v77
    v_cvt_pk_bf16_f32 v187, v78, v79
    ds_write_b128 v56, v[184:187]
    v_dot2_f32_bf16 v80, v188, v200, 0
    v_dot2_f32_bf16 v81, v188, v201, 0
    v_dot2_f32_bf16 v82, v189, v202, 0
    v_dot2_f32_bf16 v83, v189, v203, 0
    v_dot2_f32_bf16 v84, v190, v204, 0
    v_dot2_f32_bf16 v85, v190, v205, 0
    v_dot2_f32_bf16 v86, v191, v206, 0
    v_dot2_f32_bf16 v87, v191, v207, 0
    v_cvt_pk_bf16_f32 v188, v80, v81
    v_cvt_pk_bf16_f32 v189, v82, v83
    v_cvt_pk_bf16_f32 v190, v84, v85
    v_cvt_pk_bf16_f32 v191, v86, v87
    v_dot2_f32_bf16 v88, v188, v10, v192
    v_dot2_f32_bf16 v89, v188, v11, v193
    v_dot2_f32_bf16 v90, v189, v10, v194
    v_dot2_f32_bf16 v91, v189, v11, v195
    v_dot2_f32_bf16 v92, v190, v10, v196
    v_dot2_f32_bf16 v93, v190, v11, v197
    v_dot2_f32_bf16 v94, v191, v10, v198
    v_dot2_f32_bf16 v95, v191, v11, v199
    v_cvt_pk_bf16_f32 v188, v88, v89
    v_cvt_pk_bf16_f32 v189, v90, v91
    v_cvt_pk_bf16_f32 v190, v92, v93
    v_cvt_pk_bf16_f32 v191, v94, v95
    ds_write_b128 v57, v[188:191]
    v_lshlrev_b32 v5, 7, v1
    s_lshl_b32 s56, s42, 12
    s_add_u32 s57, s56, 4096
    s_cmp_lg_u32 s40, 4
    s_cbranch_scc1 .Lk1_nkv
    s_mov_b32 exec_hi, 0
    buffer_load_dword v15, v5, s[20:23], s56 offen
    buffer_load_dword v15, v5, s[24:27], s56 offen
    s_mov_b64 exec, -1
.Lk1_nkv:
    s_mov_b32 s4, s73
    s_cmp_ge_u32 s4, 120
    s_cbranch_scc1 .Lp2c_end
    v_mov_b32 v70, s100
    v_mov_b32 v71, s101
    s_waitcnt vmcnt(0)
    s_add_u32 s76, s68, 0x1a30000
    s_addc_u32 s77, s69, 0
    s_mov_b32 s78, 0x8000
    s_mov_b32 s79, 0x00020000
    v_lshlrev_b32 v3, 10, v1
    s_mov_b32 s4, s73
    s_lshl_b32 s4, s4, 3
    s_mov_b32 exec_hi, 0
    buffer_store_dwordx2 v[70:71], v3, s[76:79], s4 offen sc1
    s_mov_b64 exec, -1
.Lp2c_end:
    s_waitcnt lgkmcnt(0)
    s_barrier
    s_add_u32 m0, s43, 16384
    s_nop 0
    buffer_load_dwordx4 v26, s[16:19], s44 offen  lds
    s_add_u32 s44, s44, 65536
    s_add_u32 m0, s43, 17408
    s_nop 0
    buffer_load_dwordx4 v26, s[16:19], s44 offen  lds
    s_add_u32 s44, s44, 65536
    s_waitcnt vmcnt(10)
    ds_read_b64_tr_b16 v[128:129], v24 offset:32768
    ds_read_b64_tr_b16 v[130:131], v24 offset:33280
    ds_read_b64_tr_b16 v[132:133], v25 offset:32768
    ds_read_b64_tr_b16 v[134:135], v25 offset:33280
    ds_read_b128 v[136:139], v16 offset:0
    ds_read_b128 v[140:143], v16 offset:32768
    s_waitcnt vmcnt(8)
    ds_read_b64_tr_b16 v[144:145], v24 offset:49152
    ds_read_b64_tr_b16 v[146:147], v24 offset:49664
    ds_read_b64_tr_b16 v[148:149], v25 offset:49152
    ds_read_b64_tr_b16 v[150:151], v25 offset:49664
    ds_read_b128 v[152:155], v17 offset:0
    ds_read_b128 v[156:159], v17 offset:32768
    s_waitcnt lgkmcnt(6)
    s_add_u32 m0, s43, 32768
    s_nop 0
    buffer_load_dwordx4 v26, s[16:19], s44 offen  lds
    s_add_u32 s44, s44, 65536
    s_add_u32 m0, s43, 33792
    s_nop 0
    buffer_load_dwordx4 v26, s[16:19], s44 offen  lds
    s_add_u32 s44, s44, 65536
    v_mfma_f32_32x32x16_bf16 v[64:79], v[128:131], v[136:139], 0
    v_mfma_f32_32x32x16_bf16 v[80:95], v[128:131], v[140:143], 0
    v_mfma_f32_32x32x16_bf16 v[96:111], v[132:135], v[136:139], 0
    v_mfma_f32_32x32x16_bf16 v[112:127], v[132:135], v[140:143], 0
    s_waitcnt vmcnt(8)
    ds_read_b64_tr_b16 v[128:129], v43 offset:0
    ds_read_b64_tr_b16 v[130:131], v43 offset:512
    ds_read_b64_tr_b16 v[132:133], v45 offset:0
    ds_read_b64_tr_b16 v[134:135], v45 offset:512
    ds_read_b128 v[136:139], v18 offset:0
    ds_read_b128 v[140:143], v18 offset:32768
    s_waitcnt lgkmcnt(6)
    s_add_u32 m0, s43, 49152
    s_nop 0
    buffer_load_dwordx4 v26, s[16:19], s44 offen  lds
    s_add_u32 s44, s44, 65536
    s_add_u32 m0, s43, 50176
    s_nop 0
    buffer_load_dwordx4 v26, s[16:19], s44 offen  lds
    s_add_u32 s44, s44, 65536
    v_mfma_f32_32x32x16_bf16 v[64:79], v[144:147], v[152:155], v[64:79]
    v_mfma_f32_32x32x16_bf16 v[80:95], v[144:147], v[156:159], v[80:95]
    v_mfma_f32_32x32x16_bf16 v[96:111], v[148:151], v[152:155], v[96:111]
    v_mfma_f32_32x32x16_bf16 v[112:127], v[148:151], v[156:159], v[112:127]
    s_waitcnt vmcnt(8)
    ds_read_b64_tr_b16 v[144:145], v43 offset:16384
    ds_read_b64_tr_b16 v[146:147], v43 offset:16896
    ds_read_b64_tr_b16 v[148:149], v45 offset:16384
    ds_read_b64_tr_b16 v[150:151], v45 offset:16896
    ds_read_b128 v[152:155], v19 offset:0
    ds_read_b128 v[156:159], v19 offset:32768
    s_waitcnt lgkmcnt(6)
    s_add_u32 m0, s43, 65536
    s_nop 0
    buffer_load_dwordx4 v26, s[16:19], s44 offen  lds
    s_add_u32 s44, s44, 65536
    s_add_u32 m0, s43, 66560
    s_nop 0
    buffer_load_dwordx4 v26, s[16:19], s44 offen  lds
    s_add_u32 s44, s44, 65536
    v_mfma_f32_32x32x16_bf16 v[64:79], v[128:131], v[136:139], v[64:79]
    v_mfma_f32_32x32x16_bf16 v[80:95], v[128:131], v[140:143], v[80:95]
    v_mfma_f32_32x32x16_bf16 v[96:111], v[132:135], v[136:139], v[96:111]
    v_mfma_f32_32x32x16_bf16 v[112:127], v[132:135], v[140:143], v[112:127]
    s_waitcnt vmcnt(8)
    ds_read_b64_tr_b16 v[128:129], v24 offset:0
    ds_read_b64_tr_b16 v[130:131], v24 offset:512
    ds_read_b64_tr_b16 v[132:133], v25 offset:0
    ds_read_b64_tr_b16 v[134:135], v25 offset:512
    ds_read_b128 v[136:139], v20 offset:0
    ds_read_b128 v[140:143], v20 offset:32768
    s_waitcnt lgkmcnt(6)
    s_add_u32 m0, s43, 81920
    s_nop 0
    buffer_load_dwordx4 v26, s[16:19], s44 offen  lds
    s_add_u32 s44, s44, 65536
    s_add_u32 m0, s43, 82944
    s_nop 0
    buffer_load_dwordx4 v26, s[16:19], s44 offen  lds
    s_add_u32 s44, s44, 65536
    v_mfma_f32_32x32x16_bf16 v[64:79], v[144:147], v[152:155], v[64:79]
    v_mfma_f32_32x32x16_bf16 v[80:95], v[144:147], v[156:159], v[80:95]
    v_mfma_f32_32x32x16_bf16 v[96:111], v[148:151], v[152:155], v[96:111]
    v_mfma_f32_32x32x16_bf16 v[112:127], v[148:151], v[156:159], v[112:127]
    s_waitcnt vmcnt(8)
    ds_read_b64_tr_b16 v[144:145], v24 offset:16384
    ds_read_b64_tr_b16 v[146:147], v24 offset:16896
    ds_read_b64_tr_b16 v[148:149], v25 offset:16384
    ds_read_b64_tr_b16 v[150:151], v25 offset:16896
    ds_read_b128 v[152:155], v21 offset:0
    ds_read_b128 v[156:159], v21 offset:32768
    s_waitcnt lgkmcnt(6)
    s_add_u32 m0, s43, 0
    s_nop 0
    buffer_load_dwordx4 v26, s[16:19], s44 offen  lds
    s_add_u32 s44, s44, 65536
    s_add_u32 m0, s43, 1024
    s_nop 0
    buffer_load_dwordx4 v26, s[16:19], s44 offen  lds
    s_add_u32 s44, s44, 65536
    v_mfma_f32_32x32x16_bf16 v[64:79], v[128:131], v[136:139], v[64:79]
    v_mfma_f32_32x32x16_bf16 v[80:95], v[128:131], v[140:143], v[80:95]
    v_mfma_f32_32x32x16_bf16 v[96:111], v[132:135], v[136:139], v[96:111]
    v_mfma_f32_32x32x16_bf16 v[112:127], v[132:135], v[140:143], v[112:127]
    s_waitcnt vmcnt(8)
    ds_read_b64_tr_b16 v[128:129], v24 offset:32768
    ds_read_b64_tr_b16 v[130:131], v24 offset:33280
    ds_read_b64_tr_b16 v[132:133], v25 offset:32768
    ds_read_b64_tr_b16 v[134:135], v25 offset:33280
    ds_read_b128 v[136:139], v22 offset:0
    ds_read_b128 v[140:143], v22 offset:32768
    s_waitcnt lgkmcnt(6)
    s_add_u32 m0, s43, 16384
    s_nop 0
    buffer_load_dwordx4 v26, s[16:19], s44 offen  lds
    s_add_u32 s44, s44, 65536
    s_add_u32 m0, s43, 17408
    s_nop 0
    buffer_load_dwordx4 v26, s[16:19], s44 offen  lds
    s_add_u32 s44, s44, 65536
    v_mfma_f32_32x32x16_bf16 v[64:79], v[144:147], v[152:155], v[64:79]
    v_mfma_f32_32x32x16_bf16 v[80:95], v[144:147], v[156:159], v[80:95]
    v_mfma_f32_32x32x16_bf16 v[96:111], v[148:151], v[152:155], v[96:111]
    v_mfma_f32_32x32x16_bf16 v[112:127], v[148:151], v[156:159], v[112:127]
    s_waitcnt vmcnt(8)
    ds_read_b64_tr_b16 v[144:145], v24 offset:49152
    ds_read_b64_tr_b16 v[146:147], v24 offset:49664
    ds_read_b64_tr_b16 v[148:149], v25 offset:49152
    ds_read_b64_tr_b16 v[150:151], v25 offset:49664
    ds_read_b128 v[152:155], v23 offset:0
    ds_read_b128 v[156:159], v23 offset:32768
    s_waitcnt lgkmcnt(6)
    s_add_u32 m0, s43, 32768
    s_nop 0
    buffer_load_dwordx4 v26, s[16:19], s44 offen  lds
    s_add_u32 s44, s44, 65536
    s_add_u32 m0, s43, 33792
    s_nop 0
    buffer_load_dwordx4 v26, s[16:19], s44 offen  lds
    s_add_u32 s44, s44, 65536
    v_mfma_f32_32x32x16_bf16 v[64:79], v[128:131], v[136:139], v[64:79]
    v_mfma_f32_32x32x16_bf16 v[80:95], v[128:131], v[140:143], v[80:95]
    v_mfma_f32_32x32x16_bf16 v[96:111], v[132:135], v[136:139], v[96:111]
    v_mfma_f32_32x32x16_bf16 v[112:127], v[132:135], v[140:143], v[112:127]
    s_waitcnt vmcnt(8)
    ds_read_b64_tr_b16 v[128:129], v43 offset:0
    ds_read_b64_tr_b16 v[130:131], v43 offset:512
    ds_read_b64_tr_b16 v[132:133], v45 offset:0
    ds_read_b64_tr_b16 v[134:135], v45 offset:512
    ds_read_b128 v[136:139], v16 offset:256
    ds_read_b128 v[140:143], v16 offset:33024
    s_waitcnt lgkmcnt(6)
    s_add_u32 m0, s43, 49152
    s_nop 0
    buffer_load_dwordx4 v26, s[16:19], s44 offen  lds
    s_add_u32 s44, s44, 65536
    s_add_u32 m0, s43, 50176
    s_nop 0
    buffer_load_dwordx4 v26, s[16:19], s44 offen  lds
    s_add_u32 s44, s44, 65536
    v_mfma_f32_32x32x16_bf16 v[64:79], v[144:147], v[152:155], v[64:79]
    v_mfma_f32_32x32x16_bf16 v[80:95], v[144:147], v[156:159], v[80:95]
    v_mfma_f32_32x32x16_bf16 v[96:111], v[148:151], v[152:155], v[96:111]
    v_mfma_f32_32x32x16_bf16 v[112:127], v[148:151], v[156:159], v[112:127]
    s_waitcnt vmcnt(8)
    ds_read_b64_tr_b16 v[144:145], v43 offset:16384
    ds_read_b64_tr_b16 v[146:147], v43 offset:16896
    ds_read_b64_tr_b16 v[148:149], v45 offset:16384
    ds_read_b64_tr_b16 v[150:151], v45 offset:16896
    ds_read_b128 v[152:155], v17 offset:256
    ds_read_b128 v[156:159], v17 offset:33024
    s_waitcnt lgkmcnt(6)
    s_add_u32 m0, s43, 65536
    s_nop 0
    buffer_load_dwordx4 v26, s[16:19], s44 offen  lds
    s_add_u32 s44, s44, 65536
    s_add_u32 m0, s43, 66560
    s_nop 0
    buffer_load_dwordx4 v26, s[16:19], s44 offen  lds
    s_add_u32 s44, s44, 65536
    v_mfma_f32_32x32x16_bf16 v[64:79], v[128:131], v[136:139], v[64:79]
    v_mfma_f32_32x32x16_bf16 v[80:95], v[128:131], v[140:143], v[80:95]
    v_mfma_f32_32x32x16_bf16 v[96:111], v[132:135], v[136:139], v[96:111]
    v_mfma_f32_32x32x16_bf16 v[112:127], v[132:135], v[140:143], v[112:127]
    s_waitcnt vmcnt(8)
    ds_read_b64_tr_b16 v[128:129], v24 offset:0
    ds_read_b64_tr_b16 v[130:131], v24 offset:512
    ds_read_b64_tr_b16 v[132:133], v25 offset:0
    ds_read_b64_tr_b16 v[134:135], v25 offset:512
    ds_read_b128 v[136:139], v18 offset:256
    ds_read_b128 v[140:143], v18 offset:33024
    s_waitcnt lgkmcnt(6)
    s_add_u32 m0, s43, 81920
    s_nop 0
    buffer_load_dwordx4 v26, s[16:19], s44 offen  lds
    s_add_u32 s44, s44, 65536
    s_add_u32 m0, s43, 82944
    s_nop 0
    buffer_load_dwordx4 v26, s[16:19], s44 offen  lds
    s_add_u32 s44, s44, 65536
    v_mfma_f32_32x32x16_bf16 v[64:79], v[144:147], v[152:155], v[64:79]
    v_mfma_f32_32x32x16_bf16 v[80:95], v[144:147], v[156:159], v[80:95]
    v_mfma_f32_32x32x16_bf16 v[96:111], v[148:151], v[152:155], v[96:111]
    v_mfma_f32_32x32x16_bf16 v[112:127], v[148:151], v[156:159], v[112:127]
    s_waitcnt vmcnt(8)
    ds_read_b64_tr_b16 v[144:145], v24 offset:16384
    ds_read_b64_tr_b16 v[146:147], v24 offset:16896
    ds_read_b64_tr_b16 v[148:149], v25 offset:16384
    ds_read_b64_tr_b16 v[150:151], v25 offset:16896
    ds_read_b128 v[152:155], v19 offset:256
    ds_read_b128 v[156:159], v19 offset:33024
    s_waitcnt lgkmcnt(6)
    s_add_u32 m0, s43, 0
    s_nop 0
    buffer_load_dwordx4 v26, s[16:19], s44 offen  lds
    s_add_u32 s44, s44, 65536
    s_add_u32 m0, s43, 1024
    s_nop 0
    buffer_load_dwordx4 v26, s[16:19], s44 offen  lds
    s_add_u32 s44, s44, 65536
    v_mfma_f32_32x32x16_bf16 v[64:79], v[128:131], v[136:139], v[64:79]
    v_mfma_f32_32x32x16_bf16 v[80:95], v[128:131], v[140:143], v[80:95]
    v_mfma_f32_32x32x16_bf16 v[96:111], v[132:135], v[136:139], v[96:111]
    v_mfma_f32_32x32x16_bf16 v[112:127], v[132:135], v[140:143], v[112:127]
    s_waitcnt vmcnt(8)
    ds_read_b64_tr_b16 v[128:129], v24 offset:32768
    ds_read_b64_tr_b16 v[130:131], v24 offset:33280
    ds_read_b64_tr_b16 v[132:133], v25 offset:32768
    ds_read_b64_tr_b16 v[134:135], v25 offset:33280
    ds_read_b128 v[136:139], v20 offset:256
    ds_read_b128 v[140:143], v20 offset:33024
    s_waitcnt lgkmcnt(6)
    s_add_u32 m0, s43, 16384
    s_nop 0
    buffer_load_dwordx4 v26, s[16:19], s44 offen  lds
    s_add_u32 s44, s44, 65536
    s_add_u32 m0, s43, 17408
    s_nop 0
    buffer_load_dwordx4 v26, s[16:19], s44 offen  lds
    s_add_u32 s44, s44, 65536
    v_mfma_f32_32x32x16_bf16 v[64:79], v[144:147], v[152:155], v[64:79]
    v_mfma_f32_32x32x16_bf16 v[80:95], v[144:147], v[156:159], v[80:95]
    v_mfma_f32_32x32x16_bf16 v[96:111], v[148:151], v[152:155], v[96:111]
    v_mfma_f32_32x32x16_bf16 v[112:127], v[148:151], v[156:159], v[112:127]
    s_waitcnt vmcnt(8)
    ds_read_b64_tr_b16 v[144:145], v24 offset:49152
    ds_read_b64_tr_b16 v[146:147], v24 offset:49664
    ds_read_b64_tr_b16 v[148:149], v25 offset:49152
    ds_read_b64_tr_b16 v[150:151], v25 offset:49664
    ds_read_b128 v[152:155], v21 offset:256
    ds_read_b128 v[156:159], v21 offset:33024
    s_waitcnt lgkmcnt(6)
    s_add_u32 m0, s43, 32768
    s_nop 0
    buffer_load_dwordx4 v26, s[16:19], s44 offen  lds
    s_add_u32 s44, s44, 65536
    s_add_u32 m0, s43, 33792
    s_nop 0
    buffer_load_dwordx4 v26, s[16:19], s44 offen  lds
    s_add_u32 s44, s44, 65536
    v_mfma_f32_32x32x16_bf16 v[64:79], v[128:131], v[136:139], v[64:79]
    v_mfma_f32_32x32x16_bf16 v[80:95], v[128:131], v[140:143], v[80:95]
    v_mfma_f32_32x32x16_bf16 v[96:111], v[132:135], v[136:139], v[96:111]
    v_mfma_f32_32x32x16_bf16 v[112:127], v[132:135], v[140:143], v[112:127]
    s_waitcnt vmcnt(8)
    ds_read_b64_tr_b16 v[128:129], v43 offset:0
    ds_read_b64_tr_b16 v[130:131], v43 offset:512
    ds_read_b64_tr_b16 v[132:133], v45 offset:0
    ds_read_b64_tr_b16 v[134:135], v45 offset:512
    ds_read_b128 v[136:139], v22 offset:256
    ds_read_b128 v[140:143], v22 offset:33024
    s_waitcnt lgkmcnt(6)
    s_add_u32 m0, s43, 49152
    s_nop 0
    buffer_load_dwordx4 v26, s[16:19], s44 offen  lds
    s_add_u32 s44, s44, 65536
    s_add_u32 m0, s43, 50176
    s_nop 0
    buffer_load_dwordx4 v26, s[16:19], s44 offen  lds
    s_add_u32 s44, s44, 65536
    v_mfma_f32_32x32x16_bf16 v[64:79], v[144:147], v[152:155], v[64:79]
    v_mfma_f32_32x32x16_bf16 v[80:95], v[144:147], v[156:159], v[80:95]
    v_mfma_f32_32x32x16_bf16 v[96:111], v[148:151], v[152:155], v[96:111]
    v_mfma_f32_32x32x16_bf16 v[112:127], v[148:151], v[156:159], v[112:127]
    s_waitcnt vmcnt(8)
    ds_read_b64_tr_b16 v[144:145], v43 offset:16384
    ds_read_b64_tr_b16 v[146:147], v43 offset:16896
    ds_read_b64_tr_b16 v[148:149], v45 offset:16384
    ds_read_b64_tr_b16 v[150:151], v45 offset:16896
    ds_read_b128 v[152:155], v23 offset:256
    ds_read_b128 v[156:159], v23 offset:33024
    s_waitcnt lgkmcnt(6)
    s_add_u32 m0, s43, 65536
    s_nop 0
    buffer_load_dwordx4 v26, s[16:19], s44 offen  lds
    s_add_u32 s44, s44, 65536
    s_add_u32 m0, s43, 66560
    s_nop 0
    buffer_load_dwordx4 v26, s[16:19], s44 offen  lds
    s_add_u32 s44, s44, 65536
    v_mfma_f32_32x32x16_bf16 v[64:79], v[128:131], v[136:139], v[64:79]
    v_mfma_f32_32x32x16_bf16 v[80:95], v[128:131], v[140:143], v[80:95]
    v_mfma_f32_32x32x16_bf16 v[96:111], v[132:135], v[136:139], v[96:111]
    v_mfma_f32_32x32x16_bf16 v[112:127], v[132:135], v[140:143], v[112:127]
    s_waitcnt vmcnt(8)
    ds_read_b64_tr_b16 v[128:129], v24 offset:0
    ds_read_b64_tr_b16 v[130:131], v24 offset:512
    ds_read_b64_tr_b16 v[132:133], v25 offset:0
    ds_read_b64_tr_b16 v[134:135], v25 offset:512
    ds_read_b128 v[136:139], v16 offset:512
    ds_read_b128 v[140:143], v16 offset:33280
    s_waitcnt lgkmcnt(6)
    s_add_u32 m0, s43, 81920
    s_nop 0
    buffer_load_dwordx4 v26, s[16:19], s44 offen  lds
    s_add_u32 s44, s44, 65536
    s_add_u32 m0, s43, 82944
    s_nop 0
    buffer_load_dwordx4 v26, s[16:19], s44 offen  lds
    s_add_u32 s44, s44, 65536
    v_mfma_f32_32x32x16_bf16 v[64:79], v[144:147], v[152:155], v[64:79]
    v_mfma_f32_32x32x16_bf16 v[80:95], v[144:147], v[156:159], v[80:95]
    v_mfma_f32_32x32x16_bf16 v[96:111], v[148:151], v[152:155], v[96:111]
    v_mfma_f32_32x32x16_bf16 v[112:127], v[148:151], v[156:159], v[112:127]
    s_waitcnt vmcnt(8)
    ds_read_b64_tr_b16 v[144:145], v24 offset:16384
    ds_read_b64_tr_b16 v[146:147], v24 offset:16896
    ds_read_b64_tr_b16 v[148:149], v25 offset:16384
    ds_read_b64_tr_b16 v[150:151], v25 offset:16896
    ds_read_b128 v[152:155], v17 offset:512
    ds_read_b128 v[156:159], v17 offset:33280
    s_waitcnt lgkmcnt(6)
    s_add_u32 m0, s43, 0
    s_nop 0
    buffer_load_dwordx4 v26, s[16:19], s44 offen  lds
    s_add_u32 s44, s44, 65536
    s_add_u32 m0, s43, 1024
    s_nop 0
    buffer_load_dwordx4 v26, s[16:19], s44 offen  lds
    s_add_u32 s44, s44, 65536
    v_mfma_f32_32x32x16_bf16 v[64:79], v[128:131], v[136:139], v[64:79]
    v_mfma_f32_32x32x16_bf16 v[80:95], v[128:131], v[140:143], v[80:95]
    v_mfma_f32_32x32x16_bf16 v[96:111], v[132:135], v[136:139], v[96:111]
    v_mfma_f32_32x32x16_bf16 v[112:127], v[132:135], v[140:143], v[112:127]
    s_waitcnt vmcnt(8)
    ds_read_b64_tr_b16 v[128:129], v24 offset:32768
    ds_read_b64_tr_b16 v[130:131], v24 offset:33280
    ds_read_b64_tr_b16 v[132:133], v25 offset:32768
    ds_read_b64_tr_b16 v[134:135], v25 offset:33280
    ds_read_b128 v[136:139], v18 offset:512
    ds_read_b128 v[140:143], v18 offset:33280
    s_waitcnt lgkmcnt(6)
    s_add_u32 m0, s43, 16384
    s_nop 0
    buffer_load_dwordx4 v26, s[16:19], s44 offen  lds
    s_add_u32 s44, s44, 65536
    s_add_u32 m0, s43, 17408
    s_nop 0
    buffer_load_dwordx4 v26, s[16:19], s44 offen  lds
    s_add_u32 s44, s44, 65536
    v_mfma_f32_32x32x16_bf16 v[64:79], v[144:147], v[152:155], v[64:79]
    v_mfma_f32_32x32x16_bf16 v[80:95], v[144:147], v[156:159], v[80:95]
    v_mfma_f32_32x32x16_bf16 v[96:111], v[148:151], v[152:155], v[96:111]
    v_mfma_f32_32x32x16_bf16 v[112:127], v[148:151], v[156:159], v[112:127]
    s_waitcnt vmcnt(8)
    ds_read_b64_tr_b16 v[144:145], v24 offset:49152
    ds_read_b64_tr_b16 v[146:147], v24 offset:49664
    ds_read_b64_tr_b16 v[148:149], v25 offset:49152
    ds_read_b64_tr_b16 v[150:151], v25 offset:49664
    ds_read_b128 v[152:155], v19 offset:512
    ds_read_b128 v[156:159], v19 offset:33280
    s_waitcnt lgkmcnt(6)
    s_add_u32 m0, s43, 32768
    s_nop 0
    buffer_load_dwordx4 v26, s[16:19], s44 offen  lds
    s_add_u32 s44, s44, 65536
    s_add_u32 m0, s43, 33792
    s_nop 0
    buffer_load_dwordx4 v26, s[16:19], s44 offen  lds
    s_add_u32 s44, s44, 65536
    v_mfma_f32_32x32x16_bf16 v[64:79], v[128:131], v[136:139], v[64:79]
    v_mfma_f32_32x32x16_bf16 v[80:95], v[128:131], v[140:143], v[80:95]
    v_mfma_f32_32x32x16_bf16 v[96:111], v[132:135], v[136:139], v[96:111]
    v_mfma_f32_32x32x16_bf16 v[112:127], v[132:135], v[140:143], v[112:127]
    s_waitcnt vmcnt(8)
    ds_read_b64_tr_b16 v[128:129], v43 offset:0
    ds_read_b64_tr_b16 v[130:131], v43 offset:512
    ds_read_b64_tr_b16 v[132:133], v45 offset:0
    ds_read_b64_tr_b16 v[134:135], v45 offset:512
    ds_read_b128 v[136:139], v20 offset:512
    ds_read_b128 v[140:143], v20 offset:33280
    s_waitcnt lgkmcnt(6)
    s_add_u32 m0, s43, 49152
    s_nop 0
    buffer_load_dwordx4 v26, s[16:19], s44 offen  lds
    s_add_u32 s44, s44, 65536
    s_add_u32 m0, s43, 50176
    s_nop 0
    buffer_load_dwordx4 v26, s[16:19], s44 offen  lds
    s_add_u32 s44, s44, 65536
    v_mfma_f32_32x32x16_bf16 v[64:79], v[144:147], v[152:155], v[64:79]
    v_mfma_f32_32x32x16_bf16 v[80:95], v[144:147], v[156:159], v[80:95]
    v_mfma_f32_32x32x16_bf16 v[96:111], v[148:151], v[152:155], v[96:111]
    v_mfma_f32_32x32x16_bf16 v[112:127], v[148:151], v[156:159], v[112:127]
    s_waitcnt vmcnt(8)
    ds_read_b64_tr_b16 v[144:145], v43 offset:16384
    ds_read_b64_tr_b16 v[146:147], v43 offset:16896
    ds_read_b64_tr_b16 v[148:149], v45 offset:16384
    ds_read_b64_tr_b16 v[150:151], v45 offset:16896
    ds_read_b128 v[152:155], v21 offset:512
    ds_read_b128 v[156:159], v21 offset:33280
    s_waitcnt lgkmcnt(6)
    s_add_u32 m0, s43, 65536
    s_nop 0
    buffer_load_dwordx4 v26, s[16:19], s44 offen  lds
    s_add_u32 s44, s44, 65536
    s_add_u32 m0, s43, 66560
    s_nop 0
    buffer_load_dwordx4 v26, s[16:19], s44 offen  lds
    s_add_u32 s44, s44, 65536
    v_mfma_f32_32x32x16_bf16 v[64:79], v[128:131], v[136:139], v[64:79]
    v_mfma_f32_32x32x16_bf16 v[80:95], v[128:131], v[140:143], v[80:95]
    v_mfma_f32_32x32x16_bf16 v[96:111], v[132:135], v[136:139], v[96:111]
    v_mfma_f32_32x32x16_bf16 v[112:127], v[132:135], v[140:143], v[112:127]
    s_waitcnt vmcnt(8)
    ds_read_b64_tr_b16 v[128:129], v24 offset:0
    ds_read_b64_tr_b16 v[130:131], v24 offset:512
    ds_read_b64_tr_b16 v[132:133], v25 offset:0
    ds_read_b64_tr_b16 v[134:135], v25 offset:512
    ds_read_b128 v[136:139], v22 offset:512
    ds_read_b128 v[140:143], v22 offset:33280
    s_waitcnt lgkmcnt(6)
    s_add_u32 m0, s43, 81920
    s_nop 0
    buffer_load_dwordx4 v26, s[16:19], s44 offen  lds
    s_add_u32 s44, s44, 65536
    s_add_u32 m0, s43, 82944
    s_nop 0
    buffer_load_dwordx4 v26, s[16:19], s44 offen  lds
    s_add_u32 s44, s44, 65536
    v_mfma_f32_32x32x16_bf16 v[64:79], v[144:147], v[152:155], v[64:79]
    v_mfma_f32_32x32x16_bf16 v[80:95], v[144:147], v[156:159], v[80:95]
    v_mfma_f32_32x32x16_bf16 v[96:111], v[148:151], v[152:155], v[96:111]
    v_mfma_f32_32x32x16_bf16 v[112:127], v[148:151], v[156:159], v[112:127]
    s_waitcnt vmcnt(8)
    ds_read_b64_tr_b16 v[144:145], v24 offset:16384
    ds_read_b64_tr_b16 v[146:147], v24 offset:16896
    ds_read_b64_tr_b16 v[148:149], v25 offset:16384
    ds_read_b64_tr_b16 v[150:151], v25 offset:16896
    ds_read_b128 v[152:155], v23 offset:512
    ds_read_b128 v[156:159], v23 offset:33280
    s_waitcnt lgkmcnt(6)
    s_add_u32 m0, s43, 0
    s_nop 0
    buffer_load_dwordx4 v26, s[16:19], s44 offen  lds
    s_add_u32 s44, s44, 65536
    s_add_u32 m0, s43, 1024
    s_nop 0
    buffer_load_dwordx4 v26, s[16:19], s44 offen  lds
    s_add_u32 s44, s44, 65536
    v_mfma_f32_32x32x16_bf16 v[64:79], v[128:131], v[136:139], v[64:79]
    v_mfma_f32_32x32x16_bf16 v[80:95], v[128:131], v[140:143], v[80:95]
    v_mfma_f32_32x32x16_bf16 v[96:111], v[132:135], v[136:139], v[96:111]
    v_mfma_f32_32x32x16_bf16 v[112:127], v[132:135], v[140:143], v[112:127]
    s_waitcnt vmcnt(8)
    ds_read_b64_tr_b16 v[128:129], v24 offset:32768
    ds_read_b64_tr_b16 v[130:131], v24 offset:33280
    ds_read_b64_tr_b16 v[132:133], v25 offset:32768
    ds_read_b64_tr_b16 v[134:135], v25 offset:33280
    ds_read_b128 v[136:139], v16 offset:768
    ds_read_b128 v[140:143], v16 offset:33536
    s_waitcnt lgkmcnt(6)
    s_add_u32 m0, s43, 16384
    s_nop 0
    buffer_load_dwordx4 v26, s[16:19], s44 offen  lds
    s_add_u32 s44, s44, 65536
    s_add_u32 m0, s43, 17408
    s_nop 0
    buffer_load_dwordx4 v26, s[16:19], s44 offen  lds
    s_add_u32 s44, s44, 65536
    v_mfma_f32_32x32x16_bf16 v[64:79], v[144:147], v[152:155], v[64:79]
    v_mfma_f32_32x32x16_bf16 v[80:95], v[144:147], v[156:159], v[80:95]
    v_mfma_f32_32x32x16_bf16 v[96:111], v[148:151], v[152:155], v[96:111]
    v_mfma_f32_32x32x16_bf16 v[112:127], v[148:151], v[156:159], v[112:127]
    s_waitcnt vmcnt(8)
    ds_read_b64_tr_b16 v[144:145], v24 offset:49152
    ds_read_b64_tr_b16 v[146:147], v24 offset:49664
    ds_read_b64_tr_b16 v[148:149], v25 offset:49152
    ds_read_b64_tr_b16 v[150:151], v25 offset:49664
    ds_read_b128 v[152:155], v17 offset:768
    ds_read_b128 v[156:159], v17 offset:33536
    s_waitcnt lgkmcnt(6)
    s_add_u32 m0, s43, 32768
    s_nop 0
    buffer_load_dwordx4 v26, s[16:19], s44 offen  lds
    s_add_u32 s44, s44, 65536
    s_add_u32 m0, s43, 33792
    s_nop 0
    buffer_load_dwordx4 v26, s[16:19], s44 offen  lds
    s_add_u32 s44, s44, 65536
    v_mfma_f32_32x32x16_bf16 v[64:79], v[128:131], v[136:139], v[64:79]
    v_mfma_f32_32x32x16_bf16 v[80:95], v[128:131], v[140:143], v[80:95]
    v_mfma_f32_32x32x16_bf16 v[96:111], v[132:135], v[136:139], v[96:111]
    v_mfma_f32_32x32x16_bf16 v[112:127], v[132:135], v[140:143], v[112:127]
    s_waitcnt vmcnt(8)
    ds_read_b64_tr_b16 v[128:129], v43 offset:0
    ds_read_b64_tr_b16 v[130:131], v43 offset:512
    ds_read_b64_tr_b16 v[132:133], v45 offset:0
    ds_read_b64_tr_b16 v[134:135], v45 offset:512
    ds_read_b128 v[136:139], v18 offset:768
    ds_read_b128 v[140:143], v18 offset:33536
    s_waitcnt lgkmcnt(6)
    s_add_u32 m0, s43, 49152
    s_nop 0
    buffer_load_dwordx4 v26, s[16:19], s44 offen  lds
    s_add_u32 s44, s44, 65536
    s_add_u32 m0, s43, 50176
    s_nop 0
    buffer_load_dwordx4 v26, s[16:19], s44 offen  lds
    s_add_u32 s44, s44, 65536
    v_mfma_f32_32x32x16_bf16 v[64:79], v[144:147], v[152:155], v[64:79]
    v_mfma_f32_32x32x16_bf16 v[80:95], v[144:147], v[156:159], v[80:95]
    v_mfma_f32_32x32x16_bf16 v[96:111], v[148:151], v[152:155], v[96:111]
    v_mfma_f32_32x32x16_bf16 v[112:127], v[148:151], v[156:159], v[112:127]
    s_waitcnt vmcnt(8)
    ds_read_b64_tr_b16 v[144:145], v43 offset:16384
    ds_read_b64_tr_b16 v[146:147], v43 offset:16896
    ds_read_b64_tr_b16 v[148:149], v45 offset:16384
    ds_read_b64_tr_b16 v[150:151], v45 offset:16896
    ds_read_b128 v[152:155], v19 offset:768
    ds_read_b128 v[156:159], v19 offset:33536
    s_waitcnt lgkmcnt(6)
    s_mov_b32 s46, 0
    s_add_u32 m0, s47, 131072
    s_nop 0
    buffer_load_dwordx4 v40, s[20:23], s46 offen lds
    buffer_load_dwordx4 v41, s[20:23], s46 offen offset:1024 lds
    v_mfma_f32_32x32x16_bf16 v[64:79], v[128:131], v[136:139], v[64:79]
    v_mfma_f32_32x32x16_bf16 v[80:95], v[128:131], v[140:143], v[80:95]
    v_mfma_f32_32x32x16_bf16 v[96:111], v[132:135], v[136:139], v[96:111]
    v_mfma_f32_32x32x16_bf16 v[112:127], v[132:135], v[140:143], v[112:127]
    s_waitcnt vmcnt(8)
    ds_read_b64_tr_b16 v[128:129], v24 offset:0
    ds_read_b64_tr_b16 v[130:131], v24 offset:512
    ds_read_b64_tr_b16 v[132:133], v25 offset:0
    ds_read_b64_tr_b16 v[134:135], v25 offset:512
    ds_read_b128 v[136:139], v20 offset:768
    ds_read_b128 v[140:143], v20 offset:33536
    s_waitcnt lgkmcnt(6)
    s_mov_b32 s46, 16384
    s_add_u32 m0, s47, 147456
    s_nop 0
    buffer_load_dwordx4 v40, s[20:23], s46 offen lds
    buffer_load_dwordx4 v41, s[20:23], s46 offen offset:1024 lds
    v_mfma_f32_32x32x16_bf16 v[64:79], v[144:147], v[152:155], v[64:79]
    v_mfma_f32_32x32x16_bf16 v[80:95], v[144:147], v[156:159], v[80:95]
    v_mfma_f32_32x32x16_bf16 v[96:111], v[148:151], v[152:155], v[96:111]
    v_mfma_f32_32x32x16_bf16 v[112:127], v[148:151], v[156:159], v[112:127]
    s_waitcnt vmcnt(8)
    ds_read_b64_tr_b16 v[144:145], v24 offset:16384
    ds_read_b64_tr_b16 v[146:147], v24 offset:16896
    ds_read_b64_tr_b16 v[148:149], v25 offset:16384
    ds_read_b64_tr_b16 v[150:151], v25 offset:16896
    ds_read_b128 v[152:155], v21 offset:768
    ds_read_b128 v[156:159], v21 offset:33536
    s_waitcnt lgkmcnt(6)
    s_mov_b32 s46, 0
    s_add_u32 m0, s47, 65536
    s_nop 0
    buffer_load_dwordx4 v42, s[24:27], s46 offen lds
    buffer_load_dwordx4 v42, s[24:27], s46 offen offset:1024 lds
    v_mfma_f32_32x32x16_bf16 v[64:79], v[128:131], v[136:139], v[64:79]
    v_mfma_f32_32x32x16_bf16 v[80:95], v[128:131], v[140:143], v[80:95]
    v_mfma_f32_32x32x16_bf16 v[96:111], v[132:135], v[136:139], v[96:111]
    v_mfma_f32_32x32x16_bf16 v[112:127], v[132:135], v[140:143], v[112:127]
    s_waitcnt vmcnt(8)
    ds_read_b64_tr_b16 v[128:129], v24 offset:32768
    ds_read_b64_tr_b16 v[130:131], v24 offset:33280
    ds_read_b64_tr_b16 v[132:133], v25 offset:32768
    ds_read_b64_tr_b16 v[134:135], v25 offset:33280
    ds_read_b128 v[136:139], v22 offset:768
    ds_read_b128 v[140:143], v22 offset:33536
    s_waitcnt lgkmcnt(6)
    s_mov_b32 s46, 16384
    s_add_u32 m0, s47, 81920
    s_nop 0
    buffer_load_dwordx4 v42, s[24:27], s46 offen lds
    buffer_load_dwordx4 v42, s[24:27], s46 offen offset:1024 lds
    v_mfma_f32_32x32x16_bf16 v[64:79], v[144:147], v[152:155], v[64:79]
    v_mfma_f32_32x32x16_bf16 v[80:95], v[144:147], v[156:159], v[80:95]
    v_mfma_f32_32x32x16_bf16 v[96:111], v[148:151], v[152:155], v[96:111]
    v_mfma_f32_32x32x16_bf16 v[112:127], v[148:151], v[156:159], v[112:127]
    s_waitcnt vmcnt(8)
    ds_read_b64_tr_b16 v[144:145], v24 offset:49152
    ds_read_b64_tr_b16 v[146:147], v24 offset:49664
    ds_read_b64_tr_b16 v[148:149], v25 offset:49152
    ds_read_b64_tr_b16 v[150:151], v25 offset:49664
    ds_read_b128 v[152:155], v23 offset:768
    ds_read_b128 v[156:159], v23 offset:33536
    s_waitcnt lgkmcnt(6)
    v_mfma_f32_32x32x16_bf16 v[64:79], v[128:131], v[136:139], v[64:79]
    v_mfma_f32_32x32x16_bf16 v[80:95], v[128:131], v[140:143], v[80:95]
    v_mfma_f32_32x32x16_bf16 v[96:111], v[132:135], v[136:139], v[96:111]
    v_mfma_f32_32x32x16_bf16 v[112:127], v[132:135], v[140:143], v[112:127]
    s_waitcnt lgkmcnt(0)
    s_mov_b32 s46, 32768
    s_add_u32 m0, s47, 114688
    s_nop 0
    buffer_load_dwordx4 v40, s[20:23], s46 offen lds
    buffer_load_dwordx4 v41, s[20:23], s46 offen offset:1024 lds
    v_mfma_f32_32x32x16_bf16 v[64:79], v[144:147], v[152:155], v[64:79]
    v_mfma_f32_32x32x16_bf16 v[80:95], v[144:147], v[156:159], v[80:95]
    v_mfma_f32_32x32x16_bf16 v[96:111], v[148:151], v[152:155], v[96:111]
    v_mfma_f32_32x32x16_bf16 v[112:127], v[148:151], v[156:159], v[112:127]
    s_barrier
    s_and_b32 s56, s40, 1
    s_lshr_b32 s57, s40, 1
    s_lshl_b32 s57, s57, 8
    s_cmp_eq_u32 s56, 1
    s_cselect_b64 vcc, -1, 0
    v_mov_b32 v46, s66
    v_cndmask_b32 v2, v16, v20, vcc
    v_add_u32 v2, s57, v2
    v_cndmask_b32 v3, v17, v21, vcc
    v_add_u32 v3, s57, v3
    v_cndmask_b32 v4, v18, v22, vcc
    v_add_u32 v4, s57, v4
    v_cndmask_b32 v5, v19, v23, vcc
    v_add_u32 v5, s57, v5
    v_pk_mul_f32 v[64:65], v[64:65], v[46:47] op_sel_hi:[1,0]
    v_pk_mul_f32 v[66:67], v[66:67], v[46:47] op_sel_hi:[1,0]
    v_pk_mul_f32 v[68:69], v[68:69], v[46:47] op_sel_hi:[1,0]
    v_pk_mul_f32 v[70:71], v[70:71], v[46:47] op_sel_hi:[1,0]
    v_cvt_pk_bf16_f32 v160, v64, v65
    v_cvt_pk_bf16_f32 v161, v66, v67
    v_cvt_pk_bf16_f32 v162, v68, v69
    v_cvt_pk_bf16_f32 v163, v70, v71
    ds_write_b128 v2, v[160:163] offset:0
    v_pk_mul_f32 v[72:73], v[72:73], v[46:47] op_sel_hi:[1,0]
    v_pk_mul_f32 v[74:75], v[74:75], v[46:47] op_sel_hi:[1,0]
    v_pk_mul_f32 v[76:77], v[76:77], v[46:47] op_sel_hi:[1,0]
    v_pk_mul_f32 v[78:79], v[78:79], v[46:47] op_sel_hi:[1,0]
    v_cvt_pk_bf16_f32 v164, v72, v73
    v_cvt_pk_bf16_f32 v165, v74, v75
    v_cvt_pk_bf16_f32 v166, v76, v77
    v_cvt_pk_bf16_f32 v167, v78, v79
    ds_write_b128 v3, v[164:167] offset:0
    v_pk_mul_f32 v[80:81], v[80:81], v[46:47] op_sel_hi:[1,0]
    v_pk_mul_f32 v[82:83], v[82:83], v[46:47] op_sel_hi:[1,0]
    v_pk_mul_f32 v[84:85], v[84:85], v[46:47] op_sel_hi:[1,0]
    v_pk_mul_f32 v[86:87], v[86:87], v[46:47] op_sel_hi:[1,0]
    v_cvt_pk_bf16_f32 v168, v80, v81
    v_cvt_pk_bf16_f32 v169, v82, v83
    v_cvt_pk_bf16_f32 v170, v84, v85
    v_cvt_pk_bf16_f32 v171, v86, v87
    ds_write_b128 v2, v[168:171] offset:32768
    v_pk_mul_f32 v[88:89], v[88:89], v[46:47] op_sel_hi:[1,0]
    v_pk_mul_f32 v[90:91], v[90:91], v[46:47] op_sel_hi:[1,0]
    v_pk_mul_f32 v[92:93], v[92:93], v[46:47] op_sel_hi:[1,0]
    v_pk_mul_f32 v[94:95], v[94:95], v[46:47] op_sel_hi:[1,0]
    v_cvt_pk_bf16_f32 v172, v88, v89
    v_cvt_pk_bf16_f32 v173, v90, v91
    v_cvt_pk_bf16_f32 v174, v92, v93
    v_cvt_pk_bf16_f32 v175, v94, v95
    ds_write_b128 v3, v[172:175] offset:32768
    v_pk_mul_f32 v[96:97], v[96:97], v[46:47] op_sel_hi:[1,0]
    v_pk_mul_f32 v[98:99], v[98:99], v[46:47] op_sel_hi:[1,0]
    v_pk_mul_f32 v[100:101], v[100:101], v[46:47] op_sel_hi:[1,0]
    v_pk_mul_f32 v[102:103], v[102:103], v[46:47] op_sel_hi:[1,0]
    v_cvt_pk_bf16_f32 v176, v96, v97
    v_cvt_pk_bf16_f32 v177, v98, v99
    v_cvt_pk_bf16_f32 v178, v100, v101
    v_cvt_pk_bf16_f32 v179, v102, v103
    ds_write_b128 v4, v[176:179] offset:0
    v_pk_mul_f32 v[104:105], v[104:105], v[46:47] op_sel_hi:[1,0]
    v_pk_mul_f32 v[106:107], v[106:107], v[46:47] op_sel_hi:[1,0]
    v_pk_mul_f32 v[108:109], v[108:109], v[46:47] op_sel_hi:[1,0]
    v_pk_mul_f32 v[110:111], v[110:111], v[46:47] op_sel_hi:[1,0]
    v_cvt_pk_bf16_f32 v180, v104, v105
    v_cvt_pk_bf16_f32 v181, v106, v107
    v_cvt_pk_bf16_f32 v182, v108, v109
    v_cvt_pk_bf16_f32 v183, v110, v111
    ds_write_b128 v5, v[180:183] offset:0
    v_pk_mul_f32 v[112:113], v[112:113], v[46:47] op_sel_hi:[1,0]
    v_pk_mul_f32 v[114:115], v[114:115], v[46:47] op_sel_hi:[1,0]
    v_pk_mul_f32 v[116:117], v[116:117], v[46:47] op_sel_hi:[1,0]
    v_pk_mul_f32 v[118:119], v[118:119], v[46:47] op_sel_hi:[1,0]
    v_cvt_pk_bf16_f32 v184, v112, v113
    v_cvt_pk_bf16_f32 v185, v114, v115
    v_cvt_pk_bf16_f32 v186, v116, v117
    v_cvt_pk_bf16_f32 v187, v118, v119
    ds_write_b128 v4, v[184:187] offset:32768
    v_pk_mul_f32 v[120:121], v[120:121], v[46:47] op_sel_hi:[1,0]
    v_pk_mul_f32 v[122:123], v[122:123], v[46:47] op_sel_hi:[1,0]
    v_pk_mul_f32 v[124:125], v[124:125], v[46:47] op_sel_hi:[1,0]
    v_pk_mul_f32 v[126:127], v[126:127], v[46:47] op_sel_hi:[1,0]
    v_cvt_pk_bf16_f32 v188, v120, v121
    v_cvt_pk_bf16_f32 v189, v122, v123
    v_cvt_pk_bf16_f32 v190, v124, v125
    v_cvt_pk_bf16_f32 v191, v126, v127
    ds_write_b128 v5, v[188:191] offset:32768
    s_and_b32 s56, s40, 3
    s_lshl_b32 s56, s56, 8
    s_lshr_b32 s57, s40, 2
    s_lshl_b32 s57, s57, 15
    s_add_u32 s67, s56, s57
    v_add_u32 v50, s67, v16
    v_add_u32 v51, s67, v17
    v_add_u32 v52, s67, v18
    v_add_u32 v53, s67, v19
    v_add_u32 v54, s67, v20
    v_add_u32 v55, s67, v21
    v_add_u32 v56, s67, v22
    v_add_u32 v57, s67, v23
    s_waitcnt lgkmcnt(0)
    s_waitcnt vmcnt(8)
    s_barrier
    ds_read_b128 v[128:131], v50
    ds_read_b128 v[132:135], v51
    ds_read_b128 v[136:139], v52
    ds_read_b128 v[140:143], v53
    ds_read_b128 v[144:147], v54
    ds_read_b128 v[148:151], v55
    ds_read_b128 v[152:155], v56
    ds_read_b128 v[156:159], v57
    ds_read_b128 v[224:227], v28 offset:16384
    ds_read_b128 v[228:231], v29 offset:16384
    ds_read_b128 v[232:235], v30 offset:16384
    ds_read_b128 v[236:239], v31 offset:16384
    ds_read_b128 v[240:243], v32 offset:16384
    ds_read_b128 v[244:247], v33 offset:16384
    s_waitcnt lgkmcnt(5)
    v_mfma_f32_32x32x16_bf16 v[160:175], v[224:227], v[128:131], 0
    ds_read_b128 v[248:251], v34 offset:16384
    s_waitcnt lgkmcnt(5)
    v_mfma_f32_32x32x16_bf16 v[160:175], v[228:231], v[132:135], v[160:175]
    ds_read_b128 v[252:255], v35 offset:16384
    s_waitcnt lgkmcnt(5)
    v_mfma_f32_32x32x16_bf16 v[160:175], v[232:235], v[136:139], v[160:175]
    ds_read_b128 v[224:227], v28 offset:24576
    s_waitcnt lgkmcnt(5)
    v_mfma_f32_32x32x16_bf16 v[160:175], v[236:239], v[140:143], v[160:175]
    ds_read_b128 v[228:231], v29 offset:24576
    s_waitcnt lgkmcnt(5)
    v_mfma_f32_32x32x16_bf16 v[160:175], v[240:243], v[144:147], v[160:175]
    ds_read_b128 v[232:235], v30 offset:24576
    s_waitcnt lgkmcnt(5)
    v_mfma_f32_32x32x16_bf16 v[160:175], v[244:247], v[148:151], v[160:175]
    ds_read_b128 v[236:239], v31 offset:24576
    s_waitcnt lgkmcnt(5)
    v_mfma_f32_32x32x16_bf16 v[160:175], v[248:251], v[152:155], v[160:175]
    ds_read_b128 v[240:243], v32 offset:24576
    s_waitcnt lgkmcnt(5)
    v_mfma_f32_32x32x16_bf16 v[160:175], v[252:255], v[156:159], v[160:175]
    ds_read_b128 v[244:247], v33 offset:24576
    s_waitcnt lgkmcnt(5)
    v_mfma_f32_32x32x16_bf16 v[176:191], v[224:227], v[128:131], 0
    ds_read_b128 v[248:251], v34 offset:24576
    s_waitcnt lgkmcnt(5)
    v_mfma_f32_32x32x16_bf16 v[176:191], v[228:231], v[132:135], v[176:191]
    ds_read_b128 v[252:255], v35 offset:24576
    s_waitcnt lgkmcnt(5)
    v_mfma_f32_32x32x16_bf16 v[176:191], v[232:235], v[136:139], v[176:191]
    s_waitcnt lgkmcnt(4)
    v_mfma_f32_32x32x16_bf16 v[176:191], v[236:239], v[140:143], v[176:191]
    s_waitcnt lgkmcnt(3)
    v_mfma_f32_32x32x16_bf16 v[176:191], v[240:243], v[144:147], v[176:191]
    s_waitcnt lgkmcnt(2)
    v_mfma_f32_32x32x16_bf16 v[176:191], v[244:247], v[148:151], v[176:191]
    s_waitcnt lgkmcnt(1)
    v_mfma_f32_32x32x16_bf16 v[176:191], v[248:251], v[152:155], v[176:191]
    s_waitcnt lgkmcnt(0)
    v_mfma_f32_32x32x16_bf16 v[176:191], v[252:255], v[156:159], v[176:191]
    s_waitcnt vmcnt(6)
    s_waitcnt vmcnt(4)
    s_barrier
    s_mov_b32 s46, 49152
    s_add_u32 m0, s47, 131072
    s_nop 0
    buffer_load_dwordx4 v40, s[20:23], s46 offen lds
    buffer_load_dwordx4 v41, s[20:23], s46 offen offset:1024 lds
    s_nop 7
    s_nop 3
    v_max3_f32 v2, v160, v161, v162
    v_max3_f32 v3, v163, v164, v165
    v_max3_f32 v2, v2, v166, v167
    v_max3_f32 v3, v3, v168, v169
    v_max3_f32 v2, v2, v170, v171
    v_max3_f32 v3, v3, v172, v173
    v_max3_f32 v2, v2, v174, v175
    v_max3_f32 v3, v3, v176, v177
    v_max3_f32 v2, v2, v178, v179
    v_max3_f32 v3, v3, v180, v181
    v_max3_f32 v2, v2, v182, v183
    v_max3_f32 v3, v3, v184, v185
    v_max3_f32 v2, v2, v186, v187
    v_max3_f32 v3, v3, v188, v189
    v_max3_f32 v2, v2, v190, v191
    v_max_f32 v2, v2, v3
    v_mov_b32 v3, v2
    s_nop 1
    v_permlane32_swap_b32 v2, v3
    s_nop 1
    v_max_f32 v2, v2, v3
    v_add_f32 v2, 0x42d80000, v2
    v_sub_f32 v48, 0, v2
    v_sub_f32 v49, 0, v2
    v_sub_f32 v50, 0, v2
    v_sub_f32 v51, 0, v2
    v_sub_f32 v52, 0, v2
    v_sub_f32 v53, 0, v2
    v_sub_f32 v54, 0, v2
    v_sub_f32 v55, 0, v2
    v_sub_f32 v56, 0, v2
    v_sub_f32 v57, 0, v2
    v_sub_f32 v58, 0, v2
    v_sub_f32 v59, 0, v2
    v_sub_f32 v60, 0, v2
    v_sub_f32 v61, 0, v2
    v_sub_f32 v62, 0, v2
    v_sub_f32 v63, 0, v2
    v_sub_f32 v160, v160, v2
    v_sub_f32 v161, v161, v2
    v_sub_f32 v162, v162, v2
    v_sub_f32 v163, v163, v2
    v_sub_f32 v164, v164, v2
    v_sub_f32 v165, v165, v2
    v_sub_f32 v166, v166, v2
    v_sub_f32 v167, v167, v2
    v_sub_f32 v168, v168, v2
    v_sub_f32 v169, v169, v2
    v_sub_f32 v170, v170, v2
    v_sub_f32 v171, v171, v2
    v_sub_f32 v172, v172, v2
    v_sub_f32 v173, v173, v2
    v_sub_f32 v174, v174, v2
    v_sub_f32 v175, v175, v2
    v_sub_f32 v176, v176, v2
    v_sub_f32 v177, v177, v2
    v_sub_f32 v178, v178, v2
    v_sub_f32 v179, v179, v2
    v_sub_f32 v180, v180, v2
    v_sub_f32 v181, v181, v2
    v_sub_f32 v182, v182, v2
    v_sub_f32 v183, v183, v2
    v_sub_f32 v184, v184, v2
    v_sub_f32 v185, v185, v2
    v_sub_f32 v186, v186, v2
    v_sub_f32 v187, v187, v2
    v_sub_f32 v188, v188, v2
    v_sub_f32 v189, v189, v2
    v_sub_f32 v190, v190, v2
    v_sub_f32 v191, v191, v2
    ds_read_b128 v[224:227], v28 offset:32768
    ds_read_b128 v[228:231], v29 offset:32768
    ds_read_b128 v[232:235], v30 offset:32768
    ds_read_b128 v[236:239], v31 offset:32768
    ds_read_b128 v[240:243], v32 offset:32768
    ds_read_b128 v[244:247], v33 offset:32768
    s_waitcnt lgkmcnt(5)
    v_mfma_f32_32x32x16_bf16 v[192:207], v[224:227], v[128:131], v[48:63]
    ds_read_b128 v[248:251], v34 offset:32768
    v_exp_f32 v160, v160
    v_exp_f32 v161, v161
    v_exp_f32 v162, v162
    s_waitcnt lgkmcnt(5)
    v_mfma_f32_32x32x16_bf16 v[192:207], v[228:231], v[132:135], v[192:207]
    ds_read_b128 v[252:255], v35 offset:32768
    v_exp_f32 v163, v163
    v_exp_f32 v164, v164
    v_exp_f32 v165, v165
    s_waitcnt lgkmcnt(5)
    v_mfma_f32_32x32x16_bf16 v[192:207], v[232:235], v[136:139], v[192:207]
    ds_read_b128 v[224:227], v28 offset:40960
    v_exp_f32 v166, v166
    v_exp_f32 v167, v167
    s_nop 0
    s_waitcnt lgkmcnt(5)
    v_mfma_f32_32x32x16_bf16 v[192:207], v[236:239], v[140:143], v[192:207]
    ds_read_b128 v[228:231], v29 offset:40960
    v_mov_b32 v10, v160
    v_mov_b32 v11, v161
    s_waitcnt lgkmcnt(5)
    v_mfma_f32_32x32x16_bf16 v[192:207], v[240:243], v[144:147], v[192:207]
    ds_read_b128 v[232:235], v30 offset:40960
    v_cvt_pk_bf16_f32 v160, v160, v161
    v_add_f32 v10, v10, v162
    v_add_f32 v11, v11, v163
    s_waitcnt lgkmcnt(5)
    v_mfma_f32_32x32x16_bf16 v[192:207], v[244:247], v[148:151], v[192:207]
    ds_read_b128 v[236:239], v31 offset:40960
    v_cvt_pk_bf16_f32 v161, v162, v163
    v_add_f32 v10, v10, v164
    v_add_f32 v11, v11, v165
    s_waitcnt lgkmcnt(5)
    v_mfma_f32_32x32x16_bf16 v[192:207], v[248:251], v[152:155], v[192:207]
    ds_read_b128 v[240:243], v32 offset:40960
    v_cvt_pk_bf16_f32 v162, v164, v165
    v_add_f32 v10, v10, v166
    s_waitcnt lgkmcnt(5)
    v_mfma_f32_32x32x16_bf16 v[192:207], v[252:255], v[156:159], v[192:207]
    ds_read_b128 v[244:247], v33 offset:40960
    v_add_f32 v11, v11, v167
    v_cvt_pk_bf16_f32 v163, v166, v167
    v_exp_f32 v168, v168
    s_waitcnt lgkmcnt(5)
    v_mfma_f32_32x32x16_bf16 v[208:223], v[224:227], v[128:131], v[48:63]
    ds_read_b128 v[248:251], v34 offset:40960
    v_exp_f32 v169, v169
    v_exp_f32 v170, v170
    v_exp_f32 v171, v171
    s_waitcnt lgkmcnt(5)
    v_mfma_f32_32x32x16_bf16 v[208:223], v[228:231], v[132:135], v[208:223]
    ds_read_b128 v[252:255], v35 offset:40960
    v_exp_f32 v172, v172
    v_exp_f32 v173, v173
    s_waitcnt lgkmcnt(5)
    v_mfma_f32_32x32x16_bf16 v[208:223], v[232:235], v[136:139], v[208:223]
    ds_read_b64_tr_b16 v[224:225], v36 offset:0
    ds_read_b64_tr_b16 v[226:227], v36 offset:1024
    v_exp_f32 v174, v174
    v_exp_f32 v175, v175
    s_nop 0
    s_waitcnt lgkmcnt(6)
    v_mfma_f32_32x32x16_bf16 v[208:223], v[236:239], v[140:143], v[208:223]
    ds_read_b64_tr_b16 v[228:229], v37 offset:0
    ds_read_b64_tr_b16 v[230:231], v37 offset:1024
    v_add_f32 v10, v10, v168
    v_add_f32 v11, v11, v169
    v_cvt_pk_bf16_f32 v164, v168, v169
    s_waitcnt lgkmcnt(7)
    v_mfma_f32_32x32x16_bf16 v[208:223], v[240:243], v[144:147], v[208:223]
    ds_read_b64_tr_b16 v[232:233], v38 offset:0
    ds_read_b64_tr_b16 v[234:235], v38 offset:1024
    v_add_f32 v10, v10, v170
    v_add_f32 v11, v11, v171
    s_waitcnt lgkmcnt(8)
    v_mfma_f32_32x32x16_bf16 v[208:223], v[244:247], v[148:151], v[208:223]
    ds_read_b64_tr_b16 v[236:237], v39 offset:0
    ds_read_b64_tr_b16 v[238:239], v39 offset:1024
    v_cvt_pk_bf16_f32 v165, v170, v171
    v_add_f32 v10, v10, v172
    v_add_f32 v11, v11, v173
    s_waitcnt lgkmcnt(9)
    v_mfma_f32_32x32x16_bf16 v[208:223], v[248:251], v[152:155], v[208:223]
    ds_read_b64_tr_b16 v[240:241], v36 offset:4096
    ds_read_b64_tr_b16 v[242:243], v36 offset:5120
    v_cvt_pk_bf16_f32 v166, v172, v173
    v_add_f32 v10, v10, v174
    v_add_f32 v11, v11, v175
    s_waitcnt lgkmcnt(10)
    v_mfma_f32_32x32x16_bf16 v[208:223], v[252:255], v[156:159], v[208:223]
    ds_read_b64_tr_b16 v[244:245], v37 offset:4096
    ds_read_b64_tr_b16 v[246:247], v37 offset:5120
    v_cvt_pk_bf16_f32 v167, v174, v175
    s_nop 1
    s_waitcnt lgkmcnt(10)
    v_mfma_f32_32x32x16_bf16 v[64:79], v[224:227], v[160:163], 0
    ds_read_b64_tr_b16 v[248:249], v38 offset:4096
    ds_read_b64_tr_b16 v[250:251], v38 offset:5120
    v_exp_f32 v176, v176
    v_exp_f32 v177, v177
    v_exp_f32 v178, v178
    v_exp_f32 v179, v179
    s_waitcnt lgkmcnt(10)
    v_mfma_f32_32x32x16_bf16 v[80:95], v[228:231], v[160:163], 0
    ds_read_b64_tr_b16 v[252:253], v39 offset:4096
    ds_read_b64_tr_b16 v[254:255], v39 offset:5120
    v_exp_f32 v180, v180
    v_exp_f32 v181, v181
    v_exp_f32 v182, v182
    v_exp_f32 v183, v183
    s_waitcnt lgkmcnt(10)
    v_mfma_f32_32x32x16_bf16 v[96:111], v[232:235], v[160:163], 0
    ds_read_b64_tr_b16 v[224:225], v36 offset:8192
    ds_read_b64_tr_b16 v[226:227], v36 offset:9216
    s_nop 0
    v_add_f32 v10, v10, v176
    v_add_f32 v11, v11, v177
    s_waitcnt lgkmcnt(10)
    v_mfma_f32_32x32x16_bf16 v[112:127], v[236:239], v[160:163], 0
    ds_read_b64_tr_b16 v[228:229], v37 offset:8192
    ds_read_b64_tr_b16 v[230:231], v37 offset:9216
    v_cvt_pk_bf16_f32 v168, v176, v177
    v_add_f32 v10, v10, v178
    v_add_f32 v11, v11, v179
    v_cvt_pk_bf16_f32 v169, v178, v179
    s_waitcnt lgkmcnt(10)
    v_mfma_f32_32x32x16_bf16 v[64:79], v[240:243], v[164:167], v[64:79]
    ds_read_b64_tr_b16 v[232:233], v38 offset:8192
    ds_read_b64_tr_b16 v[234:235], v38 offset:9216
    v_add_f32 v10, v10, v180
    v_add_f32 v11, v11, v181
    v_cvt_pk_bf16_f32 v170, v180, v181
    v_add_f32 v10, v10, v182
    s_waitcnt lgkmcnt(10)
    v_mfma_f32_32x32x16_bf16 v[80:95], v[244:247], v[164:167], v[80:95]
    ds_read_b64_tr_b16 v[236:237], v39 offset:8192
    ds_read_b64_tr_b16 v[238:239], v39 offset:9216
    v_add_f32 v11, v11, v183
    v_cvt_pk_bf16_f32 v171, v182, v183
    s_nop 1
    s_waitcnt lgkmcnt(10)
    v_mfma_f32_32x32x16_bf16 v[96:111], v[248:251], v[164:167], v[96:111]
    ds_read_b64_tr_b16 v[240:241], v36 offset:12288
    ds_read_b64_tr_b16 v[242:243], v36 offset:13312
    v_exp_f32 v184, v184
    v_exp_f32 v185, v185
    v_exp_f32 v186, v186
    v_exp_f32 v187, v187
    s_waitcnt lgkmcnt(10)
    v_mfma_f32_32x32x16_bf16 v[112:127], v[252:255], v[164:167], v[112:127]
    ds_read_b64_tr_b16 v[244:245], v37 offset:12288
    ds_read_b64_tr_b16 v[246:247], v37 offset:13312
    v_exp_f32 v188, v188
    v_exp_f32 v189, v189
    v_exp_f32 v190, v190
    s_waitcnt lgkmcnt(10)
    v_mfma_f32_32x32x16_bf16 v[64:79], v[224:227], v[168:171], v[64:79]
    ds_read_b64_tr_b16 v[248:249], v38 offset:12288
    ds_read_b64_tr_b16 v[250:251], v38 offset:13312
    v_exp_f32 v191, v191
    s_nop 0
    v_add_f32 v10, v10, v184
    v_add_f32 v11, v11, v185
    v_cvt_pk_bf16_f32 v172, v184, v185
    s_waitcnt lgkmcnt(10)
    v_mfma_f32_32x32x16_bf16 v[80:95], v[228:231], v[168:171], v[80:95]
    ds_read_b64_tr_b16 v[252:253], v39 offset:12288
    ds_read_b64_tr_b16 v[254:255], v39 offset:13312
    v_add_f32 v10, v10, v186
    v_add_f32 v11, v11, v187
    v_cvt_pk_bf16_f32 v173, v186, v187
    v_add_f32 v10, v10, v188
    s_waitcnt lgkmcnt(10)
    v_mfma_f32_32x32x16_bf16 v[96:111], v[232:235], v[168:171], v[96:111]
    v_add_f32 v11, v11, v189
    v_cvt_pk_bf16_f32 v174, v188, v189
    v_add_f32 v10, v10, v190
    v_add_f32 v11, v11, v191
    s_waitcnt lgkmcnt(8)
    v_mfma_f32_32x32x16_bf16 v[112:127], v[236:239], v[168:171], v[112:127]
    v_cvt_pk_bf16_f32 v175, v190, v191
    v_add_f32 v10, v10, v11
    v_mov_b32 v44, v10
    s_nop 1
    s_waitcnt vmcnt(2)
    s_barrier
    s_mov_b32 s46, 65536
    s_add_u32 m0, s47, 147456
    s_nop 0
    buffer_load_dwordx4 v40, s[20:23], s46 offen lds
    buffer_load_dwordx4 v41, s[20:23], s46 offen offset:1024 lds
    s_mov_b32 s46, 32768
    s_add_u32 m0, s47, 98304
    s_nop 0
    buffer_load_dwordx4 v42, s[24:27], s46 offen lds
    buffer_load_dwordx4 v42, s[24:27], s46 offen offset:1024 lds
    ds_read_b128 v[224:227], v28 offset:0
    ds_read_b128 v[228:231], v29 offset:0
    s_waitcnt lgkmcnt(8)
    v_mfma_f32_32x32x16_bf16 v[64:79], v[240:243], v[172:175], v[64:79]
    ds_read_b128 v[232:235], v30 offset:0
    v_max3_f32 v2, v192, v193, v194
    v_max3_f32 v3, v195, v196, v197
    v_max3_f32 v2, v2, v198, v199
    v_max3_f32 v3, v3, v200, v201
    v_max3_f32 v2, v2, v202, v203
    v_max3_f32 v3, v3, v204, v205
    s_waitcnt lgkmcnt(7)
    v_mfma_f32_32x32x16_bf16 v[80:95], v[244:247], v[172:175], v[80:95]
    ds_read_b128 v[236:239], v31 offset:0
    v_max3_f32 v2, v2, v206, v207
    v_max3_f32 v3, v3, v208, v209
    v_max3_f32 v2, v2, v210, v211
    v_max3_f32 v3, v3, v212, v213
    v_max3_f32 v2, v2, v214, v215
    v_max3_f32 v3, v3, v216, v217
    s_waitcnt lgkmcnt(6)
    v_mfma_f32_32x32x16_bf16 v[96:111], v[248:251], v[172:175], v[96:111]
    ds_read_b128 v[240:243], v32 offset:0
    v_max3_f32 v2, v2, v218, v219
    v_max3_f32 v3, v3, v220, v221
    v_max3_f32 v2, v2, v222, v223
    v_max_f32 v2, v2, v3
    v_mov_b32 v3, v2
    s_nop 1
    s_waitcnt lgkmcnt(5)
    v_mfma_f32_32x32x16_bf16 v[112:127], v[252:255], v[172:175], v[112:127]
    ds_read_b128 v[244:247], v33 offset:0
    v_permlane32_swap_b32 v2, v3
    s_nop 1
    v_max_f32 v2, v2, v3
    v_cmp_lt_f32 vcc, 0xc29c0000, v2
    s_mov_b64 s[64:65], vcc
    s_cbranch_vccz .Lk1_nors_1
    v_add_f32 v2, 0x42d80000, v2
    v_max_f32 v2, 0, v2
    v_sub_f32 v46, 0, v2
    v_exp_f32 v46, v46
    v_sub_f32 v48, v48, v2
    v_sub_f32 v49, v49, v2
    v_sub_f32 v50, v50, v2
    v_sub_f32 v51, v51, v2
    v_sub_f32 v52, v52, v2
    v_sub_f32 v53, v53, v2
    v_sub_f32 v54, v54, v2
    v_sub_f32 v55, v55, v2
    v_sub_f32 v56, v56, v2
    v_sub_f32 v57, v57, v2
    v_sub_f32 v58, v58, v2
    v_sub_f32 v59, v59, v2
    v_sub_f32 v60, v60, v2
    v_sub_f32 v61, v61, v2
    v_sub_f32 v62, v62, v2
    v_sub_f32 v63, v63, v2
    v_sub_f32 v192, v192, v2
    v_sub_f32 v193, v193, v2
    v_sub_f32 v194, v194, v2
    v_sub_f32 v195, v195, v2
    v_sub_f32 v196, v196, v2
    v_sub_f32 v197, v197, v2
    v_sub_f32 v198, v198, v2
    v_sub_f32 v199, v199, v2
    v_sub_f32 v200, v200, v2
    v_sub_f32 v201, v201, v2
    v_sub_f32 v202, v202, v2
    v_sub_f32 v203, v203, v2
    v_sub_f32 v204, v204, v2
    v_sub_f32 v205, v205, v2
    v_sub_f32 v206, v206, v2
    v_sub_f32 v207, v207, v2
    v_sub_f32 v208, v208, v2
    v_sub_f32 v209, v209, v2
    v_sub_f32 v210, v210, v2
    v_sub_f32 v211, v211, v2
    v_sub_f32 v212, v212, v2
    v_sub_f32 v213, v213, v2
    v_sub_f32 v214, v214, v2
    v_sub_f32 v215, v215, v2
    v_sub_f32 v216, v216, v2
    v_sub_f32 v217, v217, v2
    v_sub_f32 v218, v218, v2
    v_sub_f32 v219, v219, v2
    v_sub_f32 v220, v220, v2
    v_sub_f32 v221, v221, v2
    v_sub_f32 v222, v222, v2
    v_sub_f32 v223, v223, v2
    v_mul_f32 v44, v44, v46
.Lk1_nors_1:
    s_waitcnt lgkmcnt(5)
    v_mfma_f32_32x32x16_bf16 v[160:175], v[224:227], v[128:131], v[48:63]
    ds_read_b128 v[248:251], v34 offset:0
    v_exp_f32 v192, v192
    v_exp_f32 v193, v193
    v_exp_f32 v194, v194
    s_waitcnt lgkmcnt(5)
    v_mfma_f32_32x32x16_bf16 v[160:175], v[228:231], v[132:135], v[160:175]
    ds_read_b128 v[252:255], v35 offset:0
    v_exp_f32 v195, v195
    v_exp_f32 v196, v196
    v_exp_f32 v197, v197
    s_waitcnt lgkmcnt(5)
    v_mfma_f32_32x32x16_bf16 v[160:175], v[232:235], v[136:139], v[160:175]
    ds_read_b128 v[224:227], v28 offset:8192
    v_exp_f32 v198, v198
    v_exp_f32 v199, v199
    s_nop 0
    s_waitcnt lgkmcnt(5)
    v_mfma_f32_32x32x16_bf16 v[160:175], v[236:239], v[140:143], v[160:175]
    ds_read_b128 v[228:231], v29 offset:8192
    v_mov_b32 v10, v192
    v_mov_b32 v11, v193
    s_waitcnt lgkmcnt(5)
    v_mfma_f32_32x32x16_bf16 v[160:175], v[240:243], v[144:147], v[160:175]
    ds_read_b128 v[232:235], v30 offset:8192
    v_cvt_pk_bf16_f32 v192, v192, v193
    v_add_f32 v10, v10, v194
    v_add_f32 v11, v11, v195
    s_waitcnt lgkmcnt(5)
    v_mfma_f32_32x32x16_bf16 v[160:175], v[244:247], v[148:151], v[160:175]
    ds_read_b128 v[236:239], v31 offset:8192
    v_cvt_pk_bf16_f32 v193, v194, v195
    v_add_f32 v10, v10, v196
    v_add_f32 v11, v11, v197
    s_waitcnt lgkmcnt(5)
    v_mfma_f32_32x32x16_bf16 v[160:175], v[248:251], v[152:155], v[160:175]
    ds_read_b128 v[240:243], v32 offset:8192
    v_cvt_pk_bf16_f32 v194, v196, v197
    v_add_f32 v10, v10, v198
    v_add_f32 v11, v11, v199
    s_waitcnt lgkmcnt(5)
    v_mfma_f32_32x32x16_bf16 v[160:175], v[252:255], v[156:159], v[160:175]
    ds_read_b128 v[244:247], v33 offset:8192
    v_cvt_pk_bf16_f32 v195, v198, v199
    s_cmp_eq_u64 s[64:65], 0
    s_cbranch_scc1 .Lk1_nors2_1
    v_mul_f32 v64, v46, v64
    v_mul_f32 v65, v46, v65
    v_mul_f32 v66, v46, v66
    v_mul_f32 v67, v46, v67
    v_mul_f32 v68, v46, v68
    v_mul_f32 v69, v46, v69
    v_mul_f32 v70, v46, v70
    v_mul_f32 v71, v46, v71
    v_mul_f32 v72, v46, v72
    v_mul_f32 v73, v46, v73
    v_mul_f32 v74, v46, v74
    v_mul_f32 v75, v46, v75
    v_mul_f32 v76, v46, v76
    v_mul_f32 v77, v46, v77
    v_mul_f32 v78, v46, v78
    v_mul_f32 v79, v46, v79
    v_mul_f32 v80, v46, v80
    v_mul_f32 v81, v46, v81
    v_mul_f32 v82, v46, v82
    v_mul_f32 v83, v46, v83
    v_mul_f32 v84, v46, v84
    v_mul_f32 v85, v46, v85
    v_mul_f32 v86, v46, v86
    v_mul_f32 v87, v46, v87
    v_mul_f32 v88, v46, v88
    v_mul_f32 v89, v46, v89
    v_mul_f32 v90, v46, v90
    v_mul_f32 v91, v46, v91
    v_mul_f32 v92, v46, v92
    v_mul_f32 v93, v46, v93
    v_mul_f32 v94, v46, v94
    v_mul_f32 v95, v46, v95
    v_mul_f32 v96, v46, v96
    v_mul_f32 v97, v46, v97
    v_mul_f32 v98, v46, v98
    v_mul_f32 v99, v46, v99
    v_mul_f32 v100, v46, v100
    v_mul_f32 v101, v46, v101
    v_mul_f32 v102, v46, v102
    v_mul_f32 v103, v46, v103
    v_mul_f32 v104, v46, v104
    v_mul_f32 v105, v46, v105
    v_mul_f32 v106, v46, v106
    v_mul_f32 v107, v46, v107
    v_mul_f32 v108, v46, v108
    v_mul_f32 v109, v46, v109
    v_mul_f32 v110, v46, v110
    v_mul_f32 v111, v46, v111
    v_mul_f32 v112, v46, v112
    v_mul_f32 v113, v46, v113
    v_mul_f32 v114, v46, v114
    v_mul_f32 v115, v46, v115
    v_mul_f32 v116, v46, v116
    v_mul_f32 v117, v46, v117
    v_mul_f32 v118, v46, v118
    v_mul_f32 v119, v46, v119
    v_mul_f32 v120, v46, v120
    v_mul_f32 v121, v46, v121
    v_mul_f32 v122, v46, v122
    v_mul_f32 v123, v46, v123
    v_mul_f32 v124, v46, v124
    v_mul_f32 v125, v46, v125
    v_mul_f32 v126, v46, v126
    v_mul_f32 v127, v46, v127
.Lk1_nors2_1:
    s_waitcnt lgkmcnt(5)
    v_mfma_f32_32x32x16_bf16 v[176:191], v[224:227], v[128:131], v[48:63]
    ds_read_b128 v[248:251], v34 offset:8192
    v_exp_f32 v200, v200
    v_exp_f32 v201, v201
    v_exp_f32 v202, v202
    s_waitcnt lgkmcnt(5)
    v_mfma_f32_32x32x16_bf16 v[176:191], v[228:231], v[132:135], v[176:191]
    ds_read_b128 v[252:255], v35 offset:8192
    v_exp_f32 v203, v203
    v_exp_f32 v204, v204
    v_exp_f32 v205, v205
    s_waitcnt lgkmcnt(5)
    v_mfma_f32_32x32x16_bf16 v[176:191], v[232:235], v[136:139], v[176:191]
    ds_read_b64_tr_b16 v[224:225], v36 offset:16384
    ds_read_b64_tr_b16 v[226:227], v36 offset:17408
    v_exp_f32 v206, v206
    v_exp_f32 v207, v207
    s_nop 0
    s_waitcnt lgkmcnt(6)
    v_mfma_f32_32x32x16_bf16 v[176:191], v[236:239], v[140:143], v[176:191]
    ds_read_b64_tr_b16 v[228:229], v37 offset:16384
    ds_read_b64_tr_b16 v[230:231], v37 offset:17408
    v_add_f32 v10, v10, v200
    v_add_f32 v11, v11, v201
    s_waitcnt lgkmcnt(7)
    v_mfma_f32_32x32x16_bf16 v[176:191], v[240:243], v[144:147], v[176:191]
    ds_read_b64_tr_b16 v[232:233], v38 offset:16384
    ds_read_b64_tr_b16 v[234:235], v38 offset:17408
    v_cvt_pk_bf16_f32 v196, v200, v201
    v_add_f32 v10, v10, v202
    v_add_f32 v11, v11, v203
    s_waitcnt lgkmcnt(8)
    v_mfma_f32_32x32x16_bf16 v[176:191], v[244:247], v[148:151], v[176:191]
    ds_read_b64_tr_b16 v[236:237], v39 offset:16384
    ds_read_b64_tr_b16 v[238:239], v39 offset:17408
    v_cvt_pk_bf16_f32 v197, v202, v203
    v_add_f32 v10, v10, v204
    v_add_f32 v11, v11, v205
    s_waitcnt lgkmcnt(9)
    v_mfma_f32_32x32x16_bf16 v[176:191], v[248:251], v[152:155], v[176:191]
    ds_read_b64_tr_b16 v[240:241], v36 offset:20480
    ds_read_b64_tr_b16 v[242:243], v36 offset:21504
    v_cvt_pk_bf16_f32 v198, v204, v205
    v_add_f32 v10, v10, v206
    v_add_f32 v11, v11, v207
    s_waitcnt lgkmcnt(10)
    v_mfma_f32_32x32x16_bf16 v[176:191], v[252:255], v[156:159], v[176:191]
    ds_read_b64_tr_b16 v[244:245], v37 offset:20480
    ds_read_b64_tr_b16 v[246:247], v37 offset:21504
    v_cvt_pk_bf16_f32 v199, v206, v207
    s_nop 1
    s_waitcnt lgkmcnt(10)
    v_mfma_f32_32x32x16_bf16 v[64:79], v[224:227], v[192:195], v[64:79]
    ds_read_b64_tr_b16 v[248:249], v38 offset:20480
    ds_read_b64_tr_b16 v[250:251], v38 offset:21504
    v_exp_f32 v208, v208
    v_exp_f32 v209, v209
    v_exp_f32 v210, v210
    v_exp_f32 v211, v211
    s_waitcnt lgkmcnt(10)
    v_mfma_f32_32x32x16_bf16 v[80:95], v[228:231], v[192:195], v[80:95]
    ds_read_b64_tr_b16 v[252:253], v39 offset:20480
    ds_read_b64_tr_b16 v[254:255], v39 offset:21504
    v_exp_f32 v212, v212
    v_exp_f32 v213, v213
    v_exp_f32 v214, v214
    v_exp_f32 v215, v215
    s_waitcnt lgkmcnt(10)
    v_mfma_f32_32x32x16_bf16 v[96:111], v[232:235], v[192:195], v[96:111]
    ds_read_b64_tr_b16 v[224:225], v36 offset:24576
    ds_read_b64_tr_b16 v[226:227], v36 offset:25600
    s_nop 0
    v_add_f32 v10, v10, v208
    v_add_f32 v11, v11, v209
    s_waitcnt lgkmcnt(10)
    v_mfma_f32_32x32x16_bf16 v[112:127], v[236:239], v[192:195], v[112:127]
    ds_read_b64_tr_b16 v[228:229], v37 offset:24576
    ds_read_b64_tr_b16 v[230:231], v37 offset:25600
    v_cvt_pk_bf16_f32 v200, v208, v209
    v_add_f32 v10, v10, v210
    v_add_f32 v11, v11, v211
    v_cvt_pk_bf16_f32 v201, v210, v211
    s_waitcnt lgkmcnt(10)
    v_mfma_f32_32x32x16_bf16 v[64:79], v[240:243], v[196:199], v[64:79]
    ds_read_b64_tr_b16 v[232:233], v38 offset:24576
    ds_read_b64_tr_b16 v[234:235], v38 offset:25600
    v_add_f32 v10, v10, v212
    v_add_f32 v11, v11, v213
    v_cvt_pk_bf16_f32 v202, v212, v213
    v_add_f32 v10, v10, v214
    s_waitcnt lgkmcnt(10)
    v_mfma_f32_32x32x16_bf16 v[80:95], v[244:247], v[196:199], v[80:95]
    ds_read_b64_tr_b16 v[236:237], v39 offset:24576
    ds_read_b64_tr_b16 v[238:239], v39 offset:25600
    v_add_f32 v11, v11, v215
    v_cvt_pk_bf16_f32 v203, v214, v215
    s_nop 1
    s_waitcnt lgkmcnt(10)
    v_mfma_f32_32x32x16_bf16 v[96:111], v[248:251], v[196:199], v[96:111]
    ds_read_b64_tr_b16 v[240:241], v36 offset:28672
    ds_read_b64_tr_b16 v[242:243], v36 offset:29696
    v_exp_f32 v216, v216
    v_exp_f32 v217, v217
    v_exp_f32 v218, v218
    v_exp_f32 v219, v219
    s_waitcnt lgkmcnt(10)
    v_mfma_f32_32x32x16_bf16 v[112:127], v[252:255], v[196:199], v[112:127]
    ds_read_b64_tr_b16 v[244:245], v37 offset:28672
    ds_read_b64_tr_b16 v[246:247], v37 offset:29696
    v_exp_f32 v220, v220
    v_exp_f32 v221, v221
    v_exp_f32 v222, v222
    s_waitcnt lgkmcnt(10)
    v_mfma_f32_32x32x16_bf16 v[64:79], v[224:227], v[200:203], v[64:79]
    ds_read_b64_tr_b16 v[248:249], v38 offset:28672
    ds_read_b64_tr_b16 v[250:251], v38 offset:29696
    v_exp_f32 v223, v223
    s_nop 0
    v_add_f32 v10, v10, v216
    v_add_f32 v11, v11, v217
    v_cvt_pk_bf16_f32 v204, v216, v217
    s_waitcnt lgkmcnt(10)
    v_mfma_f32_32x32x16_bf16 v[80:95], v[228:231], v[200:203], v[80:95]
    ds_read_b64_tr_b16 v[252:253], v39 offset:28672
    ds_read_b64_tr_b16 v[254:255], v39 offset:29696
    v_add_f32 v10, v10, v218
    v_add_f32 v11, v11, v219
    v_cvt_pk_bf16_f32 v205, v218, v219
    v_add_f32 v10, v10, v220
    s_waitcnt lgkmcnt(10)
    v_mfma_f32_32x32x16_bf16 v[96:111], v[232:235], v[200:203], v[96:111]
    v_add_f32 v11, v11, v221
    v_cvt_pk_bf16_f32 v206, v220, v221
    v_add_f32 v10, v10, v222
    v_add_f32 v11, v11, v223
    s_waitcnt lgkmcnt(8)
    v_mfma_f32_32x32x16_bf16 v[112:127], v[236:239], v[200:203], v[112:127]
    v_cvt_pk_bf16_f32 v207, v222, v223
    v_add_f32 v10, v10, v11
    v_add_f32 v44, v44, v10
    s_nop 1
    s_waitcnt vmcnt(4)
    s_waitcnt vmcnt(0)
    s_barrier
    s_mov_b32 s46, 81920
    s_add_u32 m0, s47, 114688
    s_nop 0
    buffer_load_dwordx4 v40, s[20:23], s46 offen lds
    buffer_load_dwordx4 v41, s[20:23], s46 offen offset:1024 lds
    s_mov_b32 s46, 49152
    s_add_u32 m0, s47, 65536
    s_nop 0
    buffer_load_dwordx4 v42, s[24:27], s46 offen lds
    buffer_load_dwordx4 v42, s[24:27], s46 offen offset:1024 lds
    ds_read_b128 v[224:227], v28 offset:16384
    ds_read_b128 v[228:231], v29 offset:16384
    s_waitcnt lgkmcnt(8)
    v_mfma_f32_32x32x16_bf16 v[64:79], v[240:243], v[204:207], v[64:79]
    ds_read_b128 v[232:235], v30 offset:16384
    v_max3_f32 v2, v160, v161, v162
    v_max3_f32 v3, v163, v164, v165
    v_max3_f32 v2, v2, v166, v167
    v_max3_f32 v3, v3, v168, v169
    v_max3_f32 v2, v2, v170, v171
    v_max3_f32 v3, v3, v172, v173
    s_waitcnt lgkmcnt(7)
    v_mfma_f32_32x32x16_bf16 v[80:95], v[244:247], v[204:207], v[80:95]
    ds_read_b128 v[236:239], v31 offset:16384
    v_max3_f32 v2, v2, v174, v175
    v_max3_f32 v3, v3, v176, v177
    v_max3_f32 v2, v2, v178, v179
    v_max3_f32 v3, v3, v180, v181
    v_max3_f32 v2, v2, v182, v183
    v_max3_f32 v3, v3, v184, v185
    s_waitcnt lgkmcnt(6)
    v_mfma_f32_32x32x16_bf16 v[96:111], v[248:251], v[204:207], v[96:111]
    ds_read_b128 v[240:243], v32 offset:16384
    v_max3_f32 v2, v2, v186, v187
    v_max3_f32 v3, v3, v188, v189
    v_max3_f32 v2, v2, v190, v191
    v_max_f32 v2, v2, v3
    v_mov_b32 v3, v2
    s_nop 1
    s_waitcnt lgkmcnt(5)
    v_mfma_f32_32x32x16_bf16 v[112:127], v[252:255], v[204:207], v[112:127]
    ds_read_b128 v[244:247], v33 offset:16384
    v_permlane32_swap_b32 v2, v3
    s_nop 1
    v_max_f32 v2, v2, v3
    v_cmp_lt_f32 vcc, 0xc29c0000, v2
    s_mov_b64 s[64:65], vcc
    s_cbranch_vccz .Lk1_nors_2
    v_add_f32 v2, 0x42d80000, v2
    v_max_f32 v2, 0, v2
    v_sub_f32 v46, 0, v2
    v_exp_f32 v46, v46
    v_sub_f32 v48, v48, v2
    v_sub_f32 v49, v49, v2
    v_sub_f32 v50, v50, v2
    v_sub_f32 v51, v51, v2
    v_sub_f32 v52, v52, v2
    v_sub_f32 v53, v53, v2
    v_sub_f32 v54, v54, v2
    v_sub_f32 v55, v55, v2
    v_sub_f32 v56, v56, v2
    v_sub_f32 v57, v57, v2
    v_sub_f32 v58, v58, v2
    v_sub_f32 v59, v59, v2
    v_sub_f32 v60, v60, v2
    v_sub_f32 v61, v61, v2
    v_sub_f32 v62, v62, v2
    v_sub_f32 v63, v63, v2
    v_sub_f32 v160, v160, v2
    v_sub_f32 v161, v161, v2
    v_sub_f32 v162, v162, v2
    v_sub_f32 v163, v163, v2
    v_sub_f32 v164, v164, v2
    v_sub_f32 v165, v165, v2
    v_sub_f32 v166, v166, v2
    v_sub_f32 v167, v167, v2
    v_sub_f32 v168, v168, v2
    v_sub_f32 v169, v169, v2
    v_sub_f32 v170, v170, v2
    v_sub_f32 v171, v171, v2
    v_sub_f32 v172, v172, v2
    v_sub_f32 v173, v173, v2
    v_sub_f32 v174, v174, v2
    v_sub_f32 v175, v175, v2
    v_sub_f32 v176, v176, v2
    v_sub_f32 v177, v177, v2
    v_sub_f32 v178, v178, v2
    v_sub_f32 v179, v179, v2
    v_sub_f32 v180, v180, v2
    v_sub_f32 v181, v181, v2
    v_sub_f32 v182, v182, v2
    v_sub_f32 v183, v183, v2
    v_sub_f32 v184, v184, v2
    v_sub_f32 v185, v185, v2
    v_sub_f32 v186, v186, v2
    v_sub_f32 v187, v187, v2
    v_sub_f32 v188, v188, v2
    v_sub_f32 v189, v189, v2
    v_sub_f32 v190, v190, v2
    v_sub_f32 v191, v191, v2
    v_mul_f32 v44, v44, v46
.Lk1_nors_2:
    s_waitcnt lgkmcnt(5)
    v_mfma_f32_32x32x16_bf16 v[192:207], v[224:227], v[128:131], v[48:63]
    ds_read_b128 v[248:251], v34 offset:16384
    v_exp_f32 v160, v160
    v_exp_f32 v161, v161
    v_exp_f32 v162, v162
    s_waitcnt lgkmcnt(5)
    v_mfma_f32_32x32x16_bf16 v[192:207], v[228:231], v[132:135], v[192:207]
    ds_read_b128 v[252:255], v35 offset:16384
    v_exp_f32 v163, v163
    v_exp_f32 v164, v164
    v_exp_f32 v165, v165
    s_waitcnt lgkmcnt(5)
    v_mfma_f32_32x32x16_bf16 v[192:207], v[232:235], v[136:139], v[192:207]
    ds_read_b128 v[224:227], v28 offset:24576
    v_exp_f32 v166, v166
    v_exp_f32 v167, v167
    s_nop 0
    s_waitcnt lgkmcnt(5)
    v_mfma_f32_32x32x16_bf16 v[192:207], v[236:239], v[140:143], v[192:207]
    ds_read_b128 v[228:231], v29 offset:24576
    v_mov_b32 v10, v160
    v_mov_b32 v11, v161
    s_waitcnt lgkmcnt(5)
    v_mfma_f32_32x32x16_bf16 v[192:207], v[240:243], v[144:147], v[192:207]
    ds_read_b128 v[232:235], v30 offset:24576
    v_cvt_pk_bf16_f32 v160, v160, v161
    v_add_f32 v10, v10, v162
    v_add_f32 v11, v11, v163
    s_waitcnt lgkmcnt(5)
    v_mfma_f32_32x32x16_bf16 v[192:207], v[244:247], v[148:151], v[192:207]
    ds_read_b128 v[236:239], v31 offset:24576
    v_cvt_pk_bf16_f32 v161, v162, v163
    v_add_f32 v10, v10, v164
    v_add_f32 v11, v11, v165
    s_waitcnt lgkmcnt(5)
    v_mfma_f32_32x32x16_bf16 v[192:207], v[248:251], v[152:155], v[192:207]
    ds_read_b128 v[240:243], v32 offset:24576
    v_cvt_pk_bf16_f32 v162, v164, v165
    v_add_f32 v10, v10, v166
    v_add_f32 v11, v11, v167
    s_waitcnt lgkmcnt(5)
    v_mfma_f32_32x32x16_bf16 v[192:207], v[252:255], v[156:159], v[192:207]
    ds_read_b128 v[244:247], v33 offset:24576
    v_cvt_pk_bf16_f32 v163, v166, v167
    s_cmp_eq_u64 s[64:65], 0
    s_cbranch_scc1 .Lk1_nors2_2
    v_mul_f32 v64, v46, v64
    v_mul_f32 v65, v46, v65
    v_mul_f32 v66, v46, v66
    v_mul_f32 v67, v46, v67
    v_mul_f32 v68, v46, v68
    v_mul_f32 v69, v46, v69
    v_mul_f32 v70, v46, v70
    v_mul_f32 v71, v46, v71
    v_mul_f32 v72, v46, v72
    v_mul_f32 v73, v46, v73
    v_mul_f32 v74, v46, v74
    v_mul_f32 v75, v46, v75
    v_mul_f32 v76, v46, v76
    v_mul_f32 v77, v46, v77
    v_mul_f32 v78, v46, v78
    v_mul_f32 v79, v46, v79
    v_mul_f32 v80, v46, v80
    v_mul_f32 v81, v46, v81
    v_mul_f32 v82, v46, v82
    v_mul_f32 v83, v46, v83
    v_mul_f32 v84, v46, v84
    v_mul_f32 v85, v46, v85
    v_mul_f32 v86, v46, v86
    v_mul_f32 v87, v46, v87
    v_mul_f32 v88, v46, v88
    v_mul_f32 v89, v46, v89
    v_mul_f32 v90, v46, v90
    v_mul_f32 v91, v46, v91
    v_mul_f32 v92, v46, v92
    v_mul_f32 v93, v46, v93
    v_mul_f32 v94, v46, v94
    v_mul_f32 v95, v46, v95
    v_mul_f32 v96, v46, v96
    v_mul_f32 v97, v46, v97
    v_mul_f32 v98, v46, v98
    v_mul_f32 v99, v46, v99
    v_mul_f32 v100, v46, v100
    v_mul_f32 v101, v46, v101
    v_mul_f32 v102, v46, v102
    v_mul_f32 v103, v46, v103
    v_mul_f32 v104, v46, v104
    v_mul_f32 v105, v46, v105
    v_mul_f32 v106, v46, v106
    v_mul_f32 v107, v46, v107
    v_mul_f32 v108, v46, v108
    v_mul_f32 v109, v46, v109
    v_mul_f32 v110, v46, v110
    v_mul_f32 v111, v46, v111
    v_mul_f32 v112, v46, v112
    v_mul_f32 v113, v46, v113
    v_mul_f32 v114, v46, v114
    v_mul_f32 v115, v46, v115
    v_mul_f32 v116, v46, v116
    v_mul_f32 v117, v46, v117
    v_mul_f32 v118, v46, v118
    v_mul_f32 v119, v46, v119
    v_mul_f32 v120, v46, v120
    v_mul_f32 v121, v46, v121
    v_mul_f32 v122, v46, v122
    v_mul_f32 v123, v46, v123
    v_mul_f32 v124, v46, v124
    v_mul_f32 v125, v46, v125
    v_mul_f32 v126, v46, v126
    v_mul_f32 v127, v46, v127
.Lk1_nors2_2:
    s_waitcnt lgkmcnt(5)
    v_mfma_f32_32x32x16_bf16 v[208:223], v[224:227], v[128:131], v[48:63]
    ds_read_b128 v[248:251], v34 offset:24576
    v_exp_f32 v168, v168
    v_exp_f32 v169, v169
    v_exp_f32 v170, v170
    s_waitcnt lgkmcnt(5)
    v_mfma_f32_32x32x16_bf16 v[208:223], v[228:231], v[132:135], v[208:223]
    ds_read_b128 v[252:255], v35 offset:24576
    v_exp_f32 v171, v171
    v_exp_f32 v172, v172
    v_exp_f32 v173, v173
    s_waitcnt lgkmcnt(5)
    v_mfma_f32_32x32x16_bf16 v[208:223], v[232:235], v[136:139], v[208:223]
    ds_read_b64_tr_b16 v[224:225], v36 offset:32768
    ds_read_b64_tr_b16 v[226:227], v36 offset:33792
    v_exp_f32 v174, v174
    v_exp_f32 v175, v175
    s_nop 0
    s_waitcnt lgkmcnt(6)
    v_mfma_f32_32x32x16_bf16 v[208:223], v[236:239], v[140:143], v[208:223]
    ds_read_b64_tr_b16 v[228:229], v37 offset:32768
    ds_read_b64_tr_b16 v[230:231], v37 offset:33792
    v_add_f32 v10, v10, v168
    v_add_f32 v11, v11, v169
    s_waitcnt lgkmcnt(7)
    v_mfma_f32_32x32x16_bf16 v[208:223], v[240:243], v[144:147], v[208:223]
    ds_read_b64_tr_b16 v[232:233], v38 offset:32768
    ds_read_b64_tr_b16 v[234:235], v38 offset:33792
    v_cvt_pk_bf16_f32 v164, v168, v169
    v_add_f32 v10, v10, v170
    v_add_f32 v11, v11, v171
    s_waitcnt lgkmcnt(8)
    v_mfma_f32_32x32x16_bf16 v[208:223], v[244:247], v[148:151], v[208:223]
    ds_read_b64_tr_b16 v[236:237], v39 offset:32768
    ds_read_b64_tr_b16 v[238:239], v39 offset:33792
    v_cvt_pk_bf16_f32 v165, v170, v171
    v_add_f32 v10, v10, v172
    v_add_f32 v11, v11, v173
    s_waitcnt lgkmcnt(9)
    v_mfma_f32_32x32x16_bf16 v[208:223], v[248:251], v[152:155], v[208:223]
    ds_read_b64_tr_b16 v[240:241], v36 offset:36864
    ds_read_b64_tr_b16 v[242:243], v36 offset:37888
    v_cvt_pk_bf16_f32 v166, v172, v173
    v_add_f32 v10, v10, v174
    v_add_f32 v11, v11, v175
    s_waitcnt lgkmcnt(10)
    v_mfma_f32_32x32x16_bf16 v[208:223], v[252:255], v[156:159], v[208:223]
    ds_read_b64_tr_b16 v[244:245], v37 offset:36864
    ds_read_b64_tr_b16 v[246:247], v37 offset:37888
    v_cvt_pk_bf16_f32 v167, v174, v175
    s_nop 1
    s_waitcnt lgkmcnt(10)
    v_mfma_f32_32x32x16_bf16 v[64:79], v[224:227], v[160:163], v[64:79]
    ds_read_b64_tr_b16 v[248:249], v38 offset:36864
    ds_read_b64_tr_b16 v[250:251], v38 offset:37888
    v_exp_f32 v176, v176
    v_exp_f32 v177, v177
    v_exp_f32 v178, v178
    v_exp_f32 v179, v179
    s_waitcnt lgkmcnt(10)
    v_mfma_f32_32x32x16_bf16 v[80:95], v[228:231], v[160:163], v[80:95]
    ds_read_b64_tr_b16 v[252:253], v39 offset:36864
    ds_read_b64_tr_b16 v[254:255], v39 offset:37888
    v_exp_f32 v180, v180
    v_exp_f32 v181, v181
    v_exp_f32 v182, v182
    v_exp_f32 v183, v183
    s_waitcnt lgkmcnt(10)
    v_mfma_f32_32x32x16_bf16 v[96:111], v[232:235], v[160:163], v[96:111]
    ds_read_b64_tr_b16 v[224:225], v36 offset:40960
    ds_read_b64_tr_b16 v[226:227], v36 offset:41984
    s_nop 0
    v_add_f32 v10, v10, v176
    v_add_f32 v11, v11, v177
    s_waitcnt lgkmcnt(10)
    v_mfma_f32_32x32x16_bf16 v[112:127], v[236:239], v[160:163], v[112:127]
    ds_read_b64_tr_b16 v[228:229], v37 offset:40960
    ds_read_b64_tr_b16 v[230:231], v37 offset:41984
    v_cvt_pk_bf16_f32 v168, v176, v177
    v_add_f32 v10, v10, v178
    v_add_f32 v11, v11, v179
    v_cvt_pk_bf16_f32 v169, v178, v179
    s_waitcnt lgkmcnt(10)
    v_mfma_f32_32x32x16_bf16 v[64:79], v[240:243], v[164:167], v[64:79]
    ds_read_b64_tr_b16 v[232:233], v38 offset:40960
    ds_read_b64_tr_b16 v[234:235], v38 offset:41984
    v_add_f32 v10, v10, v180
    v_add_f32 v11, v11, v181
    v_cvt_pk_bf16_f32 v170, v180, v181
    v_add_f32 v10, v10, v182
    s_waitcnt lgkmcnt(10)
    v_mfma_f32_32x32x16_bf16 v[80:95], v[244:247], v[164:167], v[80:95]
    ds_read_b64_tr_b16 v[236:237], v39 offset:40960
    ds_read_b64_tr_b16 v[238:239], v39 offset:41984
    v_add_f32 v11, v11, v183
    v_cvt_pk_bf16_f32 v171, v182, v183
    s_nop 1
    s_waitcnt lgkmcnt(10)
    v_mfma_f32_32x32x16_bf16 v[96:111], v[248:251], v[164:167], v[96:111]
    ds_read_b64_tr_b16 v[240:241], v36 offset:45056
    ds_read_b64_tr_b16 v[242:243], v36 offset:46080
    v_exp_f32 v184, v184
    v_exp_f32 v185, v185
    v_exp_f32 v186, v186
    v_exp_f32 v187, v187
    s_waitcnt lgkmcnt(10)
    v_mfma_f32_32x32x16_bf16 v[112:127], v[252:255], v[164:167], v[112:127]
    ds_read_b64_tr_b16 v[244:245], v37 offset:45056
    ds_read_b64_tr_b16 v[246:247], v37 offset:46080
    v_exp_f32 v188, v188
    v_exp_f32 v189, v189
    v_exp_f32 v190, v190
    s_waitcnt lgkmcnt(10)
    v_mfma_f32_32x32x16_bf16 v[64:79], v[224:227], v[168:171], v[64:79]
    ds_read_b64_tr_b16 v[248:249], v38 offset:45056
    ds_read_b64_tr_b16 v[250:251], v38 offset:46080
    v_exp_f32 v191, v191
    s_nop 0
    v_add_f32 v10, v10, v184
    v_add_f32 v11, v11, v185
    v_cvt_pk_bf16_f32 v172, v184, v185
    s_waitcnt lgkmcnt(10)
    v_mfma_f32_32x32x16_bf16 v[80:95], v[228:231], v[168:171], v[80:95]
    ds_read_b64_tr_b16 v[252:253], v39 offset:45056
    ds_read_b64_tr_b16 v[254:255], v39 offset:46080
    v_add_f32 v10, v10, v186
    v_add_f32 v11, v11, v187
    v_cvt_pk_bf16_f32 v173, v186, v187
    v_add_f32 v10, v10, v188
    s_waitcnt lgkmcnt(10)
    v_mfma_f32_32x32x16_bf16 v[96:111], v[232:235], v[168:171], v[96:111]
    v_add_f32 v11, v11, v189
    v_cvt_pk_bf16_f32 v174, v188, v189
    v_add_f32 v10, v10, v190
    v_add_f32 v11, v11, v191
    s_waitcnt lgkmcnt(8)
    v_mfma_f32_32x32x16_bf16 v[112:127], v[236:239], v[168:171], v[112:127]
    v_cvt_pk_bf16_f32 v175, v190, v191
    v_add_f32 v10, v10, v11
    v_add_f32 v44, v44, v10
    s_nop 1
    s_waitcnt vmcnt(0)
    s_barrier
    s_mov_b32 s46, 98304
    s_add_u32 m0, s47, 131072
    s_nop 0
    buffer_load_dwordx4 v40, s[20:23], s46 offen lds
    buffer_load_dwordx4 v41, s[20:23], s46 offen offset:1024 lds
    s_mov_b32 s46, 65536
    s_add_u32 m0, s47, 81920
    s_nop 0
    buffer_load_dwordx4 v42, s[24:27], s46 offen lds
    buffer_load_dwordx4 v42, s[24:27], s46 offen offset:1024 lds
    ds_read_b128 v[224:227], v28 offset:32768
    ds_read_b128 v[228:231], v29 offset:32768
    s_waitcnt lgkmcnt(8)
    v_mfma_f32_32x32x16_bf16 v[64:79], v[240:243], v[172:175], v[64:79]
    ds_read_b128 v[232:235], v30 offset:32768
    v_max3_f32 v2, v192, v193, v194
    v_max3_f32 v3, v195, v196, v197
    v_max3_f32 v2, v2, v198, v199
    v_max3_f32 v3, v3, v200, v201
    v_max3_f32 v2, v2, v202, v203
    v_max3_f32 v3, v3, v204, v205
    s_waitcnt lgkmcnt(7)
    v_mfma_f32_32x32x16_bf16 v[80:95], v[244:247], v[172:175], v[80:95]
    ds_read_b128 v[236:239], v31 offset:32768
    v_max3_f32 v2, v2, v206, v207
    v_max3_f32 v3, v3, v208, v209
    v_max3_f32 v2, v2, v210, v211
    v_max3_f32 v3, v3, v212, v213
    v_max3_f32 v2, v2, v214, v215
    v_max3_f32 v3, v3, v216, v217
    s_waitcnt lgkmcnt(6)
    v_mfma_f32_32x32x16_bf16 v[96:111], v[248:251], v[172:175], v[96:111]
    ds_read_b128 v[240:243], v32 offset:32768
    v_max3_f32 v2, v2, v218, v219
    v_max3_f32 v3, v3, v220, v221
    v_max3_f32 v2, v2, v222, v223
    v_max_f32 v2, v2, v3
    v_mov_b32 v3, v2
    s_nop 1
    s_waitcnt lgkmcnt(5)
    v_mfma_f32_32x32x16_bf16 v[112:127], v[252:255], v[172:175], v[112:127]
    ds_read_b128 v[244:247], v33 offset:32768
    v_permlane32_swap_b32 v2, v3
    s_nop 1
    v_max_f32 v2, v2, v3
    v_cmp_lt_f32 vcc, 0xc29c0000, v2
    s_mov_b64 s[64:65], vcc
    s_cbranch_vccz .Lk1_nors_3
    v_add_f32 v2, 0x42d80000, v2
    v_max_f32 v2, 0, v2
    v_sub_f32 v46, 0, v2
    v_exp_f32 v46, v46
    v_sub_f32 v48, v48, v2
    v_sub_f32 v49, v49, v2
    v_sub_f32 v50, v50, v2
    v_sub_f32 v51, v51, v2
    v_sub_f32 v52, v52, v2
    v_sub_f32 v53, v53, v2
    v_sub_f32 v54, v54, v2
    v_sub_f32 v55, v55, v2
    v_sub_f32 v56, v56, v2
    v_sub_f32 v57, v57, v2
    v_sub_f32 v58, v58, v2
    v_sub_f32 v59, v59, v2
    v_sub_f32 v60, v60, v2
    v_sub_f32 v61, v61, v2
    v_sub_f32 v62, v62, v2
    v_sub_f32 v63, v63, v2
    v_sub_f32 v192, v192, v2
    v_sub_f32 v193, v193, v2
    v_sub_f32 v194, v194, v2
    v_sub_f32 v195, v195, v2
    v_sub_f32 v196, v196, v2
    v_sub_f32 v197, v197, v2
    v_sub_f32 v198, v198, v2
    v_sub_f32 v199, v199, v2
    v_sub_f32 v200, v200, v2
    v_sub_f32 v201, v201, v2
    v_sub_f32 v202, v202, v2
    v_sub_f32 v203, v203, v2
    v_sub_f32 v204, v204, v2
    v_sub_f32 v205, v205, v2
    v_sub_f32 v206, v206, v2
    v_sub_f32 v207, v207, v2
    v_sub_f32 v208, v208, v2
    v_sub_f32 v209, v209, v2
    v_sub_f32 v210, v210, v2
    v_sub_f32 v211, v211, v2
    v_sub_f32 v212, v212, v2
    v_sub_f32 v213, v213, v2
    v_sub_f32 v214, v214, v2
    v_sub_f32 v215, v215, v2
    v_sub_f32 v216, v216, v2
    v_sub_f32 v217, v217, v2
    v_sub_f32 v218, v218, v2
    v_sub_f32 v219, v219, v2
    v_sub_f32 v220, v220, v2
    v_sub_f32 v221, v221, v2
    v_sub_f32 v222, v222, v2
    v_sub_f32 v223, v223, v2
    v_mul_f32 v44, v44, v46
.Lk1_nors_3:
    s_waitcnt lgkmcnt(5)
    v_mfma_f32_32x32x16_bf16 v[160:175], v[224:227], v[128:131], v[48:63]
    ds_read_b128 v[248:251], v34 offset:32768
    v_exp_f32 v192, v192
    v_exp_f32 v193, v193
    v_exp_f32 v194, v194
    s_waitcnt lgkmcnt(5)
    v_mfma_f32_32x32x16_bf16 v[160:175], v[228:231], v[132:135], v[160:175]
    ds_read_b128 v[252:255], v35 offset:32768
    v_exp_f32 v195, v195
    v_exp_f32 v196, v196
    v_exp_f32 v197, v197
    s_waitcnt lgkmcnt(5)
    v_mfma_f32_32x32x16_bf16 v[160:175], v[232:235], v[136:139], v[160:175]
    ds_read_b128 v[224:227], v28 offset:40960
    v_exp_f32 v198, v198
    v_exp_f32 v199, v199
    s_nop 0
    s_waitcnt lgkmcnt(5)
    v_mfma_f32_32x32x16_bf16 v[160:175], v[236:239], v[140:143], v[160:175]
    ds_read_b128 v[228:231], v29 offset:40960
    v_mov_b32 v10, v192
    v_mov_b32 v11, v193
    s_waitcnt lgkmcnt(5)
    v_mfma_f32_32x32x16_bf16 v[160:175], v[240:243], v[144:147], v[160:175]
    ds_read_b128 v[232:235], v30 offset:40960
    v_cvt_pk_bf16_f32 v192, v192, v193
    v_add_f32 v10, v10, v194
    v_add_f32 v11, v11, v195
    s_waitcnt lgkmcnt(5)
    v_mfma_f32_32x32x16_bf16 v[160:175], v[244:247], v[148:151], v[160:175]
    ds_read_b128 v[236:239], v31 offset:40960
    v_cvt_pk_bf16_f32 v193, v194, v195
    v_add_f32 v10, v10, v196
    v_add_f32 v11, v11, v197
    s_waitcnt lgkmcnt(5)
    v_mfma_f32_32x32x16_bf16 v[160:175], v[248:251], v[152:155], v[160:175]
    ds_read_b128 v[240:243], v32 offset:40960
    v_cvt_pk_bf16_f32 v194, v196, v197
    v_add_f32 v10, v10, v198
    v_add_f32 v11, v11, v199
    s_waitcnt lgkmcnt(5)
    v_mfma_f32_32x32x16_bf16 v[160:175], v[252:255], v[156:159], v[160:175]
    ds_read_b128 v[244:247], v33 offset:40960
    v_cvt_pk_bf16_f32 v195, v198, v199
    s_cmp_eq_u64 s[64:65], 0
    s_cbranch_scc1 .Lk1_nors2_3
    v_mul_f32 v64, v46, v64
    v_mul_f32 v65, v46, v65
    v_mul_f32 v66, v46, v66
    v_mul_f32 v67, v46, v67
    v_mul_f32 v68, v46, v68
    v_mul_f32 v69, v46, v69
    v_mul_f32 v70, v46, v70
    v_mul_f32 v71, v46, v71
    v_mul_f32 v72, v46, v72
    v_mul_f32 v73, v46, v73
    v_mul_f32 v74, v46, v74
    v_mul_f32 v75, v46, v75
    v_mul_f32 v76, v46, v76
    v_mul_f32 v77, v46, v77
    v_mul_f32 v78, v46, v78
    v_mul_f32 v79, v46, v79
    v_mul_f32 v80, v46, v80
    v_mul_f32 v81, v46, v81
    v_mul_f32 v82, v46, v82
    v_mul_f32 v83, v46, v83
    v_mul_f32 v84, v46, v84
    v_mul_f32 v85, v46, v85
    v_mul_f32 v86, v46, v86
    v_mul_f32 v87, v46, v87
    v_mul_f32 v88, v46, v88
    v_mul_f32 v89, v46, v89
    v_mul_f32 v90, v46, v90
    v_mul_f32 v91, v46, v91
    v_mul_f32 v92, v46, v92
    v_mul_f32 v93, v46, v93
    v_mul_f32 v94, v46, v94
    v_mul_f32 v95, v46, v95
    v_mul_f32 v96, v46, v96
    v_mul_f32 v97, v46, v97
    v_mul_f32 v98, v46, v98
    v_mul_f32 v99, v46, v99
    v_mul_f32 v100, v46, v100
    v_mul_f32 v101, v46, v101
    v_mul_f32 v102, v46, v102
    v_mul_f32 v103, v46, v103
    v_mul_f32 v104, v46, v104
    v_mul_f32 v105, v46, v105
    v_mul_f32 v106, v46, v106
    v_mul_f32 v107, v46, v107
    v_mul_f32 v108, v46, v108
    v_mul_f32 v109, v46, v109
    v_mul_f32 v110, v46, v110
    v_mul_f32 v111, v46, v111
    v_mul_f32 v112, v46, v112
    v_mul_f32 v113, v46, v113
    v_mul_f32 v114, v46, v114
    v_mul_f32 v115, v46, v115
    v_mul_f32 v116, v46, v116
    v_mul_f32 v117, v46, v117
    v_mul_f32 v118, v46, v118
    v_mul_f32 v119, v46, v119
    v_mul_f32 v120, v46, v120
    v_mul_f32 v121, v46, v121
    v_mul_f32 v122, v46, v122
    v_mul_f32 v123, v46, v123
    v_mul_f32 v124, v46, v124
    v_mul_f32 v125, v46, v125
    v_mul_f32 v126, v46, v126
    v_mul_f32 v127, v46, v127
.Lk1_nors2_3:
    s_waitcnt lgkmcnt(5)
    v_mfma_f32_32x32x16_bf16 v[176:191], v[224:227], v[128:131], v[48:63]
    ds_read_b128 v[248:251], v34 offset:40960
    v_exp_f32 v200, v200
    v_exp_f32 v201, v201
    v_exp_f32 v202, v202
    s_waitcnt lgkmcnt(5)
    v_mfma_f32_32x32x16_bf16 v[176:191], v[228:231], v[132:135], v[176:191]
    ds_read_b128 v[252:255], v35 offset:40960
    v_exp_f32 v203, v203
    v_exp_f32 v204, v204
    v_exp_f32 v205, v205
    s_waitcnt lgkmcnt(5)
    v_mfma_f32_32x32x16_bf16 v[176:191], v[232:235], v[136:139], v[176:191]
    ds_read_b64_tr_b16 v[224:225], v36 offset:0
    ds_read_b64_tr_b16 v[226:227], v36 offset:1024
    v_exp_f32 v206, v206
    v_exp_f32 v207, v207
    s_nop 0
    s_waitcnt lgkmcnt(6)
    v_mfma_f32_32x32x16_bf16 v[176:191], v[236:239], v[140:143], v[176:191]
    ds_read_b64_tr_b16 v[228:229], v37 offset:0
    ds_read_b64_tr_b16 v[230:231], v37 offset:1024
    v_add_f32 v10, v10, v200
    v_add_f32 v11, v11, v201
    s_waitcnt lgkmcnt(7)
    v_mfma_f32_32x32x16_bf16 v[176:191], v[240:243], v[144:147], v[176:191]
    ds_read_b64_tr_b16 v[232:233], v38 offset:0
    ds_read_b64_tr_b16 v[234:235], v38 offset:1024
    v_cvt_pk_bf16_f32 v196, v200, v201
    v_add_f32 v10, v10, v202
    v_add_f32 v11, v11, v203
    s_waitcnt lgkmcnt(8)
    v_mfma_f32_32x32x16_bf16 v[176:191], v[244:247], v[148:151], v[176:191]
    ds_read_b64_tr_b16 v[236:237], v39 offset:0
    ds_read_b64_tr_b16 v[238:239], v39 offset:1024
    v_cvt_pk_bf16_f32 v197, v202, v203
    v_add_f32 v10, v10, v204
    v_add_f32 v11, v11, v205
    s_waitcnt lgkmcnt(9)
    v_mfma_f32_32x32x16_bf16 v[176:191], v[248:251], v[152:155], v[176:191]
    ds_read_b64_tr_b16 v[240:241], v36 offset:4096
    ds_read_b64_tr_b16 v[242:243], v36 offset:5120
    v_cvt_pk_bf16_f32 v198, v204, v205
    v_add_f32 v10, v10, v206
    v_add_f32 v11, v11, v207
    s_waitcnt lgkmcnt(10)
    v_mfma_f32_32x32x16_bf16 v[176:191], v[252:255], v[156:159], v[176:191]
    ds_read_b64_tr_b16 v[244:245], v37 offset:4096
    ds_read_b64_tr_b16 v[246:247], v37 offset:5120
    v_cvt_pk_bf16_f32 v199, v206, v207
    s_nop 1
    s_waitcnt lgkmcnt(10)
    v_mfma_f32_32x32x16_bf16 v[64:79], v[224:227], v[192:195], v[64:79]
    ds_read_b64_tr_b16 v[248:249], v38 offset:4096
    ds_read_b64_tr_b16 v[250:251], v38 offset:5120
    v_exp_f32 v208, v208
    v_exp_f32 v209, v209
    v_exp_f32 v210, v210
    v_exp_f32 v211, v211
    s_waitcnt lgkmcnt(10)
    v_mfma_f32_32x32x16_bf16 v[80:95], v[228:231], v[192:195], v[80:95]
    ds_read_b64_tr_b16 v[252:253], v39 offset:4096
    ds_read_b64_tr_b16 v[254:255], v39 offset:5120
    v_exp_f32 v212, v212
    v_exp_f32 v213, v213
    v_exp_f32 v214, v214
    v_exp_f32 v215, v215
    s_waitcnt lgkmcnt(10)
    v_mfma_f32_32x32x16_bf16 v[96:111], v[232:235], v[192:195], v[96:111]
    ds_read_b64_tr_b16 v[224:225], v36 offset:8192
    ds_read_b64_tr_b16 v[226:227], v36 offset:9216
    s_nop 0
    v_add_f32 v10, v10, v208
    v_add_f32 v11, v11, v209
    s_waitcnt lgkmcnt(10)
    v_mfma_f32_32x32x16_bf16 v[112:127], v[236:239], v[192:195], v[112:127]
    ds_read_b64_tr_b16 v[228:229], v37 offset:8192
    ds_read_b64_tr_b16 v[230:231], v37 offset:9216
    v_cvt_pk_bf16_f32 v200, v208, v209
    v_add_f32 v10, v10, v210
    v_add_f32 v11, v11, v211
    v_cvt_pk_bf16_f32 v201, v210, v211
    s_waitcnt lgkmcnt(10)
    v_mfma_f32_32x32x16_bf16 v[64:79], v[240:243], v[196:199], v[64:79]
    ds_read_b64_tr_b16 v[232:233], v38 offset:8192
    ds_read_b64_tr_b16 v[234:235], v38 offset:9216
    v_add_f32 v10, v10, v212
    v_add_f32 v11, v11, v213
    v_cvt_pk_bf16_f32 v202, v212, v213
    v_add_f32 v10, v10, v214
    s_waitcnt lgkmcnt(10)
    v_mfma_f32_32x32x16_bf16 v[80:95], v[244:247], v[196:199], v[80:95]
    ds_read_b64_tr_b16 v[236:237], v39 offset:8192
    ds_read_b64_tr_b16 v[238:239], v39 offset:9216
    v_add_f32 v11, v11, v215
    v_cvt_pk_bf16_f32 v203, v214, v215
    s_nop 1
    s_waitcnt lgkmcnt(10)
    v_mfma_f32_32x32x16_bf16 v[96:111], v[248:251], v[196:199], v[96:111]
    ds_read_b64_tr_b16 v[240:241], v36 offset:12288
    ds_read_b64_tr_b16 v[242:243], v36 offset:13312
    v_exp_f32 v216, v216
    v_exp_f32 v217, v217
    v_exp_f32 v218, v218
    v_exp_f32 v219, v219
    s_waitcnt lgkmcnt(10)
    v_mfma_f32_32x32x16_bf16 v[112:127], v[252:255], v[196:199], v[112:127]
    ds_read_b64_tr_b16 v[244:245], v37 offset:12288
    ds_read_b64_tr_b16 v[246:247], v37 offset:13312
    v_exp_f32 v220, v220
    v_exp_f32 v221, v221
    v_exp_f32 v222, v222
    s_waitcnt lgkmcnt(10)
    v_mfma_f32_32x32x16_bf16 v[64:79], v[224:227], v[200:203], v[64:79]
    ds_read_b64_tr_b16 v[248:249], v38 offset:12288
    ds_read_b64_tr_b16 v[250:251], v38 offset:13312
    v_exp_f32 v223, v223
    s_nop 0
    v_add_f32 v10, v10, v216
    v_add_f32 v11, v11, v217
    v_cvt_pk_bf16_f32 v204, v216, v217
    s_waitcnt lgkmcnt(10)
    v_mfma_f32_32x32x16_bf16 v[80:95], v[228:231], v[200:203], v[80:95]
    ds_read_b64_tr_b16 v[252:253], v39 offset:12288
    ds_read_b64_tr_b16 v[254:255], v39 offset:13312
    v_add_f32 v10, v10, v218
    v_add_f32 v11, v11, v219
    v_cvt_pk_bf16_f32 v205, v218, v219
    v_add_f32 v10, v10, v220
    s_waitcnt lgkmcnt(10)
    v_mfma_f32_32x32x16_bf16 v[96:111], v[232:235], v[200:203], v[96:111]
    v_add_f32 v11, v11, v221
    v_cvt_pk_bf16_f32 v206, v220, v221
    v_add_f32 v10, v10, v222
    v_add_f32 v11, v11, v223
    s_waitcnt lgkmcnt(8)
    v_mfma_f32_32x32x16_bf16 v[112:127], v[236:239], v[200:203], v[112:127]
    v_cvt_pk_bf16_f32 v207, v222, v223
    v_add_f32 v10, v10, v11
    v_add_f32 v44, v44, v10
    s_nop 1
    s_waitcnt vmcnt(0)
    s_barrier
    s_mov_b32 s46, 114688
    s_add_u32 m0, s47, 147456
    s_nop 0
    buffer_load_dwordx4 v40, s[20:23], s46 offen lds
    buffer_load_dwordx4 v41, s[20:23], s46 offen offset:1024 lds
    s_mov_b32 s46, 81920
    s_add_u32 m0, s47, 98304
    s_nop 0
    buffer_load_dwordx4 v42, s[24:27], s46 offen lds
    buffer_load_dwordx4 v42, s[24:27], s46 offen offset:1024 lds
    ds_read_b128 v[224:227], v28 offset:0
    ds_read_b128 v[228:231], v29 offset:0
    s_waitcnt lgkmcnt(8)
    v_mfma_f32_32x32x16_bf16 v[64:79], v[240:243], v[204:207], v[64:79]
    ds_read_b128 v[232:235], v30 offset:0
    v_max3_f32 v2, v160, v161, v162
    v_max3_f32 v3, v163, v164, v165
    v_max3_f32 v2, v2, v166, v167
    v_max3_f32 v3, v3, v168, v169
    v_max3_f32 v2, v2, v170, v171
    v_max3_f32 v3, v3, v172, v173
    s_waitcnt lgkmcnt(7)
    v_mfma_f32_32x32x16_bf16 v[80:95], v[244:247], v[204:207], v[80:95]
    ds_read_b128 v[236:239], v31 offset:0
    v_max3_f32 v2, v2, v174, v175
    v_max3_f32 v3, v3, v176, v177
    v_max3_f32 v2, v2, v178, v179
    v_max3_f32 v3, v3, v180, v181
    v_max3_f32 v2, v2, v182, v183
    v_max3_f32 v3, v3, v184, v185
    s_waitcnt lgkmcnt(6)
    v_mfma_f32_32x32x16_bf16 v[96:111], v[248:251], v[204:207], v[96:111]
    ds_read_b128 v[240:243], v32 offset:0
    v_max3_f32 v2, v2, v186, v187
    v_max3_f32 v3, v3, v188, v189
    v_max3_f32 v2, v2, v190, v191
    v_max_f32 v2, v2, v3
    v_mov_b32 v3, v2
    s_nop 1
    s_waitcnt lgkmcnt(5)
    v_mfma_f32_32x32x16_bf16 v[112:127], v[252:255], v[204:207], v[112:127]
    ds_read_b128 v[244:247], v33 offset:0
    v_permlane32_swap_b32 v2, v3
    s_nop 1
    v_max_f32 v2, v2, v3
    v_cmp_lt_f32 vcc, 0xc29c0000, v2
    s_mov_b64 s[64:65], vcc
    s_cbranch_vccz .Lk1_nors_4
    v_add_f32 v2, 0x42d80000, v2
    v_max_f32 v2, 0, v2
    v_sub_f32 v46, 0, v2
    v_exp_f32 v46, v46
    v_sub_f32 v48, v48, v2
    v_sub_f32 v49, v49, v2
    v_sub_f32 v50, v50, v2
    v_sub_f32 v51, v51, v2
    v_sub_f32 v52, v52, v2
    v_sub_f32 v53, v53, v2
    v_sub_f32 v54, v54, v2
    v_sub_f32 v55, v55, v2
    v_sub_f32 v56, v56, v2
    v_sub_f32 v57, v57, v2
    v_sub_f32 v58, v58, v2
    v_sub_f32 v59, v59, v2
    v_sub_f32 v60, v60, v2
    v_sub_f32 v61, v61, v2
    v_sub_f32 v62, v62, v2
    v_sub_f32 v63, v63, v2
    v_sub_f32 v160, v160, v2
    v_sub_f32 v161, v161, v2
    v_sub_f32 v162, v162, v2
    v_sub_f32 v163, v163, v2
    v_sub_f32 v164, v164, v2
    v_sub_f32 v165, v165, v2
    v_sub_f32 v166, v166, v2
    v_sub_f32 v167, v167, v2
    v_sub_f32 v168, v168, v2
    v_sub_f32 v169, v169, v2
    v_sub_f32 v170, v170, v2
    v_sub_f32 v171, v171, v2
    v_sub_f32 v172, v172, v2
    v_sub_f32 v173, v173, v2
    v_sub_f32 v174, v174, v2
    v_sub_f32 v175, v175, v2
    v_sub_f32 v176, v176, v2
    v_sub_f32 v177, v177, v2
    v_sub_f32 v178, v178, v2
    v_sub_f32 v179, v179, v2
    v_sub_f32 v180, v180, v2
    v_sub_f32 v181, v181, v2
    v_sub_f32 v182, v182, v2
    v_sub_f32 v183, v183, v2
    v_sub_f32 v184, v184, v2
    v_sub_f32 v185, v185, v2
    v_sub_f32 v186, v186, v2
    v_sub_f32 v187, v187, v2
    v_sub_f32 v188, v188, v2
    v_sub_f32 v189, v189, v2
    v_sub_f32 v190, v190, v2
    v_sub_f32 v191, v191, v2
    v_mul_f32 v44, v44, v46
.Lk1_nors_4:
    s_waitcnt lgkmcnt(5)
    v_mfma_f32_32x32x16_bf16 v[192:207], v[224:227], v[128:131], v[48:63]
    ds_read_b128 v[248:251], v34 offset:0
    v_exp_f32 v160, v160
    v_exp_f32 v161, v161
    v_exp_f32 v162, v162
    s_waitcnt lgkmcnt(5)
    v_mfma_f32_32x32x16_bf16 v[192:207], v[228:231], v[132:135], v[192:207]
    ds_read_b128 v[252:255], v35 offset:0
    v_exp_f32 v163, v163
    v_exp_f32 v164, v164
    v_exp_f32 v165, v165
    s_waitcnt lgkmcnt(5)
    v_mfma_f32_32x32x16_bf16 v[192:207], v[232:235], v[136:139], v[192:207]
    ds_read_b128 v[224:227], v28 offset:8192
    v_exp_f32 v166, v166
    v_exp_f32 v167, v167
    s_nop 0
    s_waitcnt lgkmcnt(5)
    v_mfma_f32_32x32x16_bf16 v[192:207], v[236:239], v[140:143], v[192:207]
    ds_read_b128 v[228:231], v29 offset:8192
    v_mov_b32 v10, v160
    v_mov_b32 v11, v161
    s_waitcnt lgkmcnt(5)
    v_mfma_f32_32x32x16_bf16 v[192:207], v[240:243], v[144:147], v[192:207]
    ds_read_b128 v[232:235], v30 offset:8192
    v_cvt_pk_bf16_f32 v160, v160, v161
    v_add_f32 v10, v10, v162
    v_add_f32 v11, v11, v163
    s_waitcnt lgkmcnt(5)
    v_mfma_f32_32x32x16_bf16 v[192:207], v[244:247], v[148:151], v[192:207]
    ds_read_b128 v[236:239], v31 offset:8192
    v_cvt_pk_bf16_f32 v161, v162, v163
    v_add_f32 v10, v10, v164
    v_add_f32 v11, v11, v165
    s_waitcnt lgkmcnt(5)
    v_mfma_f32_32x32x16_bf16 v[192:207], v[248:251], v[152:155], v[192:207]
    ds_read_b128 v[240:243], v32 offset:8192
    v_cvt_pk_bf16_f32 v162, v164, v165
    v_add_f32 v10, v10, v166
    v_add_f32 v11, v11, v167
    s_waitcnt lgkmcnt(5)
    v_mfma_f32_32x32x16_bf16 v[192:207], v[252:255], v[156:159], v[192:207]
    ds_read_b128 v[244:247], v33 offset:8192
    v_cvt_pk_bf16_f32 v163, v166, v167
    s_cmp_eq_u64 s[64:65], 0
    s_cbranch_scc1 .Lk1_nors2_4
    v_mul_f32 v64, v46, v64
    v_mul_f32 v65, v46, v65
    v_mul_f32 v66, v46, v66
    v_mul_f32 v67, v46, v67
    v_mul_f32 v68, v46, v68
    v_mul_f32 v69, v46, v69
    v_mul_f32 v70, v46, v70
    v_mul_f32 v71, v46, v71
    v_mul_f32 v72, v46, v72
    v_mul_f32 v73, v46, v73
    v_mul_f32 v74, v46, v74
    v_mul_f32 v75, v46, v75
    v_mul_f32 v76, v46, v76
    v_mul_f32 v77, v46, v77
    v_mul_f32 v78, v46, v78
    v_mul_f32 v79, v46, v79
    v_mul_f32 v80, v46, v80
    v_mul_f32 v81, v46, v81
    v_mul_f32 v82, v46, v82
    v_mul_f32 v83, v46, v83
    v_mul_f32 v84, v46, v84
    v_mul_f32 v85, v46, v85
    v_mul_f32 v86, v46, v86
    v_mul_f32 v87, v46, v87
    v_mul_f32 v88, v46, v88
    v_mul_f32 v89, v46, v89
    v_mul_f32 v90, v46, v90
    v_mul_f32 v91, v46, v91
    v_mul_f32 v92, v46, v92
    v_mul_f32 v93, v46, v93
    v_mul_f32 v94, v46, v94
    v_mul_f32 v95, v46, v95
    v_mul_f32 v96, v46, v96
    v_mul_f32 v97, v46, v97
    v_mul_f32 v98, v46, v98
    v_mul_f32 v99, v46, v99
    v_mul_f32 v100, v46, v100
    v_mul_f32 v101, v46, v101
    v_mul_f32 v102, v46, v102
    v_mul_f32 v103, v46, v103
    v_mul_f32 v104, v46, v104
    v_mul_f32 v105, v46, v105
    v_mul_f32 v106, v46, v106
    v_mul_f32 v107, v46, v107
    v_mul_f32 v108, v46, v108
    v_mul_f32 v109, v46, v109
    v_mul_f32 v110, v46, v110
    v_mul_f32 v111, v46, v111
    v_mul_f32 v112, v46, v112
    v_mul_f32 v113, v46, v113
    v_mul_f32 v114, v46, v114
    v_mul_f32 v115, v46, v115
    v_mul_f32 v116, v46, v116
    v_mul_f32 v117, v46, v117
    v_mul_f32 v118, v46, v118
    v_mul_f32 v119, v46, v119
    v_mul_f32 v120, v46, v120
    v_mul_f32 v121, v46, v121
    v_mul_f32 v122, v46, v122
    v_mul_f32 v123, v46, v123
    v_mul_f32 v124, v46, v124
    v_mul_f32 v125, v46, v125
    v_mul_f32 v126, v46, v126
    v_mul_f32 v127, v46, v127
.Lk1_nors2_4:
    s_waitcnt lgkmcnt(5)
    v_mfma_f32_32x32x16_bf16 v[208:223], v[224:227], v[128:131], v[48:63]
    ds_read_b128 v[248:251], v34 offset:8192
    v_exp_f32 v168, v168
    v_exp_f32 v169, v169
    v_exp_f32 v170, v170
    s_waitcnt lgkmcnt(5)
    v_mfma_f32_32x32x16_bf16 v[208:223], v[228:231], v[132:135], v[208:223]
    ds_read_b128 v[252:255], v35 offset:8192
    v_exp_f32 v171, v171
    v_exp_f32 v172, v172
    v_exp_f32 v173, v173
    s_waitcnt lgkmcnt(5)
    v_mfma_f32_32x32x16_bf16 v[208:223], v[232:235], v[136:139], v[208:223]
    ds_read_b64_tr_b16 v[224:225], v36 offset:16384
    ds_read_b64_tr_b16 v[226:227], v36 offset:17408
    v_exp_f32 v174, v174
    v_exp_f32 v175, v175
    s_nop 0
    s_waitcnt lgkmcnt(6)
    v_mfma_f32_32x32x16_bf16 v[208:223], v[236:239], v[140:143], v[208:223]
    ds_read_b64_tr_b16 v[228:229], v37 offset:16384
    ds_read_b64_tr_b16 v[230:231], v37 offset:17408
    v_add_f32 v10, v10, v168
    v_add_f32 v11, v11, v169
    s_waitcnt lgkmcnt(7)
    v_mfma_f32_32x32x16_bf16 v[208:223], v[240:243], v[144:147], v[208:223]
    ds_read_b64_tr_b16 v[232:233], v38 offset:16384
    ds_read_b64_tr_b16 v[234:235], v38 offset:17408
    v_cvt_pk_bf16_f32 v164, v168, v169
    v_add_f32 v10, v10, v170
    v_add_f32 v11, v11, v171
    s_waitcnt lgkmcnt(8)
    v_mfma_f32_32x32x16_bf16 v[208:223], v[244:247], v[148:151], v[208:223]
    ds_read_b64_tr_b16 v[236:237], v39 offset:16384
    ds_read_b64_tr_b16 v[238:239], v39 offset:17408
    v_cvt_pk_bf16_f32 v165, v170, v171
    v_add_f32 v10, v10, v172
    v_add_f32 v11, v11, v173
    s_waitcnt lgkmcnt(9)
    v_mfma_f32_32x32x16_bf16 v[208:223], v[248:251], v[152:155], v[208:223]
    ds_read_b64_tr_b16 v[240:241], v36 offset:20480
    ds_read_b64_tr_b16 v[242:243], v36 offset:21504
    v_cvt_pk_bf16_f32 v166, v172, v173
    v_add_f32 v10, v10, v174
    v_add_f32 v11, v11, v175
    s_waitcnt lgkmcnt(10)
    v_mfma_f32_32x32x16_bf16 v[208:223], v[252:255], v[156:159], v[208:223]
    ds_read_b64_tr_b16 v[244:245], v37 offset:20480
    ds_read_b64_tr_b16 v[246:247], v37 offset:21504
    v_cvt_pk_bf16_f32 v167, v174, v175
    s_nop 1
    s_waitcnt lgkmcnt(10)
    v_mfma_f32_32x32x16_bf16 v[64:79], v[224:227], v[160:163], v[64:79]
    ds_read_b64_tr_b16 v[248:249], v38 offset:20480
    ds_read_b64_tr_b16 v[250:251], v38 offset:21504
    v_exp_f32 v176, v176
    v_exp_f32 v177, v177
    v_exp_f32 v178, v178
    v_exp_f32 v179, v179
    s_waitcnt lgkmcnt(10)
    v_mfma_f32_32x32x16_bf16 v[80:95], v[228:231], v[160:163], v[80:95]
    ds_read_b64_tr_b16 v[252:253], v39 offset:20480
    ds_read_b64_tr_b16 v[254:255], v39 offset:21504
    v_exp_f32 v180, v180
    v_exp_f32 v181, v181
    v_exp_f32 v182, v182
    v_exp_f32 v183, v183
    s_waitcnt lgkmcnt(10)
    v_mfma_f32_32x32x16_bf16 v[96:111], v[232:235], v[160:163], v[96:111]
    ds_read_b64_tr_b16 v[224:225], v36 offset:24576
    ds_read_b64_tr_b16 v[226:227], v36 offset:25600
    s_nop 0
    v_add_f32 v10, v10, v176
    v_add_f32 v11, v11, v177
    s_waitcnt lgkmcnt(10)
    v_mfma_f32_32x32x16_bf16 v[112:127], v[236:239], v[160:163], v[112:127]
    ds_read_b64_tr_b16 v[228:229], v37 offset:24576
    ds_read_b64_tr_b16 v[230:231], v37 offset:25600
    v_cvt_pk_bf16_f32 v168, v176, v177
    v_add_f32 v10, v10, v178
    v_add_f32 v11, v11, v179
    v_cvt_pk_bf16_f32 v169, v178, v179
    s_waitcnt lgkmcnt(10)
    v_mfma_f32_32x32x16_bf16 v[64:79], v[240:243], v[164:167], v[64:79]
    ds_read_b64_tr_b16 v[232:233], v38 offset:24576
    ds_read_b64_tr_b16 v[234:235], v38 offset:25600
    v_add_f32 v10, v10, v180
    v_add_f32 v11, v11, v181
    v_cvt_pk_bf16_f32 v170, v180, v181
    v_add_f32 v10, v10, v182
    s_waitcnt lgkmcnt(10)
    v_mfma_f32_32x32x16_bf16 v[80:95], v[244:247], v[164:167], v[80:95]
    ds_read_b64_tr_b16 v[236:237], v39 offset:24576
    ds_read_b64_tr_b16 v[238:239], v39 offset:25600
    v_add_f32 v11, v11, v183
    v_cvt_pk_bf16_f32 v171, v182, v183
    s_nop 1
    s_waitcnt lgkmcnt(10)
    v_mfma_f32_32x32x16_bf16 v[96:111], v[248:251], v[164:167], v[96:111]
    ds_read_b64_tr_b16 v[240:241], v36 offset:28672
    ds_read_b64_tr_b16 v[242:243], v36 offset:29696
    v_exp_f32 v184, v184
    v_exp_f32 v185, v185
    v_exp_f32 v186, v186
    v_exp_f32 v187, v187
    s_waitcnt lgkmcnt(10)
    v_mfma_f32_32x32x16_bf16 v[112:127], v[252:255], v[164:167], v[112:127]
    ds_read_b64_tr_b16 v[244:245], v37 offset:28672
    ds_read_b64_tr_b16 v[246:247], v37 offset:29696
    v_exp_f32 v188, v188
    v_exp_f32 v189, v189
    v_exp_f32 v190, v190
    s_waitcnt lgkmcnt(10)
    v_mfma_f32_32x32x16_bf16 v[64:79], v[224:227], v[168:171], v[64:79]
    ds_read_b64_tr_b16 v[248:249], v38 offset:28672
    ds_read_b64_tr_b16 v[250:251], v38 offset:29696
    v_exp_f32 v191, v191
    s_nop 0
    v_add_f32 v10, v10, v184
    v_add_f32 v11, v11, v185
    v_cvt_pk_bf16_f32 v172, v184, v185
    s_waitcnt lgkmcnt(10)
    v_mfma_f32_32x32x16_bf16 v[80:95], v[228:231], v[168:171], v[80:95]
    ds_read_b64_tr_b16 v[252:253], v39 offset:28672
    ds_read_b64_tr_b16 v[254:255], v39 offset:29696
    v_add_f32 v10, v10, v186
    v_add_f32 v11, v11, v187
    v_cvt_pk_bf16_f32 v173, v186, v187
    v_add_f32 v10, v10, v188
    s_waitcnt lgkmcnt(10)
    v_mfma_f32_32x32x16_bf16 v[96:111], v[232:235], v[168:171], v[96:111]
    v_add_f32 v11, v11, v189
    v_cvt_pk_bf16_f32 v174, v188, v189
    v_add_f32 v10, v10, v190
    v_add_f32 v11, v11, v191
    s_waitcnt lgkmcnt(8)
    v_mfma_f32_32x32x16_bf16 v[112:127], v[236:239], v[168:171], v[112:127]
    v_cvt_pk_bf16_f32 v175, v190, v191
    v_add_f32 v10, v10, v11
    v_add_f32 v44, v44, v10
    s_nop 1
    s_waitcnt vmcnt(0)
    s_barrier
    s_mov_b32 s46, 98304
    s_add_u32 m0, s47, 65536
    s_nop 0
    buffer_load_dwordx4 v42, s[24:27], s46 offen lds
    buffer_load_dwordx4 v42, s[24:27], s46 offen offset:1024 lds
    v_lshlrev_b32 v12, 7, v1
    s_lshl_b32 s56, s42, 14
    s_lshl_b32 s57, s40, 13
    s_add_u32 s56, s56, s57
    s_mov_b32 s8, s28
    s_mov_b32 s9, s29
    s_movk_i32 s10, 8192
    s_mul_i32 s57, s2, 2048
    s_cmp_ge_u32 s40, 2
    s_cselect_b32 s56, s57, s56
    s_cselect_b32 s8, s92, s8
    s_cselect_b32 s9, s93, s9
    s_cselect_b32 s10, 2048, s10
    s_mul_i32 s57, s2, 2048
    s_cmp_ge_u32 s40, 3
    s_cselect_b32 s56, s57, s56
    s_cselect_b32 s8, s94, s8
    s_cselect_b32 s9, s95, s9
    s_cselect_b32 s10, 2048, s10
    s_mul_i32 s57, s2, 7168
    s_cmp_ge_u32 s40, 4
    s_cselect_b32 s56, s57, s56
    s_cselect_b32 s8, s96, s8
    s_cselect_b32 s9, s97, s9
    s_cselect_b32 s10, 7168, s10
    s_mul_i32 s57, s2, 7168
    s_cmp_ge_u32 s40, 5
    s_cselect_b32 s56, s57, s56
    s_cselect_b32 s8, s98, s8
    s_cselect_b32 s9, s99, s9
    s_cselect_b32 s10, 7168, s10
    s_mul_i32 s57, s2, 0
    s_cmp_ge_u32 s40, 6
    s_cselect_b32 s56, s57, s56
    s_cselect_b32 s8, s98, s8
    s_cselect_b32 s9, s99, s9
    s_cselect_b32 s10, 0, s10
    s_add_u32 s8, s8, s56
    s_addc_u32 s9, s9, 0
    s_mov_b32 s11, 0x00020000
    buffer_load_dword v15, v12, s[8:11], 0 offen
    ds_read_b128 v[224:227], v28 offset:16384
    ds_read_b128 v[228:231], v29 offset:16384
    s_waitcnt lgkmcnt(8)
    v_mfma_f32_32x32x16_bf16 v[64:79], v[240:243], v[172:175], v[64:79]
    ds_read_b128 v[232:235], v30 offset:16384
    v_max3_f32 v2, v192, v193, v194
    v_max3_f32 v3, v195, v196, v197
    v_max3_f32 v2, v2, v198, v199
    v_max3_f32 v3, v3, v200, v201
    v_max3_f32 v2, v2, v202, v203
    v_max3_f32 v3, v3, v204, v205
    s_waitcnt lgkmcnt(7)
    v_mfma_f32_32x32x16_bf16 v[80:95], v[244:247], v[172:175], v[80:95]
    ds_read_b128 v[236:239], v31 offset:16384
    v_max3_f32 v2, v2, v206, v207
    v_max3_f32 v3, v3, v208, v209
    v_max3_f32 v2, v2, v210, v211
    v_max3_f32 v3, v3, v212, v213
    v_max3_f32 v2, v2, v214, v215
    v_max3_f32 v3, v3, v216, v217
    s_waitcnt lgkmcnt(6)
    v_mfma_f32_32x32x16_bf16 v[96:111], v[248:251], v[172:175], v[96:111]
    ds_read_b128 v[240:243], v32 offset:16384
    v_max3_f32 v2, v2, v218, v219
    v_max3_f32 v3, v3, v220, v221
    v_max3_f32 v2, v2, v222, v223
    v_max_f32 v2, v2, v3
    v_mov_b32 v3, v2
    s_nop 1
    s_waitcnt lgkmcnt(5)
    v_mfma_f32_32x32x16_bf16 v[112:127], v[252:255], v[172:175], v[112:127]
    ds_read_b128 v[244:247], v33 offset:16384
    v_permlane32_swap_b32 v2, v3
    s_nop 1
    v_max_f32 v2, v2, v3
    v_cmp_lt_f32 vcc, 0xc29c0000, v2
    s_mov_b64 s[64:65], vcc
    s_cbranch_vccz .Lk1_nors_5
    v_add_f32 v2, 0x42d80000, v2
    v_max_f32 v2, 0, v2
    v_sub_f32 v46, 0, v2
    v_exp_f32 v46, v46
    v_sub_f32 v48, v48, v2
    v_sub_f32 v49, v49, v2
    v_sub_f32 v50, v50, v2
    v_sub_f32 v51, v51, v2
    v_sub_f32 v52, v52, v2
    v_sub_f32 v53, v53, v2
    v_sub_f32 v54, v54, v2
    v_sub_f32 v55, v55, v2
    v_sub_f32 v56, v56, v2
    v_sub_f32 v57, v57, v2
    v_sub_f32 v58, v58, v2
    v_sub_f32 v59, v59, v2
    v_sub_f32 v60, v60, v2
    v_sub_f32 v61, v61, v2
    v_sub_f32 v62, v62, v2
    v_sub_f32 v63, v63, v2
    v_sub_f32 v192, v192, v2
    v_sub_f32 v193, v193, v2
    v_sub_f32 v194, v194, v2
    v_sub_f32 v195, v195, v2
    v_sub_f32 v196, v196, v2
    v_sub_f32 v197, v197, v2
    v_sub_f32 v198, v198, v2
    v_sub_f32 v199, v199, v2
    v_sub_f32 v200, v200, v2
    v_sub_f32 v201, v201, v2
    v_sub_f32 v202, v202, v2
    v_sub_f32 v203, v203, v2
    v_sub_f32 v204, v204, v2
    v_sub_f32 v205, v205, v2
    v_sub_f32 v206, v206, v2
    v_sub_f32 v207, v207, v2
    v_sub_f32 v208, v208, v2
    v_sub_f32 v209, v209, v2
    v_sub_f32 v210, v210, v2
    v_sub_f32 v211, v211, v2
    v_sub_f32 v212, v212, v2
    v_sub_f32 v213, v213, v2
    v_sub_f32 v214, v214, v2
    v_sub_f32 v215, v215, v2
    v_sub_f32 v216, v216, v2
    v_sub_f32 v217, v217, v2
    v_sub_f32 v218, v218, v2
    v_sub_f32 v219, v219, v2
    v_sub_f32 v220, v220, v2
    v_sub_f32 v221, v221, v2
    v_sub_f32 v222, v222, v2
    v_sub_f32 v223, v223, v2
    v_mul_f32 v44, v44, v46
.Lk1_nors_5:
    s_waitcnt lgkmcnt(5)
    v_mfma_f32_32x32x16_bf16 v[160:175], v[224:227], v[128:131], v[48:63]
    ds_read_b128 v[248:251], v34 offset:16384
    v_exp_f32 v192, v192
    v_exp_f32 v193, v193
    v_exp_f32 v194, v194
    s_waitcnt lgkmcnt(5)
    v_mfma_f32_32x32x16_bf16 v[160:175], v[228:231], v[132:135], v[160:175]
    ds_read_b128 v[252:255], v35 offset:16384
    v_exp_f32 v195, v195
    v_exp_f32 v196, v196
    v_exp_f32 v197, v197
    s_waitcnt lgkmcnt(5)
    v_mfma_f32_32x32x16_bf16 v[160:175], v[232:235], v[136:139], v[160:175]
    ds_read_b128 v[224:227], v28 offset:24576
    v_exp_f32 v198, v198
    v_exp_f32 v199, v199
    s_nop 0
    s_waitcnt lgkmcnt(5)
    v_mfma_f32_32x32x16_bf16 v[160:175], v[236:239], v[140:143], v[160:175]
    ds_read_b128 v[228:231], v29 offset:24576
    v_mov_b32 v10, v192
    v_mov_b32 v11, v193
    s_waitcnt lgkmcnt(5)
    v_mfma_f32_32x32x16_bf16 v[160:175], v[240:243], v[144:147], v[160:175]
    ds_read_b128 v[232:235], v30 offset:24576
    v_cvt_pk_bf16_f32 v192, v192, v193
    v_add_f32 v10, v10, v194
    v_add_f32 v11, v11, v195
    s_waitcnt lgkmcnt(5)
    v_mfma_f32_32x32x16_bf16 v[160:175], v[244:247], v[148:151], v[160:175]
    ds_read_b128 v[236:239], v31 offset:24576
    v_cvt_pk_bf16_f32 v193, v194, v195
    v_add_f32 v10, v10, v196
    v_add_f32 v11, v11, v197
    s_waitcnt lgkmcnt(5)
    v_mfma_f32_32x32x16_bf16 v[160:175], v[248:251], v[152:155], v[160:175]
    ds_read_b128 v[240:243], v32 offset:24576
    v_cvt_pk_bf16_f32 v194, v196, v197
    v_add_f32 v10, v10, v198
    v_add_f32 v11, v11, v199
    s_waitcnt lgkmcnt(5)
    v_mfma_f32_32x32x16_bf16 v[160:175], v[252:255], v[156:159], v[160:175]
    ds_read_b128 v[244:247], v33 offset:24576
    v_cvt_pk_bf16_f32 v195, v198, v199
    s_cmp_eq_u64 s[64:65], 0
    s_cbranch_scc1 .Lk1_nors2_5
    v_mul_f32 v64, v46, v64
    v_mul_f32 v65, v46, v65
    v_mul_f32 v66, v46, v66
    v_mul_f32 v67, v46, v67
    v_mul_f32 v68, v46, v68
    v_mul_f32 v69, v46, v69
    v_mul_f32 v70, v46, v70
    v_mul_f32 v71, v46, v71
    v_mul_f32 v72, v46, v72
    v_mul_f32 v73, v46, v73
    v_mul_f32 v74, v46, v74
    v_mul_f32 v75, v46, v75
    v_mul_f32 v76, v46, v76
    v_mul_f32 v77, v46, v77
    v_mul_f32 v78, v46, v78
    v_mul_f32 v79, v46, v79
    v_mul_f32 v80, v46, v80
    v_mul_f32 v81, v46, v81
    v_mul_f32 v82, v46, v82
    v_mul_f32 v83, v46, v83
    v_mul_f32 v84, v46, v84
    v_mul_f32 v85, v46, v85
    v_mul_f32 v86, v46, v86
    v_mul_f32 v87, v46, v87
    v_mul_f32 v88, v46, v88
    v_mul_f32 v89, v46, v89
    v_mul_f32 v90, v46, v90
    v_mul_f32 v91, v46, v91
    v_mul_f32 v92, v46, v92
    v_mul_f32 v93, v46, v93
    v_mul_f32 v94, v46, v94
    v_mul_f32 v95, v46, v95
    v_mul_f32 v96, v46, v96
    v_mul_f32 v97, v46, v97
    v_mul_f32 v98, v46, v98
    v_mul_f32 v99, v46, v99
    v_mul_f32 v100, v46, v100
    v_mul_f32 v101, v46, v101
    v_mul_f32 v102, v46, v102
    v_mul_f32 v103, v46, v103
    v_mul_f32 v104, v46, v104
    v_mul_f32 v105, v46, v105
    v_mul_f32 v106, v46, v106
    v_mul_f32 v107, v46, v107
    v_mul_f32 v108, v46, v108
    v_mul_f32 v109, v46, v109
    v_mul_f32 v110, v46, v110
    v_mul_f32 v111, v46, v111
    v_mul_f32 v112, v46, v112
    v_mul_f32 v113, v46, v113
    v_mul_f32 v114, v46, v114
    v_mul_f32 v115, v46, v115
    v_mul_f32 v116, v46, v116
    v_mul_f32 v117, v46, v117
    v_mul_f32 v118, v46, v118
    v_mul_f32 v119, v46, v119
    v_mul_f32 v120, v46, v120
    v_mul_f32 v121, v46, v121
    v_mul_f32 v122, v46, v122
    v_mul_f32 v123, v46, v123
    v_mul_f32 v124, v46, v124
    v_mul_f32 v125, v46, v125
    v_mul_f32 v126, v46, v126
    v_mul_f32 v127, v46, v127
.Lk1_nors2_5:
    s_waitcnt lgkmcnt(5)
    v_mfma_f32_32x32x16_bf16 v[176:191], v[224:227], v[128:131], v[48:63]
    ds_read_b128 v[248:251], v34 offset:24576
    v_exp_f32 v200, v200
    v_exp_f32 v201, v201
    v_exp_f32 v202, v202
    s_waitcnt lgkmcnt(5)
    v_mfma_f32_32x32x16_bf16 v[176:191], v[228:231], v[132:135], v[176:191]
    ds_read_b128 v[252:255], v35 offset:24576
    v_exp_f32 v203, v203
    v_exp_f32 v204, v204
    v_exp_f32 v205, v205
    s_waitcnt lgkmcnt(5)
    v_mfma_f32_32x32x16_bf16 v[176:191], v[232:235], v[136:139], v[176:191]
    ds_read_b64_tr_b16 v[224:225], v36 offset:32768
    ds_read_b64_tr_b16 v[226:227], v36 offset:33792
    v_exp_f32 v206, v206
    v_exp_f32 v207, v207
    s_nop 0
    s_waitcnt lgkmcnt(6)
    v_mfma_f32_32x32x16_bf16 v[176:191], v[236:239], v[140:143], v[176:191]
    ds_read_b64_tr_b16 v[228:229], v37 offset:32768
    ds_read_b64_tr_b16 v[230:231], v37 offset:33792
    v_add_f32 v10, v10, v200
    v_add_f32 v11, v11, v201
    s_waitcnt lgkmcnt(7)
    v_mfma_f32_32x32x16_bf16 v[176:191], v[240:243], v[144:147], v[176:191]
    ds_read_b64_tr_b16 v[232:233], v38 offset:32768
    ds_read_b64_tr_b16 v[234:235], v38 offset:33792
    v_cvt_pk_bf16_f32 v196, v200, v201
    v_add_f32 v10, v10, v202
    v_add_f32 v11, v11, v203
    s_waitcnt lgkmcnt(8)
    v_mfma_f32_32x32x16_bf16 v[176:191], v[244:247], v[148:151], v[176:191]
    ds_read_b64_tr_b16 v[236:237], v39 offset:32768
    ds_read_b64_tr_b16 v[238:239], v39 offset:33792
    v_cvt_pk_bf16_f32 v197, v202, v203
    v_add_f32 v10, v10, v204
    v_add_f32 v11, v11, v205
    s_waitcnt lgkmcnt(9)
    v_mfma_f32_32x32x16_bf16 v[176:191], v[248:251], v[152:155], v[176:191]
    ds_read_b64_tr_b16 v[240:241], v36 offset:36864
    ds_read_b64_tr_b16 v[242:243], v36 offset:37888
    v_cvt_pk_bf16_f32 v198, v204, v205
    v_add_f32 v10, v10, v206
    v_add_f32 v11, v11, v207
    s_waitcnt lgkmcnt(10)
    v_mfma_f32_32x32x16_bf16 v[176:191], v[252:255], v[156:159], v[176:191]
    ds_read_b64_tr_b16 v[244:245], v37 offset:36864
    ds_read_b64_tr_b16 v[246:247], v37 offset:37888
    v_cvt_pk_bf16_f32 v199, v206, v207
    s_nop 1
    s_waitcnt lgkmcnt(10)
    v_mfma_f32_32x32x16_bf16 v[64:79], v[224:227], v[192:195], v[64:79]
    ds_read_b64_tr_b16 v[248:249], v38 offset:36864
    ds_read_b64_tr_b16 v[250:251], v38 offset:37888
    v_exp_f32 v208, v208
    v_exp_f32 v209, v209
    v_exp_f32 v210, v210
    v_exp_f32 v211, v211
    s_waitcnt lgkmcnt(10)
    v_mfma_f32_32x32x16_bf16 v[80:95], v[228:231], v[192:195], v[80:95]
    ds_read_b64_tr_b16 v[252:253], v39 offset:36864
    ds_read_b64_tr_b16 v[254:255], v39 offset:37888
    v_exp_f32 v212, v212
    v_exp_f32 v213, v213
    v_exp_f32 v214, v214
    v_exp_f32 v215, v215
    s_waitcnt lgkmcnt(10)
    v_mfma_f32_32x32x16_bf16 v[96:111], v[232:235], v[192:195], v[96:111]
    ds_read_b64_tr_b16 v[224:225], v36 offset:40960
    ds_read_b64_tr_b16 v[226:227], v36 offset:41984
    s_nop 0
    v_add_f32 v10, v10, v208
    v_add_f32 v11, v11, v209
    s_waitcnt lgkmcnt(10)
    v_mfma_f32_32x32x16_bf16 v[112:127], v[236:239], v[192:195], v[112:127]
    ds_read_b64_tr_b16 v[228:229], v37 offset:40960
    ds_read_b64_tr_b16 v[230:231], v37 offset:41984
    v_cvt_pk_bf16_f32 v200, v208, v209
    v_add_f32 v10, v10, v210
    v_add_f32 v11, v11, v211
    v_cvt_pk_bf16_f32 v201, v210, v211
    s_waitcnt lgkmcnt(10)
    v_mfma_f32_32x32x16_bf16 v[64:79], v[240:243], v[196:199], v[64:79]
    ds_read_b64_tr_b16 v[232:233], v38 offset:40960
    ds_read_b64_tr_b16 v[234:235], v38 offset:41984
    v_add_f32 v10, v10, v212
    v_add_f32 v11, v11, v213
    v_cvt_pk_bf16_f32 v202, v212, v213
    v_add_f32 v10, v10, v214
    s_waitcnt lgkmcnt(10)
    v_mfma_f32_32x32x16_bf16 v[80:95], v[244:247], v[196:199], v[80:95]
    ds_read_b64_tr_b16 v[236:237], v39 offset:40960
    ds_read_b64_tr_b16 v[238:239], v39 offset:41984
    v_add_f32 v11, v11, v215
    v_cvt_pk_bf16_f32 v203, v214, v215
    s_nop 1
    s_waitcnt lgkmcnt(10)
    v_mfma_f32_32x32x16_bf16 v[96:111], v[248:251], v[196:199], v[96:111]
    ds_read_b64_tr_b16 v[240:241], v36 offset:45056
    ds_read_b64_tr_b16 v[242:243], v36 offset:46080
    v_exp_f32 v216, v216
    v_exp_f32 v217, v217
    v_exp_f32 v218, v218
    v_exp_f32 v219, v219
    s_waitcnt lgkmcnt(10)
    v_mfma_f32_32x32x16_bf16 v[112:127], v[252:255], v[196:199], v[112:127]
    ds_read_b64_tr_b16 v[244:245], v37 offset:45056
    ds_read_b64_tr_b16 v[246:247], v37 offset:46080
    v_exp_f32 v220, v220
    v_exp_f32 v221, v221
    v_exp_f32 v222, v222
    s_waitcnt lgkmcnt(10)
    v_mfma_f32_32x32x16_bf16 v[64:79], v[224:227], v[200:203], v[64:79]
    ds_read_b64_tr_b16 v[248:249], v38 offset:45056
    ds_read_b64_tr_b16 v[250:251], v38 offset:46080
    v_exp_f32 v223, v223
    s_nop 0
    v_add_f32 v10, v10, v216
    v_add_f32 v11, v11, v217
    v_cvt_pk_bf16_f32 v204, v216, v217
    s_waitcnt lgkmcnt(10)
    v_mfma_f32_32x32x16_bf16 v[80:95], v[228:231], v[200:203], v[80:95]
    ds_read_b64_tr_b16 v[252:253], v39 offset:45056
    ds_read_b64_tr_b16 v[254:255], v39 offset:46080
    v_add_f32 v10, v10, v218
    v_add_f32 v11, v11, v219
    v_cvt_pk_bf16_f32 v205, v218, v219
    v_add_f32 v10, v10, v220
    s_waitcnt lgkmcnt(10)
    v_mfma_f32_32x32x16_bf16 v[96:111], v[232:235], v[200:203], v[96:111]
    v_add_f32 v11, v11, v221
    v_cvt_pk_bf16_f32 v206, v220, v221
    v_add_f32 v10, v10, v222
    v_add_f32 v11, v11, v223
    s_waitcnt lgkmcnt(8)
    v_mfma_f32_32x32x16_bf16 v[112:127], v[236:239], v[200:203], v[112:127]
    v_cvt_pk_bf16_f32 v207, v222, v223
    v_add_f32 v10, v10, v11
    v_add_f32 v44, v44, v10
    s_nop 1
    s_waitcnt vmcnt(1)
    s_barrier
    s_mov_b32 s46, 114688
    s_add_u32 m0, s47, 81920
    s_nop 0
    buffer_load_dwordx4 v42, s[24:27], s46 offen lds
    buffer_load_dwordx4 v42, s[24:27], s46 offen offset:1024 lds
    ds_read_b128 v[224:227], v28 offset:32768
    ds_read_b128 v[228:231], v29 offset:32768
    s_waitcnt lgkmcnt(8)
    v_mfma_f32_32x32x16_bf16 v[64:79], v[240:243], v[204:207], v[64:79]
    ds_read_b128 v[232:235], v30 offset:32768
    v_max3_f32 v2, v160, v161, v162
    v_max3_f32 v3, v163, v164, v165
    v_max3_f32 v2, v2, v166, v167
    v_max3_f32 v3, v3, v168, v169
    v_max3_f32 v2, v2, v170, v171
    v_max3_f32 v3, v3, v172, v173
    s_waitcnt lgkmcnt(7)
    v_mfma_f32_32x32x16_bf16 v[80:95], v[244:247], v[204:207], v[80:95]
    ds_read_b128 v[236:239], v31 offset:32768
    v_max3_f32 v2, v2, v174, v175
    v_max3_f32 v3, v3, v176, v177
    v_max3_f32 v2, v2, v178, v179
    v_max3_f32 v3, v3, v180, v181
    v_max3_f32 v2, v2, v182, v183
    v_max3_f32 v3, v3, v184, v185
    s_waitcnt lgkmcnt(6)
    v_mfma_f32_32x32x16_bf16 v[96:111], v[248:251], v[204:207], v[96:111]
    ds_read_b128 v[240:243], v32 offset:32768
    v_max3_f32 v2, v2, v186, v187
    v_max3_f32 v3, v3, v188, v189
    v_max3_f32 v2, v2, v190, v191
    v_max_f32 v2, v2, v3
    v_mov_b32 v3, v2
    s_nop 1
    s_waitcnt lgkmcnt(5)
    v_mfma_f32_32x32x16_bf16 v[112:127], v[252:255], v[204:207], v[112:127]
    ds_read_b128 v[244:247], v33 offset:32768
    v_permlane32_swap_b32 v2, v3
    s_nop 1
    v_max_f32 v2, v2, v3
    v_cmp_lt_f32 vcc, 0xc29c0000, v2
    s_mov_b64 s[64:65], vcc
    s_cbranch_vccz .Lk1_nors_6
    v_add_f32 v2, 0x42d80000, v2
    v_max_f32 v2, 0, v2
    v_sub_f32 v46, 0, v2
    v_exp_f32 v46, v46
    v_sub_f32 v48, v48, v2
    v_sub_f32 v49, v49, v2
    v_sub_f32 v50, v50, v2
    v_sub_f32 v51, v51, v2
    v_sub_f32 v52, v52, v2
    v_sub_f32 v53, v53, v2
    v_sub_f32 v54, v54, v2
    v_sub_f32 v55, v55, v2
    v_sub_f32 v56, v56, v2
    v_sub_f32 v57, v57, v2
    v_sub_f32 v58, v58, v2
    v_sub_f32 v59, v59, v2
    v_sub_f32 v60, v60, v2
    v_sub_f32 v61, v61, v2
    v_sub_f32 v62, v62, v2
    v_sub_f32 v63, v63, v2
    v_sub_f32 v160, v160, v2
    v_sub_f32 v161, v161, v2
    v_sub_f32 v162, v162, v2
    v_sub_f32 v163, v163, v2
    v_sub_f32 v164, v164, v2
    v_sub_f32 v165, v165, v2
    v_sub_f32 v166, v166, v2
    v_sub_f32 v167, v167, v2
    v_sub_f32 v168, v168, v2
    v_sub_f32 v169, v169, v2
    v_sub_f32 v170, v170, v2
    v_sub_f32 v171, v171, v2
    v_sub_f32 v172, v172, v2
    v_sub_f32 v173, v173, v2
    v_sub_f32 v174, v174, v2
    v_sub_f32 v175, v175, v2
    v_sub_f32 v176, v176, v2
    v_sub_f32 v177, v177, v2
    v_sub_f32 v178, v178, v2
    v_sub_f32 v179, v179, v2
    v_sub_f32 v180, v180, v2
    v_sub_f32 v181, v181, v2
    v_sub_f32 v182, v182, v2
    v_sub_f32 v183, v183, v2
    v_sub_f32 v184, v184, v2
    v_sub_f32 v185, v185, v2
    v_sub_f32 v186, v186, v2
    v_sub_f32 v187, v187, v2
    v_sub_f32 v188, v188, v2
    v_sub_f32 v189, v189, v2
    v_sub_f32 v190, v190, v2
    v_sub_f32 v191, v191, v2
    v_mul_f32 v44, v44, v46
.Lk1_nors_6:
    s_waitcnt lgkmcnt(5)
    v_mfma_f32_32x32x16_bf16 v[192:207], v[224:227], v[128:131], v[48:63]
    ds_read_b128 v[248:251], v34 offset:32768
    v_exp_f32 v160, v160
    v_exp_f32 v161, v161
    v_exp_f32 v162, v162
    s_waitcnt lgkmcnt(5)
    v_mfma_f32_32x32x16_bf16 v[192:207], v[228:231], v[132:135], v[192:207]
    ds_read_b128 v[252:255], v35 offset:32768
    v_exp_f32 v163, v163
    v_exp_f32 v164, v164
    v_exp_f32 v165, v165
    s_waitcnt lgkmcnt(5)
    v_mfma_f32_32x32x16_bf16 v[192:207], v[232:235], v[136:139], v[192:207]
    ds_read_b128 v[224:227], v28 offset:40960
    v_exp_f32 v166, v166
    v_exp_f32 v167, v167
    s_nop 0
    s_waitcnt lgkmcnt(5)
    v_mfma_f32_32x32x16_bf16 v[192:207], v[236:239], v[140:143], v[192:207]
    ds_read_b128 v[228:231], v29 offset:40960
    v_mov_b32 v10, v160
    v_mov_b32 v11, v161
    s_waitcnt lgkmcnt(5)
    v_mfma_f32_32x32x16_bf16 v[192:207], v[240:243], v[144:147], v[192:207]
    ds_read_b128 v[232:235], v30 offset:40960
    v_cvt_pk_bf16_f32 v160, v160, v161
    v_add_f32 v10, v10, v162
    v_add_f32 v11, v11, v163
    s_waitcnt lgkmcnt(5)
    v_mfma_f32_32x32x16_bf16 v[192:207], v[244:247], v[148:151], v[192:207]
    ds_read_b128 v[236:239], v31 offset:40960
    v_cvt_pk_bf16_f32 v161, v162, v163
    v_add_f32 v10, v10, v164
    v_add_f32 v11, v11, v165
    s_waitcnt lgkmcnt(5)
    v_mfma_f32_32x32x16_bf16 v[192:207], v[248:251], v[152:155], v[192:207]
    ds_read_b128 v[240:243], v32 offset:40960
    v_cvt_pk_bf16_f32 v162, v164, v165
    v_add_f32 v10, v10, v166
    v_add_f32 v11, v11, v167
    s_waitcnt lgkmcnt(5)
    v_mfma_f32_32x32x16_bf16 v[192:207], v[252:255], v[156:159], v[192:207]
    ds_read_b128 v[244:247], v33 offset:40960
    v_cvt_pk_bf16_f32 v163, v166, v167
    s_cmp_eq_u64 s[64:65], 0
    s_cbranch_scc1 .Lk1_nors2_6
    v_mul_f32 v64, v46, v64
    v_mul_f32 v65, v46, v65
    v_mul_f32 v66, v46, v66
    v_mul_f32 v67, v46, v67
    v_mul_f32 v68, v46, v68
    v_mul_f32 v69, v46, v69
    v_mul_f32 v70, v46, v70
    v_mul_f32 v71, v46, v71
    v_mul_f32 v72, v46, v72
    v_mul_f32 v73, v46, v73
    v_mul_f32 v74, v46, v74
    v_mul_f32 v75, v46, v75
    v_mul_f32 v76, v46, v76
    v_mul_f32 v77, v46, v77
    v_mul_f32 v78, v46, v78
    v_mul_f32 v79, v46, v79
    v_mul_f32 v80, v46, v80
    v_mul_f32 v81, v46, v81
    v_mul_f32 v82, v46, v82
    v_mul_f32 v83, v46, v83
    v_mul_f32 v84, v46, v84
    v_mul_f32 v85, v46, v85
    v_mul_f32 v86, v46, v86
    v_mul_f32 v87, v46, v87
    v_mul_f32 v88, v46, v88
    v_mul_f32 v89, v46, v89
    v_mul_f32 v90, v46, v90
    v_mul_f32 v91, v46, v91
    v_mul_f32 v92, v46, v92
    v_mul_f32 v93, v46, v93
    v_mul_f32 v94, v46, v94
    v_mul_f32 v95, v46, v95
    v_mul_f32 v96, v46, v96
    v_mul_f32 v97, v46, v97
    v_mul_f32 v98, v46, v98
    v_mul_f32 v99, v46, v99
    v_mul_f32 v100, v46, v100
    v_mul_f32 v101, v46, v101
    v_mul_f32 v102, v46, v102
    v_mul_f32 v103, v46, v103
    v_mul_f32 v104, v46, v104
    v_mul_f32 v105, v46, v105
    v_mul_f32 v106, v46, v106
    v_mul_f32 v107, v46, v107
    v_mul_f32 v108, v46, v108
    v_mul_f32 v109, v46, v109
    v_mul_f32 v110, v46, v110
    v_mul_f32 v111, v46, v111
    v_mul_f32 v112, v46, v112
    v_mul_f32 v113, v46, v113
    v_mul_f32 v114, v46, v114
    v_mul_f32 v115, v46, v115
    v_mul_f32 v116, v46, v116
    v_mul_f32 v117, v46, v117
    v_mul_f32 v118, v46, v118
    v_mul_f32 v119, v46, v119
    v_mul_f32 v120, v46, v120
    v_mul_f32 v121, v46, v121
    v_mul_f32 v122, v46, v122
    v_mul_f32 v123, v46, v123
    v_mul_f32 v124, v46, v124
    v_mul_f32 v125, v46, v125
    v_mul_f32 v126, v46, v126
    v_mul_f32 v127, v46, v127
.Lk1_nors2_6:
    s_waitcnt lgkmcnt(5)
    v_mfma_f32_32x32x16_bf16 v[208:223], v[224:227], v[128:131], v[48:63]
    ds_read_b128 v[248:251], v34 offset:40960
    v_exp_f32 v168, v168
    v_exp_f32 v169, v169
    v_exp_f32 v170, v170
    s_waitcnt lgkmcnt(5)
    v_mfma_f32_32x32x16_bf16 v[208:223], v[228:231], v[132:135], v[208:223]
    ds_read_b128 v[252:255], v35 offset:40960
    v_exp_f32 v171, v171
    v_exp_f32 v172, v172
    v_exp_f32 v173, v173
    s_waitcnt lgkmcnt(5)
    v_mfma_f32_32x32x16_bf16 v[208:223], v[232:235], v[136:139], v[208:223]
    ds_read_b64_tr_b16 v[224:225], v36 offset:0
    ds_read_b64_tr_b16 v[226:227], v36 offset:1024
    v_exp_f32 v174, v174
    v_exp_f32 v175, v175
    s_nop 0
    s_waitcnt lgkmcnt(6)
    v_mfma_f32_32x32x16_bf16 v[208:223], v[236:239], v[140:143], v[208:223]
    ds_read_b64_tr_b16 v[228:229], v37 offset:0
    ds_read_b64_tr_b16 v[230:231], v37 offset:1024
    v_add_f32 v10, v10, v168
    v_add_f32 v11, v11, v169
    s_waitcnt lgkmcnt(7)
    v_mfma_f32_32x32x16_bf16 v[208:223], v[240:243], v[144:147], v[208:223]
    ds_read_b64_tr_b16 v[232:233], v38 offset:0
    ds_read_b64_tr_b16 v[234:235], v38 offset:1024
    v_cvt_pk_bf16_f32 v164, v168, v169
    v_add_f32 v10, v10, v170
    v_add_f32 v11, v11, v171
    s_waitcnt lgkmcnt(8)
    v_mfma_f32_32x32x16_bf16 v[208:223], v[244:247], v[148:151], v[208:223]
    ds_read_b64_tr_b16 v[236:237], v39 offset:0
    ds_read_b64_tr_b16 v[238:239], v39 offset:1024
    v_cvt_pk_bf16_f32 v165, v170, v171
    v_add_f32 v10, v10, v172
    v_add_f32 v11, v11, v173
    s_waitcnt lgkmcnt(9)
    v_mfma_f32_32x32x16_bf16 v[208:223], v[248:251], v[152:155], v[208:223]
    ds_read_b64_tr_b16 v[240:241], v36 offset:4096
    ds_read_b64_tr_b16 v[242:243], v36 offset:5120
    v_cvt_pk_bf16_f32 v166, v172, v173
    v_add_f32 v10, v10, v174
    v_add_f32 v11, v11, v175
    s_waitcnt lgkmcnt(10)
    v_mfma_f32_32x32x16_bf16 v[208:223], v[252:255], v[156:159], v[208:223]
    ds_read_b64_tr_b16 v[244:245], v37 offset:4096
    ds_read_b64_tr_b16 v[246:247], v37 offset:5120
    v_cvt_pk_bf16_f32 v167, v174, v175
    s_nop 1
    s_waitcnt lgkmcnt(10)
    v_mfma_f32_32x32x16_bf16 v[64:79], v[224:227], v[160:163], v[64:79]
    ds_read_b64_tr_b16 v[248:249], v38 offset:4096
    ds_read_b64_tr_b16 v[250:251], v38 offset:5120
    v_exp_f32 v176, v176
    v_exp_f32 v177, v177
    v_exp_f32 v178, v178
    v_exp_f32 v179, v179
    s_waitcnt lgkmcnt(10)
    v_mfma_f32_32x32x16_bf16 v[80:95], v[228:231], v[160:163], v[80:95]
    ds_read_b64_tr_b16 v[252:253], v39 offset:4096
    ds_read_b64_tr_b16 v[254:255], v39 offset:5120
    v_exp_f32 v180, v180
    v_exp_f32 v181, v181
    v_exp_f32 v182, v182
    v_exp_f32 v183, v183
    s_waitcnt lgkmcnt(10)
    v_mfma_f32_32x32x16_bf16 v[96:111], v[232:235], v[160:163], v[96:111]
    ds_read_b64_tr_b16 v[224:225], v36 offset:8192
    ds_read_b64_tr_b16 v[226:227], v36 offset:9216
    s_nop 0
    v_add_f32 v10, v10, v176
    v_add_f32 v11, v11, v177
    s_waitcnt lgkmcnt(10)
    v_mfma_f32_32x32x16_bf16 v[112:127], v[236:239], v[160:163], v[112:127]
    ds_read_b64_tr_b16 v[228:229], v37 offset:8192
    ds_read_b64_tr_b16 v[230:231], v37 offset:9216
    v_cvt_pk_bf16_f32 v168, v176, v177
    v_add_f32 v10, v10, v178
    v_add_f32 v11, v11, v179
    v_cvt_pk_bf16_f32 v169, v178, v179
    s_waitcnt lgkmcnt(10)
    v_mfma_f32_32x32x16_bf16 v[64:79], v[240:243], v[164:167], v[64:79]
    ds_read_b64_tr_b16 v[232:233], v38 offset:8192
    ds_read_b64_tr_b16 v[234:235], v38 offset:9216
    v_add_f32 v10, v10, v180
    v_add_f32 v11, v11, v181
    v_cvt_pk_bf16_f32 v170, v180, v181
    v_add_f32 v10, v10, v182
    s_waitcnt lgkmcnt(10)
    v_mfma_f32_32x32x16_bf16 v[80:95], v[244:247], v[164:167], v[80:95]
    ds_read_b64_tr_b16 v[236:237], v39 offset:8192
    ds_read_b64_tr_b16 v[238:239], v39 offset:9216
    v_add_f32 v11, v11, v183
    v_cvt_pk_bf16_f32 v171, v182, v183
    s_nop 1
    s_waitcnt lgkmcnt(10)
    v_mfma_f32_32x32x16_bf16 v[96:111], v[248:251], v[164:167], v[96:111]
    ds_read_b64_tr_b16 v[240:241], v36 offset:12288
    ds_read_b64_tr_b16 v[242:243], v36 offset:13312
    v_exp_f32 v184, v184
    v_exp_f32 v185, v185
    v_exp_f32 v186, v186
    v_exp_f32 v187, v187
    s_waitcnt lgkmcnt(10)
    v_mfma_f32_32x32x16_bf16 v[112:127], v[252:255], v[164:167], v[112:127]
    ds_read_b64_tr_b16 v[244:245], v37 offset:12288
    ds_read_b64_tr_b16 v[246:247], v37 offset:13312
    v_exp_f32 v188, v188
    v_exp_f32 v189, v189
    v_exp_f32 v190, v190
    s_waitcnt lgkmcnt(10)
    v_mfma_f32_32x32x16_bf16 v[64:79], v[224:227], v[168:171], v[64:79]
    ds_read_b64_tr_b16 v[248:249], v38 offset:12288
    ds_read_b64_tr_b16 v[250:251], v38 offset:13312
    v_exp_f32 v191, v191
    s_nop 0
    v_add_f32 v10, v10, v184
    v_add_f32 v11, v11, v185
    v_cvt_pk_bf16_f32 v172, v184, v185
    s_waitcnt lgkmcnt(10)
    v_mfma_f32_32x32x16_bf16 v[80:95], v[228:231], v[168:171], v[80:95]
    ds_read_b64_tr_b16 v[252:253], v39 offset:12288
    ds_read_b64_tr_b16 v[254:255], v39 offset:13312
    v_add_f32 v10, v10, v186
    v_add_f32 v11, v11, v187
    v_cvt_pk_bf16_f32 v173, v186, v187
    v_add_f32 v10, v10, v188
    s_waitcnt lgkmcnt(10)
    v_mfma_f32_32x32x16_bf16 v[96:111], v[232:235], v[168:171], v[96:111]
    v_add_f32 v11, v11, v189
    v_cvt_pk_bf16_f32 v174, v188, v189
    v_add_f32 v10, v10, v190
    v_add_f32 v11, v11, v191
    s_waitcnt lgkmcnt(8)
    v_mfma_f32_32x32x16_bf16 v[112:127], v[236:239], v[168:171], v[112:127]
    v_cvt_pk_bf16_f32 v175, v190, v191
    v_add_f32 v10, v10, v11
    v_add_f32 v44, v44, v10
    s_nop 1
    s_waitcnt vmcnt(0)
    s_barrier
    s_lshl_b32 s44, s40, 7
    s_add_u32 m0, s43, 32768
    s_nop 0
    buffer_load_dwordx4 v27, s[28:31], s44 offen  lds
    s_add_u32 s44, s44, 8192
    s_add_u32 m0, s43, 33792
    s_nop 0
    buffer_load_dwordx4 v27, s[28:31], s44 offen  lds
    s_add_u32 s44, s44, 8192
    s_add_u32 m0, s43, 49152
    s_nop 0
    buffer_load_dwordx4 v27, s[28:31], s44 offen  lds
    s_add_u32 s44, s44, 8192
    s_add_u32 m0, s43, 50176
    s_nop 0
    buffer_load_dwordx4 v27, s[28:31], s44 offen  lds
    s_add_u32 s44, s44, 8192
    s_add_u32 m0, s43, 65536
    s_nop 0
    buffer_load_dwordx4 v27, s[28:31], s44 offen  lds
    s_add_u32 s44, s44, 8192
    s_add_u32 m0, s43, 66560
    s_nop 0
    buffer_load_dwordx4 v27, s[28:31], s44 offen  lds
    s_add_u32 s44, s44, 8192
    s_add_u32 m0, s43, 81920
    s_nop 0
    buffer_load_dwordx4 v27, s[28:31], s44 offen  lds
    s_add_u32 s44, s44, 8192
    s_add_u32 m0, s43, 82944
    s_nop 0
    buffer_load_dwordx4 v27, s[28:31], s44 offen  lds
    s_add_u32 s44, s44, 8192
    ds_read_b64_tr_b16 v[224:225], v36 offset:16384
    ds_read_b64_tr_b16 v[226:227], v36 offset:17408
    ds_read_b64_tr_b16 v[228:229], v37 offset:16384
    ds_read_b64_tr_b16 v[230:231], v37 offset:17408
    s_waitcnt lgkmcnt(10)
    v_mfma_f32_32x32x16_bf16 v[64:79], v[240:243], v[172:175], v[64:79]
    ds_read_b64_tr_b16 v[232:233], v38 offset:16384
    ds_read_b64_tr_b16 v[234:235], v38 offset:17408
    v_max3_f32 v2, v192, v193, v194
    v_max3_f32 v3, v195, v196, v197
    v_max3_f32 v2, v2, v198, v199
    v_max3_f32 v3, v3, v200, v201
    v_max3_f32 v2, v2, v202, v203
    v_max3_f32 v3, v3, v204, v205
    s_waitcnt lgkmcnt(10)
    v_mfma_f32_32x32x16_bf16 v[80:95], v[244:247], v[172:175], v[80:95]
    ds_read_b64_tr_b16 v[236:237], v39 offset:16384
    ds_read_b64_tr_b16 v[238:239], v39 offset:17408
    v_max3_f32 v2, v2, v206, v207
    v_max3_f32 v3, v3, v208, v209
    v_max3_f32 v2, v2, v210, v211
    v_max3_f32 v3, v3, v212, v213
    v_max3_f32 v2, v2, v214, v215
    v_max3_f32 v3, v3, v216, v217
    s_waitcnt lgkmcnt(10)
    v_mfma_f32_32x32x16_bf16 v[96:111], v[248:251], v[172:175], v[96:111]
    ds_read_b64_tr_b16 v[240:241], v36 offset:20480
    ds_read_b64_tr_b16 v[242:243], v36 offset:21504
    v_max3_f32 v2, v2, v218, v219
    v_max3_f32 v3, v3, v220, v221
    v_max3_f32 v2, v2, v222, v223
    v_max_f32 v2, v2, v3
    v_mov_b32 v3, v2
    s_nop 1
    s_waitcnt lgkmcnt(10)
    v_mfma_f32_32x32x16_bf16 v[112:127], v[252:255], v[172:175], v[112:127]
    ds_read_b64_tr_b16 v[244:245], v37 offset:20480
    ds_read_b64_tr_b16 v[246:247], v37 offset:21504
    v_permlane32_swap_b32 v2, v3
    s_nop 1
    v_max_f32 v2, v2, v3
    v_cmp_lt_f32 vcc, 0xc29c0000, v2
    s_mov_b64 s[64:65], vcc
    s_cbranch_vccz .Lk1_nors_7
    v_add_f32 v2, 0x42d80000, v2
    v_max_f32 v2, 0, v2
    v_sub_f32 v46, 0, v2
    v_exp_f32 v46, v46
    v_sub_f32 v48, v48, v2
    v_sub_f32 v49, v49, v2
    v_sub_f32 v50, v50, v2
    v_sub_f32 v51, v51, v2
    v_sub_f32 v52, v52, v2
    v_sub_f32 v53, v53, v2
    v_sub_f32 v54, v54, v2
    v_sub_f32 v55, v55, v2
    v_sub_f32 v56, v56, v2
    v_sub_f32 v57, v57, v2
    v_sub_f32 v58, v58, v2
    v_sub_f32 v59, v59, v2
    v_sub_f32 v60, v60, v2
    v_sub_f32 v61, v61, v2
    v_sub_f32 v62, v62, v2
    v_sub_f32 v63, v63, v2
    v_sub_f32 v192, v192, v2
    v_sub_f32 v193, v193, v2
    v_sub_f32 v194, v194, v2
    v_sub_f32 v195, v195, v2
    v_sub_f32 v196, v196, v2
    v_sub_f32 v197, v197, v2
    v_sub_f32 v198, v198, v2
    v_sub_f32 v199, v199, v2
    v_sub_f32 v200, v200, v2
    v_sub_f32 v201, v201, v2
    v_sub_f32 v202, v202, v2
    v_sub_f32 v203, v203, v2
    v_sub_f32 v204, v204, v2
    v_sub_f32 v205, v205, v2
    v_sub_f32 v206, v206, v2
    v_sub_f32 v207, v207, v2
    v_sub_f32 v208, v208, v2
    v_sub_f32 v209, v209, v2
    v_sub_f32 v210, v210, v2
    v_sub_f32 v211, v211, v2
    v_sub_f32 v212, v212, v2
    v_sub_f32 v213, v213, v2
    v_sub_f32 v214, v214, v2
    v_sub_f32 v215, v215, v2
    v_sub_f32 v216, v216, v2
    v_sub_f32 v217, v217, v2
    v_sub_f32 v218, v218, v2
    v_sub_f32 v219, v219, v2
    v_sub_f32 v220, v220, v2
    v_sub_f32 v221, v221, v2
    v_sub_f32 v222, v222, v2
    v_sub_f32 v223, v223, v2
    v_mul_f32 v44, v44, v46
.Lk1_nors_7:
    v_exp_f32 v192, v192
    v_exp_f32 v193, v193
    v_exp_f32 v194, v194
    v_exp_f32 v195, v195
    v_exp_f32 v196, v196
    v_exp_f32 v197, v197
    v_exp_f32 v198, v198
    v_exp_f32 v199, v199
    s_nop 0
    v_mov_b32 v10, v192
    v_mov_b32 v11, v193
    v_cvt_pk_bf16_f32 v192, v192, v193
    v_add_f32 v10, v10, v194
    v_add_f32 v11, v11, v195
    v_cvt_pk_bf16_f32 v193, v194, v195
    v_add_f32 v10, v10, v196
    v_add_f32 v11, v11, v197
    v_cvt_pk_bf16_f32 v194, v196, v197
    v_add_f32 v10, v10, v198
    v_add_f32 v11, v11, v199
    v_cvt_pk_bf16_f32 v195, v198, v199
    s_cmp_eq_u64 s[64:65], 0
    s_cbranch_scc1 .Lk1_nors2_7
    v_mul_f32 v64, v46, v64
    v_mul_f32 v65, v46, v65
    v_mul_f32 v66, v46, v66
    v_mul_f32 v67, v46, v67
    v_mul_f32 v68, v46, v68
    v_mul_f32 v69, v46, v69
    v_mul_f32 v70, v46, v70
    v_mul_f32 v71, v46, v71
    v_mul_f32 v72, v46, v72
    v_mul_f32 v73, v46, v73
    v_mul_f32 v74, v46, v74
    v_mul_f32 v75, v46, v75
    v_mul_f32 v76, v46, v76
    v_mul_f32 v77, v46, v77
    v_mul_f32 v78, v46, v78
    v_mul_f32 v79, v46, v79
    v_mul_f32 v80, v46, v80
    v_mul_f32 v81, v46, v81
    v_mul_f32 v82, v46, v82
    v_mul_f32 v83, v46, v83
    v_mul_f32 v84, v46, v84
    v_mul_f32 v85, v46, v85
    v_mul_f32 v86, v46, v86
    v_mul_f32 v87, v46, v87
    v_mul_f32 v88, v46, v88
    v_mul_f32 v89, v46, v89
    v_mul_f32 v90, v46, v90
    v_mul_f32 v91, v46, v91
    v_mul_f32 v92, v46, v92
    v_mul_f32 v93, v46, v93
    v_mul_f32 v94, v46, v94
    v_mul_f32 v95, v46, v95
    v_mul_f32 v96, v46, v96
    v_mul_f32 v97, v46, v97
    v_mul_f32 v98, v46, v98
    v_mul_f32 v99, v46, v99
    v_mul_f32 v100, v46, v100
    v_mul_f32 v101, v46, v101
    v_mul_f32 v102, v46, v102
    v_mul_f32 v103, v46, v103
    v_mul_f32 v104, v46, v104
    v_mul_f32 v105, v46, v105
    v_mul_f32 v106, v46, v106
    v_mul_f32 v107, v46, v107
    v_mul_f32 v108, v46, v108
    v_mul_f32 v109, v46, v109
    v_mul_f32 v110, v46, v110
    v_mul_f32 v111, v46, v111
    v_mul_f32 v112, v46, v112
    v_mul_f32 v113, v46, v113
    v_mul_f32 v114, v46, v114
    v_mul_f32 v115, v46, v115
    v_mul_f32 v116, v46, v116
    v_mul_f32 v117, v46, v117
    v_mul_f32 v118, v46, v118
    v_mul_f32 v119, v46, v119
    v_mul_f32 v120, v46, v120
    v_mul_f32 v121, v46, v121
    v_mul_f32 v122, v46, v122
    v_mul_f32 v123, v46, v123
    v_mul_f32 v124, v46, v124
    v_mul_f32 v125, v46, v125
    v_mul_f32 v126, v46, v126
    v_mul_f32 v127, v46, v127
.Lk1_nors2_7:
    v_exp_f32 v200, v200
    v_exp_f32 v201, v201
    v_exp_f32 v202, v202
    v_exp_f32 v203, v203
    v_exp_f32 v204, v204
    v_exp_f32 v205, v205
    v_exp_f32 v206, v206
    v_exp_f32 v207, v207
    s_nop 0
    v_add_f32 v10, v10, v200
    v_add_f32 v11, v11, v201
    v_cvt_pk_bf16_f32 v196, v200, v201
    v_add_f32 v10, v10, v202
    v_add_f32 v11, v11, v203
    v_cvt_pk_bf16_f32 v197, v202, v203
    v_add_f32 v10, v10, v204
    v_add_f32 v11, v11, v205
    v_cvt_pk_bf16_f32 v198, v204, v205
    v_add_f32 v10, v10, v206
    v_add_f32 v11, v11, v207
    v_cvt_pk_bf16_f32 v199, v206, v207
    s_nop 1
    s_waitcnt lgkmcnt(10)
    v_mfma_f32_32x32x16_bf16 v[64:79], v[224:227], v[192:195], v[64:79]
    ds_read_b64_tr_b16 v[248:249], v38 offset:20480
    ds_read_b64_tr_b16 v[250:251], v38 offset:21504
    v_exp_f32 v208, v208
    v_exp_f32 v209, v209
    v_exp_f32 v210, v210
    v_exp_f32 v211, v211
    s_waitcnt lgkmcnt(10)
    v_mfma_f32_32x32x16_bf16 v[80:95], v[228:231], v[192:195], v[80:95]
    ds_read_b64_tr_b16 v[252:253], v39 offset:20480
    ds_read_b64_tr_b16 v[254:255], v39 offset:21504
    v_exp_f32 v212, v212
    v_exp_f32 v213, v213
    v_exp_f32 v214, v214
    v_exp_f32 v215, v215
    s_waitcnt lgkmcnt(10)
    v_mfma_f32_32x32x16_bf16 v[96:111], v[232:235], v[192:195], v[96:111]
    ds_read_b64_tr_b16 v[224:225], v36 offset:24576
    ds_read_b64_tr_b16 v[226:227], v36 offset:25600
    s_nop 0
    v_add_f32 v10, v10, v208
    v_add_f32 v11, v11, v209
    s_waitcnt lgkmcnt(10)
    v_mfma_f32_32x32x16_bf16 v[112:127], v[236:239], v[192:195], v[112:127]
    ds_read_b64_tr_b16 v[228:229], v37 offset:24576
    ds_read_b64_tr_b16 v[230:231], v37 offset:25600
    v_cvt_pk_bf16_f32 v200, v208, v209
    v_add_f32 v10, v10, v210
    v_add_f32 v11, v11, v211
    v_cvt_pk_bf16_f32 v201, v210, v211
    s_waitcnt lgkmcnt(10)
    v_mfma_f32_32x32x16_bf16 v[64:79], v[240:243], v[196:199], v[64:79]
    ds_read_b64_tr_b16 v[232:233], v38 offset:24576
    ds_read_b64_tr_b16 v[234:235], v38 offset:25600
    v_add_f32 v10, v10, v212
    v_add_f32 v11, v11, v213
    v_cvt_pk_bf16_f32 v202, v212, v213
    v_add_f32 v10, v10, v214
    s_waitcnt lgkmcnt(10)
    v_mfma_f32_32x32x16_bf16 v[80:95], v[244:247], v[196:199], v[80:95]
    ds_read_b64_tr_b16 v[236:237], v39 offset:24576
    ds_read_b64_tr_b16 v[238:239], v39 offset:25600
    v_add_f32 v11, v11, v215
    v_cvt_pk_bf16_f32 v203, v214, v215
    s_nop 1
    s_waitcnt lgkmcnt(10)
    v_mfma_f32_32x32x16_bf16 v[96:111], v[248:251], v[196:199], v[96:111]
    ds_read_b64_tr_b16 v[240:241], v36 offset:28672
    ds_read_b64_tr_b16 v[242:243], v36 offset:29696
    v_exp_f32 v216, v216
    v_exp_f32 v217, v217
    v_exp_f32 v218, v218
    v_exp_f32 v219, v219
    s_waitcnt lgkmcnt(10)
    v_mfma_f32_32x32x16_bf16 v[112:127], v[252:255], v[196:199], v[112:127]
    ds_read_b64_tr_b16 v[244:245], v37 offset:28672
    ds_read_b64_tr_b16 v[246:247], v37 offset:29696
    v_exp_f32 v220, v220
    v_exp_f32 v221, v221
    v_exp_f32 v222, v222
    s_waitcnt lgkmcnt(10)
    v_mfma_f32_32x32x16_bf16 v[64:79], v[224:227], v[200:203], v[64:79]
    ds_read_b64_tr_b16 v[248:249], v38 offset:28672
    ds_read_b64_tr_b16 v[250:251], v38 offset:29696
    v_exp_f32 v223, v223
    s_nop 0
    v_add_f32 v10, v10, v216
    v_add_f32 v11, v11, v217
    v_cvt_pk_bf16_f32 v204, v216, v217
    s_waitcnt lgkmcnt(10)
    v_mfma_f32_32x32x16_bf16 v[80:95], v[228:231], v[200:203], v[80:95]
    ds_read_b64_tr_b16 v[252:253], v39 offset:28672
    ds_read_b64_tr_b16 v[254:255], v39 offset:29696
    v_add_f32 v10, v10, v218
    v_add_f32 v11, v11, v219
    v_cvt_pk_bf16_f32 v205, v218, v219
    v_add_f32 v10, v10, v220
    s_waitcnt lgkmcnt(10)
    v_mfma_f32_32x32x16_bf16 v[96:111], v[232:235], v[200:203], v[96:111]
    v_add_f32 v11, v11, v221
    v_cvt_pk_bf16_f32 v206, v220, v221
    v_add_f32 v10, v10, v222
    v_add_f32 v11, v11, v223
    s_waitcnt lgkmcnt(8)
    v_mfma_f32_32x32x16_bf16 v[112:127], v[236:239], v[200:203], v[112:127]
    v_cvt_pk_bf16_f32 v207, v222, v223
    v_add_f32 v10, v10, v11
    v_add_f32 v44, v44, v10
    s_nop 1
    s_waitcnt lgkmcnt(6)
    v_mfma_f32_32x32x16_bf16 v[64:79], v[240:243], v[204:207], v[64:79]
    s_waitcnt lgkmcnt(4)
    v_mfma_f32_32x32x16_bf16 v[80:95], v[244:247], v[204:207], v[80:95]
    s_waitcnt lgkmcnt(2)
    v_mfma_f32_32x32x16_bf16 v[96:111], v[248:251], v[204:207], v[96:111]
    s_waitcnt lgkmcnt(0)
    v_mfma_f32_32x32x16_bf16 v[112:127], v[252:255], v[204:207], v[112:127]
    v_mov_b32 v2, v44
    v_mov_b32 v3, v44
    s_nop 1
    v_permlane32_swap_b32 v2, v3
    s_nop 1
    v_add_f32 v44, v2, v3
    v_add_u32 v50, s67, v16
    v_add_u32 v51, s67, v17
    v_add_u32 v52, s67, v18
    v_add_u32 v53, s67, v19
    v_add_u32 v54, s67, v20
    v_add_u32 v55, s67, v21
    v_add_u32 v56, s67, v22
    v_add_u32 v57, s67, v23
    v_rcp_f32 v46, v44
    s_nop 7
    s_nop 3
    v_pk_mul_f32 v[64:65], v[64:65], v[46:47] op_sel_hi:[1,0]
    v_pk_mul_f32 v[66:67], v[66:67], v[46:47] op_sel_hi:[1,0]
    v_pk_mul_f32 v[68:69], v[68:69], v[46:47] op_sel_hi:[1,0]
    v_pk_mul_f32 v[70:71], v[70:71], v[46:47] op_sel_hi:[1,0]
    v_cvt_pk_bf16_f32 v160, v64, v65
    v_cvt_pk_bf16_f32 v161, v66, v67
    v_cvt_pk_bf16_f32 v162, v68, v69
    v_cvt_pk_bf16_f32 v163, v70, v71
    ds_write_b128 v50, v[160:163]
    v_pk_mul_f32 v[72:73], v[72:73], v[46:47] op_sel_hi:[1,0]
    v_pk_mul_f32 v[74:75], v[74:75], v[46:47] op_sel_hi:[1,0]
    v_pk_mul_f32 v[76:77], v[76:77], v[46:47] op_sel_hi:[1,0]
    v_pk_mul_f32 v[78:79], v[78:79], v[46:47] op_sel_hi:[1,0]
    v_cvt_pk_bf16_f32 v164, v72, v73
    v_cvt_pk_bf16_f32 v165, v74, v75
    v_cvt_pk_bf16_f32 v166, v76, v77
    v_cvt_pk_bf16_f32 v167, v78, v79
    ds_write_b128 v51, v[164:167]
    v_pk_mul_f32 v[80:81], v[80:81], v[46:47] op_sel_hi:[1,0]
    v_pk_mul_f32 v[82:83], v[82:83], v[46:47] op_sel_hi:[1,0]
    v_pk_mul_f32 v[84:85], v[84:85], v[46:47] op_sel_hi:[1,0]
    v_pk_mul_f32 v[86:87], v[86:87], v[46:47] op_sel_hi:[1,0]
    v_cvt_pk_bf16_f32 v168, v80, v81
    v_cvt_pk_bf16_f32 v169, v82, v83
    v_cvt_pk_bf16_f32 v170, v84, v85
    v_cvt_pk_bf16_f32 v171, v86, v87
    ds_write_b128 v52, v[168:171]
    v_pk_mul_f32 v[88:89], v[88:89], v[46:47] op_sel_hi:[1,0]
    v_pk_mul_f32 v[90:91], v[90:91], v[46:47] op_sel_hi:[1,0]
    v_pk_mul_f32 v[92:93], v[92:93], v[46:47] op_sel_hi:[1,0]
    v_pk_mul_f32 v[94:95], v[94:95], v[46:47] op_sel_hi:[1,0]
    v_cvt_pk_bf16_f32 v172, v88, v89
    v_cvt_pk_bf16_f32 v173, v90, v91
    v_cvt_pk_bf16_f32 v174, v92, v93
    v_cvt_pk_bf16_f32 v175, v94, v95
    ds_write_b128 v53, v[172:175]
    v_pk_mul_f32 v[96:97], v[96:97], v[46:47] op_sel_hi:[1,0]
    v_pk_mul_f32 v[98:99], v[98:99], v[46:47] op_sel_hi:[1,0]
    v_pk_mul_f32 v[100:101], v[100:101], v[46:47] op_sel_hi:[1,0]
    v_pk_mul_f32 v[102:103], v[102:103], v[46:47] op_sel_hi:[1,0]
    v_cvt_pk_bf16_f32 v176, v96, v97
    v_cvt_pk_bf16_f32 v177, v98, v99
    v_cvt_pk_bf16_f32 v178, v100, v101
    v_cvt_pk_bf16_f32 v179, v102, v103
    ds_write_b128 v54, v[176:179]
    v_pk_mul_f32 v[104:105], v[104:105], v[46:47] op_sel_hi:[1,0]
    v_pk_mul_f32 v[106:107], v[106:107], v[46:47] op_sel_hi:[1,0]
    v_pk_mul_f32 v[108:109], v[108:109], v[46:47] op_sel_hi:[1,0]
    v_pk_mul_f32 v[110:111], v[110:111], v[46:47] op_sel_hi:[1,0]
    v_cvt_pk_bf16_f32 v180, v104, v105
    v_cvt_pk_bf16_f32 v181, v106, v107
    v_cvt_pk_bf16_f32 v182, v108, v109
    v_cvt_pk_bf16_f32 v183, v110, v111
    ds_write_b128 v55, v[180:183]
    v_pk_mul_f32 v[112:113], v[112:113], v[46:47] op_sel_hi:[1,0]
    v_pk_mul_f32 v[114:115], v[114:115], v[46:47] op_sel_hi:[1,0]
    v_pk_mul_f32 v[116:117], v[116:117], v[46:47] op_sel_hi:[1,0]
    v_pk_mul_f32 v[118:119], v[118:119], v[46:47] op_sel_hi:[1,0]
    v_cvt_pk_bf16_f32 v184, v112, v113
    v_cvt_pk_bf16_f32 v185, v114, v115
    v_cvt_pk_bf16_f32 v186, v116, v117
    v_cvt_pk_bf16_f32 v187, v118, v119
    ds_write_b128 v56, v[184:187]
    v_pk_mul_f32 v[120:121], v[120:121], v[46:47] op_sel_hi:[1,0]
    v_pk_mul_f32 v[122:123], v[122:123], v[46:47] op_sel_hi:[1,0]
    v_pk_mul_f32 v[124:125], v[124:125], v[46:47] op_sel_hi:[1,0]
    v_pk_mul_f32 v[126:127], v[126:127], v[46:47] op_sel_hi:[1,0]
    v_cvt_pk_bf16_f32 v188, v120, v121
    v_cvt_pk_bf16_f32 v189, v122, v123
    v_cvt_pk_bf16_f32 v190, v124, v125
    v_cvt_pk_bf16_f32 v191, v126, v127
    ds_write_b128 v57, v[188:191]
    s_waitcnt lgkmcnt(0)
    s_barrier
    s_add_u32 m0, s43, 0
    s_nop 0
    buffer_load_dwordx4 v27, s[28:31], s44 offen  lds
    s_add_u32 s44, s44, 8192
    s_add_u32 m0, s43, 1024
    s_nop 0
    buffer_load_dwordx4 v27, s[28:31], s44 offen  lds
    s_add_u32 s44, s44, 8192
    s_add_u32 m0, s43, 16384
    s_nop 0
    buffer_load_dwordx4 v27, s[28:31], s44 offen  lds
    s_add_u32 s44, s44, 8192
    s_add_u32 m0, s43, 17408
    s_nop 0
    buffer_load_dwordx4 v27, s[28:31], s44 offen  lds
    s_add_u32 s44, s44, 8192
    s_waitcnt vmcnt(10)
    ds_read_b64_tr_b16 v[128:129], v24 offset:32768
    ds_read_b64_tr_b16 v[130:131], v24 offset:33280
    ds_read_b64_tr_b16 v[132:133], v25 offset:32768
    ds_read_b64_tr_b16 v[134:135], v25 offset:33280
    ds_read_b128 v[136:139], v16 offset:0
    ds_read_b128 v[140:143], v16 offset:32768
    s_waitcnt vmcnt(8)
    ds_read_b64_tr_b16 v[144:145], v24 offset:49152
    ds_read_b64_tr_b16 v[146:147], v24 offset:49664
    ds_read_b64_tr_b16 v[148:149], v25 offset:49152
    ds_read_b64_tr_b16 v[150:151], v25 offset:49664
    ds_read_b128 v[152:155], v17 offset:0
    ds_read_b128 v[156:159], v17 offset:32768
    s_waitcnt lgkmcnt(6)
    s_add_u32 m0, s43, 32768
    s_nop 0
    buffer_load_dwordx4 v27, s[28:31], s44 offen  lds
    s_add_u32 s44, s44, 8192
    s_add_u32 m0, s43, 33792
    s_nop 0
    buffer_load_dwordx4 v27, s[28:31], s44 offen  lds
    s_add_u32 s44, s44, 8192
    v_mfma_f32_32x32x16_bf16 v[64:79], v[128:131], v[136:139], 0
    v_mfma_f32_32x32x16_bf16 v[80:95], v[128:131], v[140:143], 0
    v_mfma_f32_32x32x16_bf16 v[96:111], v[132:135], v[136:139], 0
    v_mfma_f32_32x32x16_bf16 v[112:127], v[132:135], v[140:143], 0
    s_waitcnt vmcnt(8)
    ds_read_b64_tr_b16 v[128:129], v43 offset:0
    ds_read_b64_tr_b16 v[130:131], v43 offset:512
    ds_read_b64_tr_b16 v[132:133], v45 offset:0
    ds_read_b64_tr_b16 v[134:135], v45 offset:512
    ds_read_b128 v[136:139], v18 offset:0
    ds_read_b128 v[140:143], v18 offset:32768
    s_waitcnt lgkmcnt(6)
    s_add_u32 m0, s43, 49152
    s_nop 0
    buffer_load_dwordx4 v27, s[28:31], s44 offen  lds
    s_add_u32 s44, s44, 8192
    s_add_u32 m0, s43, 50176
    s_nop 0
    buffer_load_dwordx4 v27, s[28:31], s44 offen  lds
    s_add_u32 s44, s44, 8192
    v_mfma_f32_32x32x16_bf16 v[64:79], v[144:147], v[152:155], v[64:79]
    v_mfma_f32_32x32x16_bf16 v[80:95], v[144:147], v[156:159], v[80:95]
    v_mfma_f32_32x32x16_bf16 v[96:111], v[148:151], v[152:155], v[96:111]
    v_mfma_f32_32x32x16_bf16 v[112:127], v[148:151], v[156:159], v[112:127]
    s_waitcnt vmcnt(8)
    ds_read_b64_tr_b16 v[144:145], v43 offset:16384
    ds_read_b64_tr_b16 v[146:147], v43 offset:16896
    ds_read_b64_tr_b16 v[148:149], v45 offset:16384
    ds_read_b64_tr_b16 v[150:151], v45 offset:16896
    ds_read_b128 v[152:155], v19 offset:0
    ds_read_b128 v[156:159], v19 offset:32768
    s_waitcnt lgkmcnt(6)
    s_add_u32 m0, s43, 65536
    s_nop 0
    buffer_load_dwordx4 v27, s[28:31], s44 offen  lds
    s_add_u32 s44, s44, 8192
    s_add_u32 m0, s43, 66560
    s_nop 0
    buffer_load_dwordx4 v27, s[28:31], s44 offen  lds
    s_add_u32 s44, s44, 8192
    v_mfma_f32_32x32x16_bf16 v[64:79], v[128:131], v[136:139], v[64:79]
    v_mfma_f32_32x32x16_bf16 v[80:95], v[128:131], v[140:143], v[80:95]
    v_mfma_f32_32x32x16_bf16 v[96:111], v[132:135], v[136:139], v[96:111]
    v_mfma_f32_32x32x16_bf16 v[112:127], v[132:135], v[140:143], v[112:127]
    s_waitcnt vmcnt(8)
    ds_read_b64_tr_b16 v[128:129], v24 offset:0
    ds_read_b64_tr_b16 v[130:131], v24 offset:512
    ds_read_b64_tr_b16 v[132:133], v25 offset:0
    ds_read_b64_tr_b16 v[134:135], v25 offset:512
    ds_read_b128 v[136:139], v20 offset:0
    ds_read_b128 v[140:143], v20 offset:32768
    s_waitcnt lgkmcnt(6)
    s_add_u32 m0, s43, 81920
    s_nop 0
    buffer_load_dwordx4 v27, s[28:31], s44 offen  lds
    s_add_u32 s44, s44, 8192
    s_add_u32 m0, s43, 82944
    s_nop 0
    buffer_load_dwordx4 v27, s[28:31], s44 offen  lds
    s_add_u32 s44, s44, 8192
    v_mfma_f32_32x32x16_bf16 v[64:79], v[144:147], v[152:155], v[64:79]
    v_mfma_f32_32x32x16_bf16 v[80:95], v[144:147], v[156:159], v[80:95]
    v_mfma_f32_32x32x16_bf16 v[96:111], v[148:151], v[152:155], v[96:111]
    v_mfma_f32_32x32x16_bf16 v[112:127], v[148:151], v[156:159], v[112:127]
    s_waitcnt vmcnt(8)
    ds_read_b64_tr_b16 v[144:145], v24 offset:16384
    ds_read_b64_tr_b16 v[146:147], v24 offset:16896
    ds_read_b64_tr_b16 v[148:149], v25 offset:16384
    ds_read_b64_tr_b16 v[150:151], v25 offset:16896
    ds_read_b128 v[152:155], v21 offset:0
    ds_read_b128 v[156:159], v21 offset:32768
    s_waitcnt lgkmcnt(6)
    s_add_u32 m0, s43, 0
    s_nop 0
    buffer_load_dwordx4 v27, s[28:31], s44 offen  lds
    s_add_u32 s44, s44, 8192
    s_add_u32 m0, s43, 1024
    s_nop 0
    buffer_load_dwordx4 v27, s[28:31], s44 offen  lds
    s_add_u32 s44, s44, 8192
    v_mfma_f32_32x32x16_bf16 v[64:79], v[128:131], v[136:139], v[64:79]
    v_mfma_f32_32x32x16_bf16 v[80:95], v[128:131], v[140:143], v[80:95]
    v_mfma_f32_32x32x16_bf16 v[96:111], v[132:135], v[136:139], v[96:111]
    v_mfma_f32_32x32x16_bf16 v[112:127], v[132:135], v[140:143], v[112:127]
    s_waitcnt vmcnt(8)
    ds_read_b64_tr_b16 v[128:129], v24 offset:32768
    ds_read_b64_tr_b16 v[130:131], v24 offset:33280
    ds_read_b64_tr_b16 v[132:133], v25 offset:32768
    ds_read_b64_tr_b16 v[134:135], v25 offset:33280
    ds_read_b128 v[136:139], v22 offset:0
    ds_read_b128 v[140:143], v22 offset:32768
    s_waitcnt lgkmcnt(6)
    s_add_u32 m0, s43, 16384
    s_nop 0
    buffer_load_dwordx4 v27, s[28:31], s44 offen  lds
    s_add_u32 s44, s44, 8192
    s_add_u32 m0, s43, 17408
    s_nop 0
    buffer_load_dwordx4 v27, s[28:31], s44 offen  lds
    s_add_u32 s44, s44, 8192
    v_mfma_f32_32x32x16_bf16 v[64:79], v[144:147], v[152:155], v[64:79]
    v_mfma_f32_32x32x16_bf16 v[80:95], v[144:147], v[156:159], v[80:95]
    v_mfma_f32_32x32x16_bf16 v[96:111], v[148:151], v[152:155], v[96:111]
    v_mfma_f32_32x32x16_bf16 v[112:127], v[148:151], v[156:159], v[112:127]
    s_waitcnt vmcnt(8)
    ds_read_b64_tr_b16 v[144:145], v24 offset:49152
    ds_read_b64_tr_b16 v[146:147], v24 offset:49664
    ds_read_b64_tr_b16 v[148:149], v25 offset:49152
    ds_read_b64_tr_b16 v[150:151], v25 offset:49664
    ds_read_b128 v[152:155], v23 offset:0
    ds_read_b128 v[156:159], v23 offset:32768
    s_waitcnt lgkmcnt(6)
    s_add_u32 m0, s43, 32768
    s_nop 0
    buffer_load_dwordx4 v27, s[28:31], s44 offen  lds
    s_add_u32 s44, s44, 8192
    s_add_u32 m0, s43, 33792
    s_nop 0
    buffer_load_dwordx4 v27, s[28:31], s44 offen  lds
    s_add_u32 s44, s44, 8192
    v_mfma_f32_32x32x16_bf16 v[64:79], v[128:131], v[136:139], v[64:79]
    v_mfma_f32_32x32x16_bf16 v[80:95], v[128:131], v[140:143], v[80:95]
    v_mfma_f32_32x32x16_bf16 v[96:111], v[132:135], v[136:139], v[96:111]
    v_mfma_f32_32x32x16_bf16 v[112:127], v[132:135], v[140:143], v[112:127]
    s_waitcnt vmcnt(8)
    ds_read_b64_tr_b16 v[128:129], v43 offset:0
    ds_read_b64_tr_b16 v[130:131], v43 offset:512
    ds_read_b64_tr_b16 v[132:133], v45 offset:0
    ds_read_b64_tr_b16 v[134:135], v45 offset:512
    ds_read_b128 v[136:139], v16 offset:256
    ds_read_b128 v[140:143], v16 offset:33024
    s_waitcnt lgkmcnt(6)
    s_add_u32 m0, s43, 49152
    s_nop 0
    buffer_load_dwordx4 v27, s[28:31], s44 offen  lds
    s_add_u32 s44, s44, 8192
    s_add_u32 m0, s43, 50176
    s_nop 0
    buffer_load_dwordx4 v27, s[28:31], s44 offen  lds
    s_add_u32 s44, s44, 8192
    v_mfma_f32_32x32x16_bf16 v[64:79], v[144:147], v[152:155], v[64:79]
    v_mfma_f32_32x32x16_bf16 v[80:95], v[144:147], v[156:159], v[80:95]
    v_mfma_f32_32x32x16_bf16 v[96:111], v[148:151], v[152:155], v[96:111]
    v_mfma_f32_32x32x16_bf16 v[112:127], v[148:151], v[156:159], v[112:127]
    s_waitcnt vmcnt(8)
    ds_read_b64_tr_b16 v[144:145], v43 offset:16384
    ds_read_b64_tr_b16 v[146:147], v43 offset:16896
    ds_read_b64_tr_b16 v[148:149], v45 offset:16384
    ds_read_b64_tr_b16 v[150:151], v45 offset:16896
    ds_read_b128 v[152:155], v17 offset:256
    ds_read_b128 v[156:159], v17 offset:33024
    s_waitcnt lgkmcnt(6)
    s_add_u32 m0, s43, 65536
    s_nop 0
    buffer_load_dwordx4 v27, s[28:31], s44 offen  lds
    s_add_u32 s44, s44, 8192
    s_add_u32 m0, s43, 66560
    s_nop 0
    buffer_load_dwordx4 v27, s[28:31], s44 offen  lds
    s_add_u32 s44, s44, 8192
    v_mfma_f32_32x32x16_bf16 v[64:79], v[128:131], v[136:139], v[64:79]
    v_mfma_f32_32x32x16_bf16 v[80:95], v[128:131], v[140:143], v[80:95]
    v_mfma_f32_32x32x16_bf16 v[96:111], v[132:135], v[136:139], v[96:111]
    v_mfma_f32_32x32x16_bf16 v[112:127], v[132:135], v[140:143], v[112:127]
    s_waitcnt vmcnt(8)
    ds_read_b64_tr_b16 v[128:129], v24 offset:0
    ds_read_b64_tr_b16 v[130:131], v24 offset:512
    ds_read_b64_tr_b16 v[132:133], v25 offset:0
    ds_read_b64_tr_b16 v[134:135], v25 offset:512
    ds_read_b128 v[136:139], v18 offset:256
    ds_read_b128 v[140:143], v18 offset:33024
    s_waitcnt lgkmcnt(6)
    s_add_u32 m0, s43, 81920
    s_nop 0
    buffer_load_dwordx4 v27, s[28:31], s44 offen  lds
    s_add_u32 s44, s44, 8192
    s_add_u32 m0, s43, 82944
    s_nop 0
    buffer_load_dwordx4 v27, s[28:31], s44 offen  lds
    s_add_u32 s44, s44, 8192
    v_mfma_f32_32x32x16_bf16 v[64:79], v[144:147], v[152:155], v[64:79]
    v_mfma_f32_32x32x16_bf16 v[80:95], v[144:147], v[156:159], v[80:95]
    v_mfma_f32_32x32x16_bf16 v[96:111], v[148:151], v[152:155], v[96:111]
    v_mfma_f32_32x32x16_bf16 v[112:127], v[148:151], v[156:159], v[112:127]
    s_waitcnt vmcnt(8)
    ds_read_b64_tr_b16 v[144:145], v24 offset:16384
    ds_read_b64_tr_b16 v[146:147], v24 offset:16896
    ds_read_b64_tr_b16 v[148:149], v25 offset:16384
    ds_read_b64_tr_b16 v[150:151], v25 offset:16896
    ds_read_b128 v[152:155], v19 offset:256
    ds_read_b128 v[156:159], v19 offset:33024
    s_waitcnt lgkmcnt(6)
    s_add_u32 m0, s43, 0
    s_nop 0
    buffer_load_dwordx4 v27, s[28:31], s44 offen  lds
    s_add_u32 s44, s44, 8192
    s_add_u32 m0, s43, 1024
    s_nop 0
    buffer_load_dwordx4 v27, s[28:31], s44 offen  lds
    s_add_u32 s44, s44, 8192
    v_mfma_f32_32x32x16_bf16 v[64:79], v[128:131], v[136:139], v[64:79]
    v_mfma_f32_32x32x16_bf16 v[80:95], v[128:131], v[140:143], v[80:95]
    v_mfma_f32_32x32x16_bf16 v[96:111], v[132:135], v[136:139], v[96:111]
    v_mfma_f32_32x32x16_bf16 v[112:127], v[132:135], v[140:143], v[112:127]
    s_waitcnt vmcnt(8)
    ds_read_b64_tr_b16 v[128:129], v24 offset:32768
    ds_read_b64_tr_b16 v[130:131], v24 offset:33280
    ds_read_b64_tr_b16 v[132:133], v25 offset:32768
    ds_read_b64_tr_b16 v[134:135], v25 offset:33280
    ds_read_b128 v[136:139], v20 offset:256
    ds_read_b128 v[140:143], v20 offset:33024
    s_waitcnt lgkmcnt(6)
    s_add_u32 m0, s43, 16384
    s_nop 0
    buffer_load_dwordx4 v27, s[28:31], s44 offen  lds
    s_add_u32 s44, s44, 8192
    s_add_u32 m0, s43, 17408
    s_nop 0
    buffer_load_dwordx4 v27, s[28:31], s44 offen  lds
    s_add_u32 s44, s44, 8192
    v_mfma_f32_32x32x16_bf16 v[64:79], v[144:147], v[152:155], v[64:79]
    v_mfma_f32_32x32x16_bf16 v[80:95], v[144:147], v[156:159], v[80:95]
    v_mfma_f32_32x32x16_bf16 v[96:111], v[148:151], v[152:155], v[96:111]
    v_mfma_f32_32x32x16_bf16 v[112:127], v[148:151], v[156:159], v[112:127]
    s_waitcnt vmcnt(8)
    ds_read_b64_tr_b16 v[144:145], v24 offset:49152
    ds_read_b64_tr_b16 v[146:147], v24 offset:49664
    ds_read_b64_tr_b16 v[148:149], v25 offset:49152
    ds_read_b64_tr_b16 v[150:151], v25 offset:49664
    ds_read_b128 v[152:155], v21 offset:256
    ds_read_b128 v[156:159], v21 offset:33024
    s_waitcnt lgkmcnt(6)
    s_add_u32 m0, s43, 32768
    s_nop 0
    buffer_load_dwordx4 v27, s[28:31], s44 offen  lds
    s_add_u32 s44, s44, 8192
    s_add_u32 m0, s43, 33792
    s_nop 0
    buffer_load_dwordx4 v27, s[28:31], s44 offen  lds
    s_add_u32 s44, s44, 8192
    v_mfma_f32_32x32x16_bf16 v[64:79], v[128:131], v[136:139], v[64:79]
    v_mfma_f32_32x32x16_bf16 v[80:95], v[128:131], v[140:143], v[80:95]
    v_mfma_f32_32x32x16_bf16 v[96:111], v[132:135], v[136:139], v[96:111]
    v_mfma_f32_32x32x16_bf16 v[112:127], v[132:135], v[140:143], v[112:127]
    s_waitcnt vmcnt(8)
    ds_read_b64_tr_b16 v[128:129], v43 offset:0
    ds_read_b64_tr_b16 v[130:131], v43 offset:512
    ds_read_b64_tr_b16 v[132:133], v45 offset:0
    ds_read_b64_tr_b16 v[134:135], v45 offset:512
    ds_read_b128 v[136:139], v22 offset:256
    ds_read_b128 v[140:143], v22 offset:33024
    s_waitcnt lgkmcnt(6)
    s_add_u32 m0, s43, 49152
    s_nop 0
    buffer_load_dwordx4 v27, s[28:31], s44 offen  lds
    s_add_u32 s44, s44, 8192
    s_add_u32 m0, s43, 50176
    s_nop 0
    buffer_load_dwordx4 v27, s[28:31], s44 offen  lds
    s_add_u32 s44, s44, 8192
    v_mfma_f32_32x32x16_bf16 v[64:79], v[144:147], v[152:155], v[64:79]
    v_mfma_f32_32x32x16_bf16 v[80:95], v[144:147], v[156:159], v[80:95]
    v_mfma_f32_32x32x16_bf16 v[96:111], v[148:151], v[152:155], v[96:111]
    v_mfma_f32_32x32x16_bf16 v[112:127], v[148:151], v[156:159], v[112:127]
    s_waitcnt vmcnt(8)
    ds_read_b64_tr_b16 v[144:145], v43 offset:16384
    ds_read_b64_tr_b16 v[146:147], v43 offset:16896
    ds_read_b64_tr_b16 v[148:149], v45 offset:16384
    ds_read_b64_tr_b16 v[150:151], v45 offset:16896
    ds_read_b128 v[152:155], v23 offset:256
    ds_read_b128 v[156:159], v23 offset:33024
    s_waitcnt lgkmcnt(6)
    s_add_u32 m0, s43, 65536
    s_nop 0
    buffer_load_dwordx4 v27, s[28:31], s44 offen  lds
    s_add_u32 s44, s44, 8192
    s_add_u32 m0, s43, 66560
    s_nop 0
    buffer_load_dwordx4 v27, s[28:31], s44 offen  lds
    s_add_u32 s44, s44, 8192
    v_mfma_f32_32x32x16_bf16 v[64:79], v[128:131], v[136:139], v[64:79]
    v_mfma_f32_32x32x16_bf16 v[80:95], v[128:131], v[140:143], v[80:95]
    v_mfma_f32_32x32x16_bf16 v[96:111], v[132:135], v[136:139], v[96:111]
    v_mfma_f32_32x32x16_bf16 v[112:127], v[132:135], v[140:143], v[112:127]
    s_waitcnt vmcnt(8)
    ds_read_b64_tr_b16 v[128:129], v24 offset:0
    ds_read_b64_tr_b16 v[130:131], v24 offset:512
    ds_read_b64_tr_b16 v[132:133], v25 offset:0
    ds_read_b64_tr_b16 v[134:135], v25 offset:512
    ds_read_b128 v[136:139], v16 offset:512
    ds_read_b128 v[140:143], v16 offset:33280
    s_waitcnt lgkmcnt(6)
    s_add_u32 m0, s43, 81920
    s_nop 0
    buffer_load_dwordx4 v27, s[28:31], s44 offen  lds
    s_add_u32 s44, s44, 8192
    s_add_u32 m0, s43, 82944
    s_nop 0
    buffer_load_dwordx4 v27, s[28:31], s44 offen  lds
    s_add_u32 s44, s44, 8192
    v_mfma_f32_32x32x16_bf16 v[64:79], v[144:147], v[152:155], v[64:79]
    v_mfma_f32_32x32x16_bf16 v[80:95], v[144:147], v[156:159], v[80:95]
    v_mfma_f32_32x32x16_bf16 v[96:111], v[148:151], v[152:155], v[96:111]
    v_mfma_f32_32x32x16_bf16 v[112:127], v[148:151], v[156:159], v[112:127]
    s_waitcnt vmcnt(8)
    ds_read_b64_tr_b16 v[144:145], v24 offset:16384
    ds_read_b64_tr_b16 v[146:147], v24 offset:16896
    ds_read_b64_tr_b16 v[148:149], v25 offset:16384
    ds_read_b64_tr_b16 v[150:151], v25 offset:16896
    ds_read_b128 v[152:155], v17 offset:512
    ds_read_b128 v[156:159], v17 offset:33280
    s_waitcnt lgkmcnt(6)
    s_add_u32 m0, s43, 0
    s_nop 0
    buffer_load_dwordx4 v27, s[28:31], s44 offen  lds
    s_add_u32 s44, s44, 8192
    s_add_u32 m0, s43, 1024
    s_nop 0
    buffer_load_dwordx4 v27, s[28:31], s44 offen  lds
    s_add_u32 s44, s44, 8192
    v_mfma_f32_32x32x16_bf16 v[64:79], v[128:131], v[136:139], v[64:79]
    v_mfma_f32_32x32x16_bf16 v[80:95], v[128:131], v[140:143], v[80:95]
    v_mfma_f32_32x32x16_bf16 v[96:111], v[132:135], v[136:139], v[96:111]
    v_mfma_f32_32x32x16_bf16 v[112:127], v[132:135], v[140:143], v[112:127]
    s_waitcnt vmcnt(8)
    ds_read_b64_tr_b16 v[128:129], v24 offset:32768
    ds_read_b64_tr_b16 v[130:131], v24 offset:33280
    ds_read_b64_tr_b16 v[132:133], v25 offset:32768
    ds_read_b64_tr_b16 v[134:135], v25 offset:33280
    ds_read_b128 v[136:139], v18 offset:512
    ds_read_b128 v[140:143], v18 offset:33280
    s_waitcnt lgkmcnt(6)
    s_add_u32 m0, s43, 16384
    s_nop 0
    buffer_load_dwordx4 v27, s[28:31], s44 offen  lds
    s_add_u32 s44, s44, 8192
    s_add_u32 m0, s43, 17408
    s_nop 0
    buffer_load_dwordx4 v27, s[28:31], s44 offen  lds
    s_add_u32 s44, s44, 8192
    v_mfma_f32_32x32x16_bf16 v[64:79], v[144:147], v[152:155], v[64:79]
    v_mfma_f32_32x32x16_bf16 v[80:95], v[144:147], v[156:159], v[80:95]
    v_mfma_f32_32x32x16_bf16 v[96:111], v[148:151], v[152:155], v[96:111]
    v_mfma_f32_32x32x16_bf16 v[112:127], v[148:151], v[156:159], v[112:127]
    s_waitcnt vmcnt(8)
    ds_read_b64_tr_b16 v[144:145], v24 offset:49152
    ds_read_b64_tr_b16 v[146:147], v24 offset:49664
    ds_read_b64_tr_b16 v[148:149], v25 offset:49152
    ds_read_b64_tr_b16 v[150:151], v25 offset:49664
    ds_read_b128 v[152:155], v19 offset:512
    ds_read_b128 v[156:159], v19 offset:33280
    s_waitcnt lgkmcnt(6)
    s_add_u32 m0, s43, 32768
    s_nop 0
    buffer_load_dwordx4 v27, s[28:31], s44 offen  lds
    s_add_u32 s44, s44, 8192
    s_add_u32 m0, s43, 33792
    s_nop 0
    buffer_load_dwordx4 v27, s[28:31], s44 offen  lds
    s_add_u32 s44, s44, 8192
    v_mfma_f32_32x32x16_bf16 v[64:79], v[128:131], v[136:139], v[64:79]
    v_mfma_f32_32x32x16_bf16 v[80:95], v[128:131], v[140:143], v[80:95]
    v_mfma_f32_32x32x16_bf16 v[96:111], v[132:135], v[136:139], v[96:111]
    v_mfma_f32_32x32x16_bf16 v[112:127], v[132:135], v[140:143], v[112:127]
    s_waitcnt vmcnt(8)
    ds_read_b64_tr_b16 v[128:129], v43 offset:0
    ds_read_b64_tr_b16 v[130:131], v43 offset:512
    ds_read_b64_tr_b16 v[132:133], v45 offset:0
    ds_read_b64_tr_b16 v[134:135], v45 offset:512
    ds_read_b128 v[136:139], v20 offset:512
    ds_read_b128 v[140:143], v20 offset:33280
    s_waitcnt lgkmcnt(6)
    s_add_u32 m0, s43, 49152
    s_nop 0
    buffer_load_dwordx4 v27, s[28:31], s44 offen  lds
    s_add_u32 s44, s44, 8192
    s_add_u32 m0, s43, 50176
    s_nop 0
    buffer_load_dwordx4 v27, s[28:31], s44 offen  lds
    s_add_u32 s44, s44, 8192
    v_mfma_f32_32x32x16_bf16 v[64:79], v[144:147], v[152:155], v[64:79]
    v_mfma_f32_32x32x16_bf16 v[80:95], v[144:147], v[156:159], v[80:95]
    v_mfma_f32_32x32x16_bf16 v[96:111], v[148:151], v[152:155], v[96:111]
    v_mfma_f32_32x32x16_bf16 v[112:127], v[148:151], v[156:159], v[112:127]
    s_waitcnt vmcnt(8)
    ds_read_b64_tr_b16 v[144:145], v43 offset:16384
    ds_read_b64_tr_b16 v[146:147], v43 offset:16896
    ds_read_b64_tr_b16 v[148:149], v45 offset:16384
    ds_read_b64_tr_b16 v[150:151], v45 offset:16896
    ds_read_b128 v[152:155], v21 offset:512
    ds_read_b128 v[156:159], v21 offset:33280
    s_waitcnt lgkmcnt(6)
    s_add_u32 m0, s43, 65536
    s_nop 0
    buffer_load_dwordx4 v27, s[28:31], s44 offen  lds
    s_add_u32 s44, s44, 8192
    s_add_u32 m0, s43, 66560
    s_nop 0
    buffer_load_dwordx4 v27, s[28:31], s44 offen  lds
    s_add_u32 s44, s44, 8192
    v_mfma_f32_32x32x16_bf16 v[64:79], v[128:131], v[136:139], v[64:79]
    v_mfma_f32_32x32x16_bf16 v[80:95], v[128:131], v[140:143], v[80:95]
    v_mfma_f32_32x32x16_bf16 v[96:111], v[132:135], v[136:139], v[96:111]
    v_mfma_f32_32x32x16_bf16 v[112:127], v[132:135], v[140:143], v[112:127]
    s_waitcnt vmcnt(8)
    ds_read_b64_tr_b16 v[128:129], v24 offset:0
    ds_read_b64_tr_b16 v[130:131], v24 offset:512
    ds_read_b64_tr_b16 v[132:133], v25 offset:0
    ds_read_b64_tr_b16 v[134:135], v25 offset:512
    ds_read_b128 v[136:139], v22 offset:512
    ds_read_b128 v[140:143], v22 offset:33280
    s_waitcnt lgkmcnt(6)
    s_add_u32 m0, s43, 81920
    s_nop 0
    buffer_load_dwordx4 v27, s[28:31], s44 offen  lds
    s_add_u32 s44, s44, 8192
    s_add_u32 m0, s43, 82944
    s_nop 0
    buffer_load_dwordx4 v27, s[28:31], s44 offen  lds
    s_add_u32 s44, s44, 8192
    v_mfma_f32_32x32x16_bf16 v[64:79], v[144:147], v[152:155], v[64:79]
    v_mfma_f32_32x32x16_bf16 v[80:95], v[144:147], v[156:159], v[80:95]
    v_mfma_f32_32x32x16_bf16 v[96:111], v[148:151], v[152:155], v[96:111]
    v_mfma_f32_32x32x16_bf16 v[112:127], v[148:151], v[156:159], v[112:127]
    s_waitcnt vmcnt(8)
    ds_read_b64_tr_b16 v[144:145], v24 offset:16384
    ds_read_b64_tr_b16 v[146:147], v24 offset:16896
    ds_read_b64_tr_b16 v[148:149], v25 offset:16384
    ds_read_b64_tr_b16 v[150:151], v25 offset:16896
    ds_read_b128 v[152:155], v23 offset:512
    ds_read_b128 v[156:159], v23 offset:33280
    s_waitcnt lgkmcnt(6)
    s_add_u32 m0, s43, 0
    s_nop 0
    buffer_load_dwordx4 v27, s[28:31], s44 offen  lds
    s_add_u32 s44, s44, 8192
    s_add_u32 m0, s43, 1024
    s_nop 0
    buffer_load_dwordx4 v27, s[28:31], s44 offen  lds
    s_add_u32 s44, s44, 8192
    v_mfma_f32_32x32x16_bf16 v[64:79], v[128:131], v[136:139], v[64:79]
    v_mfma_f32_32x32x16_bf16 v[80:95], v[128:131], v[140:143], v[80:95]
    v_mfma_f32_32x32x16_bf16 v[96:111], v[132:135], v[136:139], v[96:111]
    v_mfma_f32_32x32x16_bf16 v[112:127], v[132:135], v[140:143], v[112:127]
    s_waitcnt vmcnt(8)
    ds_read_b64_tr_b16 v[128:129], v24 offset:32768
    ds_read_b64_tr_b16 v[130:131], v24 offset:33280
    ds_read_b64_tr_b16 v[132:133], v25 offset:32768
    ds_read_b64_tr_b16 v[134:135], v25 offset:33280
    ds_read_b128 v[136:139], v16 offset:768
    ds_read_b128 v[140:143], v16 offset:33536
    s_waitcnt lgkmcnt(6)
    s_add_u32 m0, s43, 16384
    s_nop 0
    buffer_load_dwordx4 v27, s[28:31], s44 offen  lds
    s_add_u32 s44, s44, 8192
    s_add_u32 m0, s43, 17408
    s_nop 0
    buffer_load_dwordx4 v27, s[28:31], s44 offen  lds
    s_add_u32 s44, s44, 8192
    v_mfma_f32_32x32x16_bf16 v[64:79], v[144:147], v[152:155], v[64:79]
    v_mfma_f32_32x32x16_bf16 v[80:95], v[144:147], v[156:159], v[80:95]
    v_mfma_f32_32x32x16_bf16 v[96:111], v[148:151], v[152:155], v[96:111]
    v_mfma_f32_32x32x16_bf16 v[112:127], v[148:151], v[156:159], v[112:127]
    s_waitcnt vmcnt(8)
    ds_read_b64_tr_b16 v[144:145], v24 offset:49152
    ds_read_b64_tr_b16 v[146:147], v24 offset:49664
    ds_read_b64_tr_b16 v[148:149], v25 offset:49152
    ds_read_b64_tr_b16 v[150:151], v25 offset:49664
    ds_read_b128 v[152:155], v17 offset:768
    ds_read_b128 v[156:159], v17 offset:33536
    s_waitcnt lgkmcnt(6)
    s_add_u32 m0, s43, 32768
    s_nop 0
    buffer_load_dwordx4 v27, s[28:31], s44 offen  lds
    s_add_u32 s44, s44, 8192
    s_add_u32 m0, s43, 33792
    s_nop 0
    buffer_load_dwordx4 v27, s[28:31], s44 offen  lds
    s_add_u32 s44, s44, 8192
    v_mfma_f32_32x32x16_bf16 v[64:79], v[128:131], v[136:139], v[64:79]
    v_mfma_f32_32x32x16_bf16 v[80:95], v[128:131], v[140:143], v[80:95]
    v_mfma_f32_32x32x16_bf16 v[96:111], v[132:135], v[136:139], v[96:111]
    v_mfma_f32_32x32x16_bf16 v[112:127], v[132:135], v[140:143], v[112:127]
    s_waitcnt vmcnt(8)
    ds_read_b64_tr_b16 v[128:129], v43 offset:0
    ds_read_b64_tr_b16 v[130:131], v43 offset:512
    ds_read_b64_tr_b16 v[132:133], v45 offset:0
    ds_read_b64_tr_b16 v[134:135], v45 offset:512
    ds_read_b128 v[136:139], v18 offset:768
    ds_read_b128 v[140:143], v18 offset:33536
    s_waitcnt lgkmcnt(6)
    s_add_u32 m0, s43, 49152
    s_nop 0
    buffer_load_dwordx4 v27, s[28:31], s44 offen  lds
    s_add_u32 s44, s44, 8192
    s_add_u32 m0, s43, 50176
    s_nop 0
    buffer_load_dwordx4 v27, s[28:31], s44 offen  lds
    s_add_u32 s44, s44, 8192
    v_mfma_f32_32x32x16_bf16 v[64:79], v[144:147], v[152:155], v[64:79]
    v_mfma_f32_32x32x16_bf16 v[80:95], v[144:147], v[156:159], v[80:95]
    v_mfma_f32_32x32x16_bf16 v[96:111], v[148:151], v[152:155], v[96:111]
    v_mfma_f32_32x32x16_bf16 v[112:127], v[148:151], v[156:159], v[112:127]
    s_waitcnt vmcnt(8)
    ds_read_b64_tr_b16 v[144:145], v43 offset:16384
    ds_read_b64_tr_b16 v[146:147], v43 offset:16896
    ds_read_b64_tr_b16 v[148:149], v45 offset:16384
    ds_read_b64_tr_b16 v[150:151], v45 offset:16896
    ds_read_b128 v[152:155], v19 offset:768
    ds_read_b128 v[156:159], v19 offset:33536
    s_waitcnt lgkmcnt(6)
    v_mfma_f32_32x32x16_bf16 v[64:79], v[128:131], v[136:139], v[64:79]
    v_mfma_f32_32x32x16_bf16 v[80:95], v[128:131], v[140:143], v[80:95]
    v_mfma_f32_32x32x16_bf16 v[96:111], v[132:135], v[136:139], v[96:111]
    v_mfma_f32_32x32x16_bf16 v[112:127], v[132:135], v[140:143], v[112:127]
    s_waitcnt vmcnt(6)
    ds_read_b64_tr_b16 v[128:129], v24 offset:0
    ds_read_b64_tr_b16 v[130:131], v24 offset:512
    ds_read_b64_tr_b16 v[132:133], v25 offset:0
    ds_read_b64_tr_b16 v[134:135], v25 offset:512
    ds_read_b128 v[136:139], v20 offset:768
    ds_read_b128 v[140:143], v20 offset:33536
    s_waitcnt lgkmcnt(6)
    v_mfma_f32_32x32x16_bf16 v[64:79], v[144:147], v[152:155], v[64:79]
    v_mfma_f32_32x32x16_bf16 v[80:95], v[144:147], v[156:159], v[80:95]
    v_mfma_f32_32x32x16_bf16 v[96:111], v[148:151], v[152:155], v[96:111]
    v_mfma_f32_32x32x16_bf16 v[112:127], v[148:151], v[156:159], v[112:127]
    s_waitcnt vmcnt(4)
    ds_read_b64_tr_b16 v[144:145], v24 offset:16384
    ds_read_b64_tr_b16 v[146:147], v24 offset:16896
    ds_read_b64_tr_b16 v[148:149], v25 offset:16384
    ds_read_b64_tr_b16 v[150:151], v25 offset:16896
    ds_read_b128 v[152:155], v21 offset:768
    ds_read_b128 v[156:159], v21 offset:33536
    s_waitcnt lgkmcnt(6)
    v_mfma_f32_32x32x16_bf16 v[64:79], v[128:131], v[136:139], v[64:79]
    v_mfma_f32_32x32x16_bf16 v[80:95], v[128:131], v[140:143], v[80:95]
    v_mfma_f32_32x32x16_bf16 v[96:111], v[132:135], v[136:139], v[96:111]
    v_mfma_f32_32x32x16_bf16 v[112:127], v[132:135], v[140:143], v[112:127]
    s_waitcnt vmcnt(2)
    ds_read_b64_tr_b16 v[128:129], v24 offset:32768
    ds_read_b64_tr_b16 v[130:131], v24 offset:33280
    ds_read_b64_tr_b16 v[132:133], v25 offset:32768
    ds_read_b64_tr_b16 v[134:135], v25 offset:33280
    ds_read_b128 v[136:139], v22 offset:768
    ds_read_b128 v[140:143], v22 offset:33536
    s_waitcnt lgkmcnt(6)
    v_mfma_f32_32x32x16_bf16 v[64:79], v[144:147], v[152:155], v[64:79]
    v_mfma_f32_32x32x16_bf16 v[80:95], v[144:147], v[156:159], v[80:95]
    v_mfma_f32_32x32x16_bf16 v[96:111], v[148:151], v[152:155], v[96:111]
    v_mfma_f32_32x32x16_bf16 v[112:127], v[148:151], v[156:159], v[112:127]
    s_waitcnt vmcnt(0)
    ds_read_b64_tr_b16 v[144:145], v24 offset:49152
    ds_read_b64_tr_b16 v[146:147], v24 offset:49664
    ds_read_b64_tr_b16 v[148:149], v25 offset:49152
    ds_read_b64_tr_b16 v[150:151], v25 offset:49664
    ds_read_b128 v[152:155], v23 offset:768
    ds_read_b128 v[156:159], v23 offset:33536
    s_waitcnt lgkmcnt(6)
    v_mfma_f32_32x32x16_bf16 v[64:79], v[128:131], v[136:139], v[64:79]
    v_mfma_f32_32x32x16_bf16 v[80:95], v[128:131], v[140:143], v[80:95]
    v_mfma_f32_32x32x16_bf16 v[96:111], v[132:135], v[136:139], v[96:111]
    v_mfma_f32_32x32x16_bf16 v[112:127], v[132:135], v[140:143], v[112:127]
    s_waitcnt lgkmcnt(0)
    v_mfma_f32_32x32x16_bf16 v[64:79], v[144:147], v[152:155], v[64:79]
    v_mfma_f32_32x32x16_bf16 v[80:95], v[144:147], v[156:159], v[80:95]
    v_mfma_f32_32x32x16_bf16 v[96:111], v[148:151], v[152:155], v[96:111]
    v_mfma_f32_32x32x16_bf16 v[112:127], v[148:151], v[156:159], v[112:127]
    v_and_b32 v5, 31, v1
    v_lshrrev_b32 v6, 5, v1
    v_and_b32 v7, 7, v5
    v_lshrrev_b32 v8, 4, v5
    v_and_b32 v5, 15, v5
    v_lshl_add_u32 v5, v8, 7, v5
    v_or_b32 v8, 0, v6
    v_xor_b32 v8, v8, v7
    v_lshlrev_b32 v8, 4, v8
    v_lshl_add_u32 v8, v5, 7, v8
    v_add_u32 v10, s43, v8
    v_or_b32 v8, 2, v6
    v_xor_b32 v8, v8, v7
    v_lshlrev_b32 v8, 4, v8
    v_lshl_add_u32 v8, v5, 7, v8
    v_add_u32 v11, s43, v8
    v_or_b32 v8, 4, v6
    v_xor_b32 v8, v8, v7
    v_lshlrev_b32 v8, 4, v8
    v_lshl_add_u32 v8, v5, 7, v8
    v_add_u32 v12, s43, v8
    v_or_b32 v8, 6, v6
    v_xor_b32 v8, v8, v7
    v_lshlrev_b32 v8, 4, v8
    v_lshl_add_u32 v8, v5, 7, v8
    v_add_u32 v13, s43, v8
    v_lshrrev_b32 v7, 3, v1
    v_and_b32 v8, 7, v1
    v_xor_b32 v9, v8, v7
    v_lshlrev_b32 v9, 4, v9
    v_lshl_add_u32 v9, v7, 7, v9
    v_add_u32 v9, s43, v9
    v_lshlrev_b32 v8, 4, v8
    v_lshl_add_u32 v8, v7, 10, v8
    s_lshl_b32 s56, s40, 7
    v_cvt_pk_bf16_f32 v160, v64, v65
    v_cvt_pk_bf16_f32 v161, v66, v67
    v_cvt_pk_bf16_f32 v162, v68, v69
    v_cvt_pk_bf16_f32 v163, v70, v71
    ds_write_b128 v10, v[160:163] offset:0
    v_cvt_pk_bf16_f32 v164, v72, v73
    v_cvt_pk_bf16_f32 v165, v74, v75
    v_cvt_pk_bf16_f32 v166, v76, v77
    v_cvt_pk_bf16_f32 v167, v78, v79
    ds_write_b128 v11, v[164:167] offset:0
    v_cvt_pk_bf16_f32 v168, v80, v81
    v_cvt_pk_bf16_f32 v169, v82, v83
    v_cvt_pk_bf16_f32 v170, v84, v85
    v_cvt_pk_bf16_f32 v171, v86, v87
    ds_write_b128 v10, v[168:171] offset:32768
    v_cvt_pk_bf16_f32 v172, v88, v89
    v_cvt_pk_bf16_f32 v173, v90, v91
    v_cvt_pk_bf16_f32 v174, v92, v93
    v_cvt_pk_bf16_f32 v175, v94, v95
    ds_write_b128 v11, v[172:175] offset:32768
    v_cvt_pk_bf16_f32 v176, v96, v97
    v_cvt_pk_bf16_f32 v177, v98, v99
    v_cvt_pk_bf16_f32 v178, v100, v101
    v_cvt_pk_bf16_f32 v179, v102, v103
    ds_write_b128 v12, v[176:179] offset:0
    v_cvt_pk_bf16_f32 v180, v104, v105
    v_cvt_pk_bf16_f32 v181, v106, v107
    v_cvt_pk_bf16_f32 v182, v108, v109
    v_cvt_pk_bf16_f32 v183, v110, v111
    ds_write_b128 v13, v[180:183] offset:0
    v_cvt_pk_bf16_f32 v184, v112, v113
    v_cvt_pk_bf16_f32 v185, v114, v115
    v_cvt_pk_bf16_f32 v186, v116, v117
    v_cvt_pk_bf16_f32 v187, v118, v119
    ds_write_b128 v12, v[184:187] offset:32768
    v_cvt_pk_bf16_f32 v188, v120, v121
    v_cvt_pk_bf16_f32 v189, v122, v123
    v_cvt_pk_bf16_f32 v190, v124, v125
    v_cvt_pk_bf16_f32 v191, v126, v127
    ds_write_b128 v13, v[188:191] offset:32768
    s_waitcnt lgkmcnt(0)
    ds_read_b128 v[192:195], v9 offset:0
    ds_read_b128 v[196:199], v9 offset:1024
    ds_read_b128 v[200:203], v9 offset:16384
    ds_read_b128 v[204:207], v9 offset:17408
    ds_read_b128 v[208:211], v9 offset:32768
    ds_read_b128 v[212:215], v9 offset:33792
    ds_read_b128 v[216:219], v9 offset:49152
    ds_read_b128 v[220:223], v9 offset:50176
    s_waitcnt lgkmcnt(7)
    buffer_store_dwordx4 v[192:195], v8, s[32:35], s56 offen sc1
    s_add_u32 s56, s56, 8192
    s_waitcnt lgkmcnt(6)
    buffer_store_dwordx4 v[196:199], v8, s[32:35], s56 offen sc1
    s_add_u32 s56, s56, 8192
    s_waitcnt lgkmcnt(5)
    buffer_store_dwordx4 v[200:203], v8, s[32:35], s56 offen sc1
    s_add_u32 s56, s56, 8192
    s_waitcnt lgkmcnt(4)
    buffer_store_dwordx4 v[204:207], v8, s[32:35], s56 offen sc1
    s_add_u32 s56, s56, 8192
    s_waitcnt lgkmcnt(3)
    buffer_store_dwordx4 v[208:211], v8, s[32:35], s56 offen sc1
    s_add_u32 s56, s56, 8192
    s_waitcnt lgkmcnt(2)
    buffer_store_dwordx4 v[212:215], v8, s[32:35], s56 offen sc1
    s_add_u32 s56, s56, 8192
    s_waitcnt lgkmcnt(1)
    buffer_store_dwordx4 v[216:219], v8, s[32:35], s56 offen sc1
    s_add_u32 s56, s56, 8192
    s_waitcnt lgkmcnt(0)
    buffer_store_dwordx4 v[220:223], v8, s[32:35], s56 offen sc1
    s_lshl_b32 s39, s42, 8
    s_lshl_b32 s38, s41, 3
    s_add_u32 s39, s39, s38
    s_load_dwordx2 s[60:61], s[0:1], 0
    s_load_dwordx2 s[62:63], s[0:1], 96
    s_load_dwordx2 s[68:69], s[0:1], 112
    s_load_dwordx8 s[84:91], s[0:1], 48
    v_and_b32 v1, 63, v0
    v_lshrrev_b32 v2, 6, v0
    s_nop 0
    v_readfirstlane_b32 s40, v2
    s_and_b32 s41, s2, 31
    s_lshr_b32 s42, s2, 5
    s_mov_b32 s43, 0xffff0000
    s_mul_i32 s44, s40, 40960
    s_waitcnt lgkmcnt(0)
    s_add_u32 s80, s68, 0x1a30000
    s_addc_u32 s81, s69, 0
    s_mov_b32 s82, 0x8000
    s_mov_b32 s83, 0x00020000
    s_mov_b32 s12, s68
    s_mov_b32 s13, s69
    s_mov_b32 s14, 0xc000
    s_mov_b32 s15, 0x00020000
    s_cmp_lg_u32 s40, 0
    s_cbranch_scc1 .Lw0m_end
    s_lshl_b32 s98, s41, 10
    v_add_u32 v2, 64, v1
    v_min_u32 v2, 63, v2
    v_lshlrev_b32 v2, 3, v2
    v_lshlrev_b32 v3, 3, v1
    s_mov_b32 s99, 0
    v_lshlrev_b32 v4, 3, v1
.Lplq_poll:
    buffer_load_dwordx2 v[248:249], v4, s[80:83], s98 offen sc1
    s_add_u32 s99, s99, 1
    s_waitcnt vmcnt(0)
    v_xor_b32 v248, s100, v248
    v_xor_b32 v249, s101, v249
    v_or_b32 v248, v248, v249
    v_cmp_ne_u32 vcc, 0, v248
    s_cmp_lt_u32 s99, 0x40000
    s_cbranch_scc0 .Lplq_done
    s_cbranch_vccz .Lplq_done
    s_cmp_lg_u32 s99, 6
    s_cbranch_scc1 .Lplq_poll
    s_bitcmp1_b32 s2, 1
    s_cbranch_scc0 .Lplq_poll
    s_and_b32 s52, s2, 1
    s_lshl_b32 s52, s52, 5
    s_lshr_b32 s53, s2, 3
    s_add_u32 s52, s52, s53
    s_bitcmp1_b64 vcc, s52
    s_cbranch_scc0 .Lplq_poll
    s_and_b32 s53, s52, 1
    s_lshr_b32 s54, s52, 1
    s_add_u32 s54, s54, 16
    s_lshl_b32 s55, s54, 7
    s_load_dwordx4 s[48:51], s[0:1], 80
    v_and_b32 v2, 7, v1
    v_lshrrev_b32 v3, 3, v1
    v_mul_u32_u24 v60, 49152, v3
    v_lshl_add_u32 v60, v2, 4, v60
    v_lshlrev_b32 v61, 4, v3
    v_lshl_add_u32 v2, v2, 3, v3
    v_mov_b32 v112, 0
    v_mov_b32 v113, 0
    v_mov_b32 v114, 0
    v_mov_b32 v115, 0
    v_mov_b32 v116, 0
    v_mov_b32 v117, 0
    v_mov_b32 v118, 0
    v_mov_b32 v119, 0
    s_waitcnt lgkmcnt(0)
    s_mov_b32 s16, s48
    s_mov_b32 s17, s49
    s_mov_b32 s18, 0x400
    s_mov_b32 s19, 0x00020000
    s_mov_b32 s20, s50
    s_mov_b32 s21, s51
    s_mov_b32 s22, 0x300000
    s_mov_b32 s23, 0x00020000
    s_mul_i32 s48, s53, 1572864
    s_add_u32 s48, s48, s55
    s_lshl_b32 s49, s53, 9
    s_mov_b32 s50, 4
.Lp4s_l:
    buffer_load_dwordx4 v[224:227], v61, s[16:19], s49 offen
    buffer_load_dwordx4 v[128:131], v60, s[20:23], s48 offen
    s_add_u32 s48, s48, 6144
    buffer_load_dwordx4 v[132:135], v60, s[20:23], s48 offen
    s_add_u32 s48, s48, 6144
    buffer_load_dwordx4 v[136:139], v60, s[20:23], s48 offen
    s_add_u32 s48, s48, 6144
    buffer_load_dwordx4 v[140:143], v60, s[20:23], s48 offen
    s_add_u32 s48, s48, 6144
    buffer_load_dwordx4 v[144:147], v60, s[20:23], s48 offen
    s_add_u32 s48, s48, 6144
    buffer_load_dwordx4 v[148:151], v60, s[20:23], s48 offen
    s_add_u32 s48, s48, 6144
    buffer_load_dwordx4 v[152:155], v60, s[20:23], s48 offen
    s_add_u32 s48, s48, 6144
    buffer_load_dwordx4 v[156:159], v60, s[20:23], s48 offen
    s_add_u32 s48, s48, 350208
    s_add_u32 s49, s49, 128
    s_waitcnt vmcnt(8)
    v_lshlrev_b32 v64, 16, v224
    v_and_b32 v65, s43, v224
    v_lshlrev_b32 v66, 16, v225
    v_and_b32 v67, s43, v225
    v_lshlrev_b32 v68, 16, v226
    v_and_b32 v69, s43, v226
    v_lshlrev_b32 v70, 16, v227
    v_and_b32 v71, s43, v227
    v_mul_f32 v72, 0xbfb8aa3b, v64
    v_mul_f32 v73, 0xbfb8aa3b, v65
    v_mul_f32 v74, 0xbfb8aa3b, v66
    v_mul_f32 v75, 0xbfb8aa3b, v67
    v_mul_f32 v76, 0xbfb8aa3b, v68
    v_mul_f32 v77, 0xbfb8aa3b, v69
    v_mul_f32 v78, 0xbfb8aa3b, v70
    v_mul_f32 v79, 0xbfb8aa3b, v71
    v_exp_f32 v72, v72
    v_exp_f32 v73, v73
    v_exp_f32 v74, v74
    v_exp_f32 v75, v75
    v_exp_f32 v76, v76
    v_exp_f32 v77, v77
    v_exp_f32 v78, v78
    v_exp_f32 v79, v79
    s_nop 0
    v_add_f32 v72, 1.0, v72
    v_add_f32 v73, 1.0, v73
    v_add_f32 v74, 1.0, v74
    v_add_f32 v75, 1.0, v75
    v_add_f32 v76, 1.0, v76
    v_add_f32 v77, 1.0, v77
    v_add_f32 v78, 1.0, v78
    v_add_f32 v79, 1.0, v79
    v_rcp_f32 v80, v72
    v_rcp_f32 v81, v73
    v_rcp_f32 v82, v74
    v_rcp_f32 v83, v75
    v_rcp_f32 v84, v76
    v_rcp_f32 v85, v77
    v_rcp_f32 v86, v78
    v_rcp_f32 v87, v79
    s_nop 0
    v_mul_f32 v88, v64, v80
    v_mul_f32 v89, v65, v81
    v_mul_f32 v90, v66, v82
    v_mul_f32 v91, v67, v83
    v_mul_f32 v92, v68, v84
    v_mul_f32 v93, v69, v85
    v_mul_f32 v94, v70, v86
    v_mul_f32 v95, v71, v87
    v_fma_f32 v72, -v88, v72, v64
    v_fma_f32 v73, -v89, v73, v65
    v_fma_f32 v74, -v90, v74, v66
    v_fma_f32 v75, -v91, v75, v67
    v_fma_f32 v76, -v92, v76, v68
    v_fma_f32 v77, -v93, v77, v69
    v_fma_f32 v78, -v94, v78, v70
    v_fma_f32 v79, -v95, v79, v71
    v_fma_f32 v64, v72, v80, v88
    v_fma_f32 v65, v73, v81, v89
    v_fma_f32 v66, v74, v82, v90
    v_fma_f32 v67, v75, v83, v91
    v_fma_f32 v68, v76, v84, v92
    v_fma_f32 v69, v77, v85, v93
    v_fma_f32 v70, v78, v86, v94
    v_fma_f32 v71, v79, v87, v95
    v_cvt_pk_bf16_f32 v72, v64, v65
    v_cvt_pk_bf16_f32 v73, v66, v67
    v_cvt_pk_bf16_f32 v74, v68, v69
    v_cvt_pk_bf16_f32 v75, v70, v71
    v_and_b32 v96, 0xffff, v72
    v_lshlrev_b32 v97, 16, v72
    v_lshrrev_b32 v98, 16, v72
    v_and_b32 v99, s43, v72
    v_and_b32 v100, 0xffff, v73
    v_lshlrev_b32 v101, 16, v73
    v_lshrrev_b32 v102, 16, v73
    v_and_b32 v103, s43, v73
    v_and_b32 v104, 0xffff, v74
    v_lshlrev_b32 v105, 16, v74
    v_lshrrev_b32 v106, 16, v74
    v_and_b32 v107, s43, v74
    v_and_b32 v108, 0xffff, v75
    v_lshlrev_b32 v109, 16, v75
    v_lshrrev_b32 v110, 16, v75
    v_and_b32 v111, s43, v75
    s_waitcnt vmcnt(0)
    v_dot2_f32_bf16 v112, v128, v96, v112
    v_dot2_f32_bf16 v113, v128, v97, v113
    v_dot2_f32_bf16 v114, v129, v96, v114
    v_dot2_f32_bf16 v115, v129, v97, v115
    v_dot2_f32_bf16 v116, v130, v96, v116
    v_dot2_f32_bf16 v117, v130, v97, v117
    v_dot2_f32_bf16 v118, v131, v96, v118
    v_dot2_f32_bf16 v119, v131, v97, v119
    v_dot2_f32_bf16 v112, v132, v98, v112
    v_dot2_f32_bf16 v113, v132, v99, v113
    v_dot2_f32_bf16 v114, v133, v98, v114
    v_dot2_f32_bf16 v115, v133, v99, v115
    v_dot2_f32_bf16 v116, v134, v98, v116
    v_dot2_f32_bf16 v117, v134, v99, v117
    v_dot2_f32_bf16 v118, v135, v98, v118
    v_dot2_f32_bf16 v119, v135, v99, v119
    v_dot2_f32_bf16 v112, v136, v100, v112
    v_dot2_f32_bf16 v113, v136, v101, v113
    v_dot2_f32_bf16 v114, v137, v100, v114
    v_dot2_f32_bf16 v115, v137, v101, v115
    v_dot2_f32_bf16 v116, v138, v100, v116
    v_dot2_f32_bf16 v117, v138, v101, v117
    v_dot2_f32_bf16 v118, v139, v100, v118
    v_dot2_f32_bf16 v119, v139, v101, v119
    v_dot2_f32_bf16 v112, v140, v102, v112
    v_dot2_f32_bf16 v113, v140, v103, v113
    v_dot2_f32_bf16 v114, v141, v102, v114
    v_dot2_f32_bf16 v115, v141, v103, v115
    v_dot2_f32_bf16 v116, v142, v102, v116
    v_dot2_f32_bf16 v117, v142, v103, v117
    v_dot2_f32_bf16 v118, v143, v102, v118
    v_dot2_f32_bf16 v119, v143, v103, v119
    v_dot2_f32_bf16 v112, v144, v104, v112
    v_dot2_f32_bf16 v113, v144, v105, v113
    v_dot2_f32_bf16 v114, v145, v104, v114
    v_dot2_f32_bf16 v115, v145, v105, v115
    v_dot2_f32_bf16 v116, v146, v104, v116
    v_dot2_f32_bf16 v117, v146, v105, v117
    v_dot2_f32_bf16 v118, v147, v104, v118
    v_dot2_f32_bf16 v119, v147, v105, v119
    v_dot2_f32_bf16 v112, v148, v106, v112
    v_dot2_f32_bf16 v113, v148, v107, v113
    v_dot2_f32_bf16 v114, v149, v106, v114
    v_dot2_f32_bf16 v115, v149, v107, v115
    v_dot2_f32_bf16 v116, v150, v106, v116
    v_dot2_f32_bf16 v117, v150, v107, v117
    v_dot2_f32_bf16 v118, v151, v106, v118
    v_dot2_f32_bf16 v119, v151, v107, v119
    v_dot2_f32_bf16 v112, v152, v108, v112
    v_dot2_f32_bf16 v113, v152, v109, v113
    v_dot2_f32_bf16 v114, v153, v108, v114
    v_dot2_f32_bf16 v115, v153, v109, v115
    v_dot2_f32_bf16 v116, v154, v108, v116
    v_dot2_f32_bf16 v117, v154, v109, v117
    v_dot2_f32_bf16 v118, v155, v108, v118
    v_dot2_f32_bf16 v119, v155, v109, v119
    v_dot2_f32_bf16 v112, v156, v110, v112
    v_dot2_f32_bf16 v113, v156, v111, v113
    v_dot2_f32_bf16 v114, v157, v110, v114
    v_dot2_f32_bf16 v115, v157, v111, v115
    v_dot2_f32_bf16 v116, v158, v110, v116
    v_dot2_f32_bf16 v117, v158, v111, v117
    v_dot2_f32_bf16 v118, v159, v110, v118
    v_dot2_f32_bf16 v119, v159, v111, v119
    s_sub_u32 s50, s50, 1
    s_cmp_lg_u32 s50, 0
    s_cbranch_scc1 .Lp4s_l
    v_permlane32_swap_b32 v112, v116
    v_permlane32_swap_b32 v113, v117
    v_permlane32_swap_b32 v114, v118
    v_permlane32_swap_b32 v115, v119
    s_nop 0
    v_add_f32 v112, v112, v116
    v_add_f32 v113, v113, v117
    v_add_f32 v114, v114, v118
    v_add_f32 v115, v115, v119
    s_nop 1
    v_permlane16_swap_b32 v112, v114
    v_permlane16_swap_b32 v113, v115
    s_nop 1
    v_add_f32 v112, v112, v114
    v_add_f32 v113, v113, v115
    s_nop 1
    v_add_f32_dpp v114, v112, v112 row_ror:8 row_mask:0xf bank_mask:0x3
    v_add_f32_dpp v114, v113, v113 row_ror:8 row_mask:0xf bank_mask:0xc
    s_mul_i32 s53, s53, 12288
    s_lshl_b32 s54, s54, 8
    s_add_u32 s53, s53, s54
    v_lshlrev_b32 v2, 2, v2
    buffer_store_dword v114, v2, s[12:15], s53 offen sc1
    v_mov_b32 v70, s100
    v_mov_b32 v71, s101
    v_lshlrev_b32 v3, 10, v1
    s_lshl_b32 s52, s52, 3
    s_waitcnt vmcnt(0)
    s_mov_b32 exec_hi, 0
    buffer_store_dwordx2 v[70:71], v3, s[80:83], s52 offen sc1
    s_mov_b64 exec, -1
    s_branch .Lplq_poll
.Lplq_done:
    v_lshlrev_b32 v10, 5, v1
    s_movk_i32 s48, 4096
    buffer_load_dwordx4 v[24:27], v10, s[12:15], s48 offen
    buffer_load_dwordx4 v[28:31], v10, s[12:15], s48 offen offset:16
    s_movk_i32 s48, 8192
    buffer_load_dwordx4 v[32:35], v10, s[12:15], s48 offen
    buffer_load_dwordx4 v[36:39], v10, s[12:15], s48 offen offset:16
    s_movk_i32 s48, 6144
    buffer_load_dwordx4 v[40:43], v10, s[12:15], s48 offen
    buffer_load_dwordx4 v[44:47], v10, s[12:15], s48 offen offset:16
    s_movk_i32 s48, 16384
    buffer_load_dwordx4 v[112:115], v10, s[12:15], s48 offen
    buffer_load_dwordx4 v[116:119], v10, s[12:15], s48 offen offset:16
    s_movk_i32 s48, 20480
    buffer_load_dwordx4 v[120:123], v10, s[12:15], s48 offen
    buffer_load_dwordx4 v[124:127], v10, s[12:15], s48 offen offset:16
    s_movk_i32 s48, 18432
    buffer_load_dwordx4 v[128:131], v10, s[12:15], s48 offen
    buffer_load_dwordx4 v[132:135], v10, s[12:15], s48 offen offset:16
    v_add_u32 v10, 81920, v10
    s_waitcnt vmcnt(0)
    v_pk_add_f32 v[24:25], v[24:25], v[112:113]
    v_pk_add_f32 v[26:27], v[26:27], v[114:115]
    v_pk_add_f32 v[28:29], v[28:29], v[116:117]
    v_pk_add_f32 v[30:31], v[30:31], v[118:119]
    v_pk_add_f32 v[32:33], v[32:33], v[120:121]
    v_pk_add_f32 v[34:35], v[34:35], v[122:123]
    v_pk_add_f32 v[36:37], v[36:37], v[124:125]
    v_pk_add_f32 v[38:39], v[38:39], v[126:127]
    v_pk_add_f32 v[40:41], v[40:41], v[128:129]
    v_pk_add_f32 v[42:43], v[42:43], v[130:131]
    v_pk_add_f32 v[44:45], v[44:45], v[132:133]
    v_pk_add_f32 v[46:47], v[46:47], v[134:135]
    v_cvt_pk_bf16_f32 v24, 0, v24
    v_cvt_pk_bf16_f32 v25, 0, v25
    v_cvt_pk_bf16_f32 v26, 0, v26
    v_cvt_pk_bf16_f32 v27, 0, v27
    v_cvt_pk_bf16_f32 v28, 0, v28
    v_cvt_pk_bf16_f32 v29, 0, v29
    v_cvt_pk_bf16_f32 v30, 0, v30
    v_cvt_pk_bf16_f32 v31, 0, v31
    v_cvt_pk_bf16_f32 v32, 0, v32
    v_cvt_pk_bf16_f32 v33, 0, v33
    v_cvt_pk_bf16_f32 v34, 0, v34
    v_cvt_pk_bf16_f32 v35, 0, v35
    v_cvt_pk_bf16_f32 v36, 0, v36
    v_cvt_pk_bf16_f32 v37, 0, v37
    v_cvt_pk_bf16_f32 v38, 0, v38
    v_cvt_pk_bf16_f32 v39, 0, v39
    v_cvt_pk_bf16_f32 v40, 0, v40
    v_cvt_pk_bf16_f32 v41, 0, v41
    v_cvt_pk_bf16_f32 v42, 0, v42
    v_cvt_pk_bf16_f32 v43, 0, v43
    v_cvt_pk_bf16_f32 v44, 0, v44
    v_cvt_pk_bf16_f32 v45, 0, v45
    v_cvt_pk_bf16_f32 v46, 0, v46
    v_cvt_pk_bf16_f32 v47, 0, v47
    v_add_f32 v32, 1.0, v32
    v_add_f32 v33, 1.0, v33
    v_add_f32 v34, 1.0, v34
    v_add_f32 v35, 1.0, v35
    v_add_f32 v36, 1.0, v36
    v_add_f32 v37, 1.0, v37
    v_add_f32 v38, 1.0, v38
    v_add_f32 v39, 1.0, v39
    v_cvt_pk_bf16_f32 v32, 0, v32
    v_cvt_pk_bf16_f32 v33, 0, v33
    v_cvt_pk_bf16_f32 v34, 0, v34
    v_cvt_pk_bf16_f32 v35, 0, v35
    v_cvt_pk_bf16_f32 v36, 0, v36
    v_cvt_pk_bf16_f32 v37, 0, v37
    v_cvt_pk_bf16_f32 v38, 0, v38
    v_cvt_pk_bf16_f32 v39, 0, v39
    ds_write_b128 v10, v[24:27] offset:0
    ds_write_b128 v10, v[28:31] offset:16
    ds_write_b128 v10, v[32:35] offset:16384
    ds_write_b128 v10, v[36:39] offset:16400
    ds_write_b128 v10, v[40:43] offset:49152
    ds_write_b128 v10, v[44:47] offset:49168
.Lw0m_end:
    s_cmp_lg_u32 s40, 1
    s_cbranch_scc1 .Lcs_end
    s_cmp_ge_u32 s2, 224
    s_cbranch_scc1 .Lcs_end
    s_mov_b32 s16, s88
    s_mov_b32 s17, s89
    s_mov_b32 s18, 0x1c0000
    s_mov_b32 s19, 0x00020000
    s_add_u32 s20, s68, 0x1b00000
    s_addc_u32 s21, s69, 0
    s_mov_b32 s22, 0x1c000
    s_mov_b32 s23, 0x00020000
    s_lshr_b32 s48, s2, 3
    s_and_b32 s49, s2, 7
    s_mul_i32 s50, s49, 229376
    s_lshl_b32 s51, s48, 7
    s_add_u32 s50, s50, s51
    v_and_b32 v2, 7, v1
    v_lshrrev_b32 v3, 3, v1
    v_mul_u32_u24 v4, 28672, v3
    v_lshl_add_u32 v4, v2, 4, v4
    buffer_load_dwordx4 v[128:131], v4, s[16:19], s50 offen
    s_add_u32 s50, s50, 3584
    buffer_load_dwordx4 v[132:135], v4, s[16:19], s50 offen
    s_add_u32 s50, s50, 3584
    buffer_load_dwordx4 v[136:139], v4, s[16:19], s50 offen
    s_add_u32 s50, s50, 3584
    buffer_load_dwordx4 v[140:143], v4, s[16:19], s50 offen
    s_add_u32 s50, s50, 3584
    buffer_load_dwordx4 v[144:147], v4, s[16:19], s50 offen
    s_add_u32 s50, s50, 3584
    buffer_load_dwordx4 v[148:151], v4, s[16:19], s50 offen
    s_add_u32 s50, s50, 3584
    buffer_load_dwordx4 v[152:155], v4, s[16:19], s50 offen
    s_add_u32 s50, s50, 3584
    buffer_load_dwordx4 v[156:159], v4, s[16:19], s50 offen
    v_lshl_add_u32 v2, v2, 3, v3
    v_lshlrev_b32 v2, 3, v2
    s_mul_i32 s49, s49, 14336
    s_lshl_b32 s48, s48, 9
    s_add_u32 s48, s48, s49
    s_waitcnt vmcnt(7)
    v_lshlrev_b32 v64, 16, v128
    v_and_b32 v65, s43, v128
    v_lshlrev_b32 v66, 16, v129
    v_and_b32 v67, s43, v129
    v_lshlrev_b32 v68, 16, v130
    v_and_b32 v69, s43, v130
    v_lshlrev_b32 v70, 16, v131
    v_and_b32 v71, s43, v131
    s_waitcnt vmcnt(6)
    v_lshlrev_b32 v80, 16, v132
    v_and_b32 v81, s43, v132
    v_lshlrev_b32 v82, 16, v133
    v_and_b32 v83, s43, v133
    v_lshlrev_b32 v84, 16, v134
    v_and_b32 v85, s43, v134
    v_lshlrev_b32 v86, 16, v135
    v_and_b32 v87, s43, v135
    v_add_f32 v64, v64, v80
    v_add_f32 v65, v65, v81
    v_add_f32 v66, v66, v82
    v_add_f32 v67, v67, v83
    v_add_f32 v68, v68, v84
    v_add_f32 v69, v69, v85
    v_add_f32 v70, v70, v86
    v_add_f32 v71, v71, v87
    s_waitcnt vmcnt(5)
    v_lshlrev_b32 v72, 16, v136
    v_and_b32 v73, s43, v136
    v_lshlrev_b32 v74, 16, v137
    v_and_b32 v75, s43, v137
    v_lshlrev_b32 v76, 16, v138
    v_and_b32 v77, s43, v138
    v_lshlrev_b32 v78, 16, v139
    v_and_b32 v79, s43, v139
    v_add_f32 v64, v64, v72
    v_add_f32 v65, v65, v73
    v_add_f32 v66, v66, v74
    v_add_f32 v67, v67, v75
    v_add_f32 v68, v68, v76
    v_add_f32 v69, v69, v77
    v_add_f32 v70, v70, v78
    v_add_f32 v71, v71, v79
    s_waitcnt vmcnt(4)
    v_lshlrev_b32 v80, 16, v140
    v_and_b32 v81, s43, v140
    v_lshlrev_b32 v82, 16, v141
    v_and_b32 v83, s43, v141
    v_lshlrev_b32 v84, 16, v142
    v_and_b32 v85, s43, v142
    v_lshlrev_b32 v86, 16, v143
    v_and_b32 v87, s43, v143
    v_add_f32 v64, v64, v80
    v_add_f32 v65, v65, v81
    v_add_f32 v66, v66, v82
    v_add_f32 v67, v67, v83
    v_add_f32 v68, v68, v84
    v_add_f32 v69, v69, v85
    v_add_f32 v70, v70, v86
    v_add_f32 v71, v71, v87
    s_waitcnt vmcnt(3)
    v_lshlrev_b32 v72, 16, v144
    v_and_b32 v73, s43, v144
    v_lshlrev_b32 v74, 16, v145
    v_and_b32 v75, s43, v145
    v_lshlrev_b32 v76, 16, v146
    v_and_b32 v77, s43, v146
    v_lshlrev_b32 v78, 16, v147
    v_and_b32 v79, s43, v147
    v_add_f32 v64, v64, v72
    v_add_f32 v65, v65, v73
    v_add_f32 v66, v66, v74
    v_add_f32 v67, v67, v75
    v_add_f32 v68, v68, v76
    v_add_f32 v69, v69, v77
    v_add_f32 v70, v70, v78
    v_add_f32 v71, v71, v79
    s_waitcnt vmcnt(2)
    v_lshlrev_b32 v80, 16, v148
    v_and_b32 v81, s43, v148
    v_lshlrev_b32 v82, 16, v149
    v_and_b32 v83, s43, v149
    v_lshlrev_b32 v84, 16, v150
    v_and_b32 v85, s43, v150
    v_lshlrev_b32 v86, 16, v151
    v_and_b32 v87, s43, v151
    v_add_f32 v64, v64, v80
    v_add_f32 v65, v65, v81
    v_add_f32 v66, v66, v82
    v_add_f32 v67, v67, v83
    v_add_f32 v68, v68, v84
    v_add_f32 v69, v69, v85
    v_add_f32 v70, v70, v86
    v_add_f32 v71, v71, v87
    s_waitcnt vmcnt(1)
    v_lshlrev_b32 v72, 16, v152
    v_and_b32 v73, s43, v152
    v_lshlrev_b32 v74, 16, v153
    v_and_b32 v75, s43, v153
    v_lshlrev_b32 v76, 16, v154
    v_and_b32 v77, s43, v154
    v_lshlrev_b32 v78, 16, v155
    v_and_b32 v79, s43, v155
    v_add_f32 v64, v64, v72
    v_add_f32 v65, v65, v73
    v_add_f32 v66, v66, v74
    v_add_f32 v67, v67, v75
    v_add_f32 v68, v68, v76
    v_add_f32 v69, v69, v77
    v_add_f32 v70, v70, v78
    v_add_f32 v71, v71, v79
    s_waitcnt vmcnt(0)
    v_lshlrev_b32 v80, 16, v156
    v_and_b32 v81, s43, v156
    v_lshlrev_b32 v82, 16, v157
    v_and_b32 v83, s43, v157
    v_lshlrev_b32 v84, 16, v158
    v_and_b32 v85, s43, v158
    v_lshlrev_b32 v86, 16, v159
    v_and_b32 v87, s43, v159
    v_add_f32 v64, v64, v80
    v_add_f32 v65, v65, v81
    v_add_f32 v66, v66, v82
    v_add_f32 v67, v67, v83
    v_add_f32 v68, v68, v84
    v_add_f32 v69, v69, v85
    v_add_f32 v70, v70, v86
    v_add_f32 v71, v71, v87
    s_nop 1
    v_permlane32_swap_b32 v64, v68
    v_permlane32_swap_b32 v65, v69
    v_permlane32_swap_b32 v66, v70
    v_permlane32_swap_b32 v67, v71
    s_nop 0
    v_add_f32 v64, v64, v68
    v_add_f32 v65, v65, v69
    v_add_f32 v66, v66, v70
    v_add_f32 v67, v67, v71
    s_nop 1
    v_permlane16_swap_b32 v64, v66
    v_permlane16_swap_b32 v65, v67
    s_nop 1
    v_add_f32 v64, v64, v66
    v_add_f32 v65, v65, v67
    s_nop 1
    v_add_f32_dpp v66, v64, v64 row_ror:8 row_mask:0xf bank_mask:0x3
    v_add_f32_dpp v66, v65, v65 row_ror:8 row_mask:0xf bank_mask:0xc
    v_mov_b32 v67, s100
    buffer_store_dwordx2 v[66:67], v2, s[20:23], s48 offen sc1
.Lcs_end:
    s_waitcnt vmcnt(0)
    s_add_u32 s92, s68, 0x1a00000
    s_addc_u32 s93, s69, 0
    s_mov_b32 s94, 0x2000
    s_mov_b32 s95, 0x00020000
    s_lshl_b32 s96, s41, 8
    s_lshl_b32 s97, s42, 3
    s_add_u32 s97, s97, s96
    s_mov_b32 s97, s39
    v_mov_b32 v246, s100
    v_mov_b32 v247, s101
    v_mov_b32 v2, 1
    v_mov_b32 v3, s97
    s_waitcnt lgkmcnt(0)
    s_barrier
    s_cmp_lg_u32 s40, 7
    s_cbranch_scc1 .Lpub0
    s_mov_b64 exec, 1
    buffer_store_dwordx2 v[246:247], v3, s[92:95], 0 offen sc1
    s_mov_b64 exec, -1
.Lpub0:
    v_lshlrev_b32 v9, 4, v1
    v_lshlrev_b32 v10, 5, v1
    s_lshl_b32 s3, s41, 3
    s_add_u32 s3, s3, s42
    s_lshl_b32 s3, s3, 3
    s_add_u32 s3, s3, s40
    s_lshl_b32 s3, s3, 10
    s_mov_b32 s8, s60
    s_mov_b32 s9, s61
    s_mov_b32 s10, 0x200000
    s_mov_b32 s11, 0x00020000
    s_mov_b32 s12, s68
    s_mov_b32 s13, s69
    s_mov_b32 s14, 0xc000
    s_mov_b32 s15, 0x00020000
    buffer_load_dwordx4 v[16:19], v9, s[8:11], s3 offen
    v_add_u32 v2, 81920, v10
    ds_read_b128 v[24:27], v2 offset:0
    ds_read_b128 v[28:31], v2 offset:16
    ds_read_b128 v[32:35], v2 offset:16384
    ds_read_b128 v[36:39], v2 offset:16400
    ds_read_b128 v[40:43], v2 offset:49152
    ds_read_b128 v[44:47], v2 offset:49168
    s_waitcnt lgkmcnt(0)
    s_add_u32 s16, s68, 0x2000000
    s_addc_u32 s17, s69, 0
    s_mov_b32 s18, 0x1000000
    s_mov_b32 s19, 0x00020000
    s_add_u32 s20, s68, 0x400000
    s_addc_u32 s21, s69, 0
    s_mov_b32 s22, 0x200000
    s_mov_b32 s23, 0x00020000
    s_add_u32 s24, s68, 0x1200000
    s_addc_u32 s25, s69, 0
    s_mov_b32 s26, 0x200000
    s_mov_b32 s27, 0x00020000
    s_add_u32 s28, s68, 0x1400000
    s_addc_u32 s29, s69, 0
    s_mov_b32 s30, 0x200000
    s_mov_b32 s31, 0x00020000
    s_add_u32 s36, s68, 0x1600000
    s_addc_u32 s37, s69, 0
    s_mov_b32 s38, 0x201000
    s_mov_b32 s39, 0x00020000
    s_cmp_ge_u32 s40, 4
    s_cbranch_scc1 .Lkr_nz2
    s_lshr_b32 s48, s40, 1
    s_mul_i32 s48, s48, 31
    s_cmp_lg_u32 s2, s48
    s_cbranch_scc1 .Lkr_nz
    s_lshl_b32 s48, s40, 10
    s_add_u32 s49, s48, 2097152
    s_cmp_lt_u32 s40, 2
    s_cselect_b32 s48, s48, s49
    v_mov_b32 v12, 0
    v_mov_b32 v13, 0
    v_mov_b32 v14, 0
    v_mov_b32 v15, 0
    buffer_store_dwordx4 v[12:15], v9, s[36:39], s48 offen sc1
.Lkr_nz:
    s_mov_b32 s32, s84
    s_mov_b32 s33, s85
    s_mov_b32 s34, 0x80000
    s_mov_b32 s35, 0x00020000
    v_lshrrev_b32 v2, 3, v1
    v_and_b32 v3, 7, v1
    v_lshlrev_b32 v6, 1, v2
    v_and_b32 v6, 4, v6
    v_xor_b32 v3, v3, v6
    v_lshlrev_b32 v3, 4, v3
    s_movk_i32 s58, 1024
    v_mul_lo_u32 v2, v2, s58
    v_add_u32 v6, v2, v3
    s_mul_i32 s58, s40, 131072
    s_lshl_b32 s59, s42, 7
    s_add_u32 s58, s58, s59
    s_sub_u32 s58, s58, 8192
    s_add_u32 m0, s44, 24576
    s_add_u32 s58, s58, 8192
    buffer_load_dwordx4 v6, s[32:35], s58 offen lds
    s_add_u32 m0, s44, 25600
    s_add_u32 s58, s58, 8192
    buffer_load_dwordx4 v6, s[32:35], s58 offen lds
    s_add_u32 m0, s44, 26624
    s_add_u32 s58, s58, 8192
    buffer_load_dwordx4 v6, s[32:35], s58 offen lds
    s_add_u32 m0, s44, 27648
    s_add_u32 s58, s58, 8192
    buffer_load_dwordx4 v6, s[32:35], s58 offen lds
    s_add_u32 m0, s44, 28672
    s_add_u32 s58, s58, 8192
    buffer_load_dwordx4 v6, s[32:35], s58 offen lds
    s_add_u32 m0, s44, 29696
    s_add_u32 s58, s58, 8192
    buffer_load_dwordx4 v6, s[32:35], s58 offen lds
    s_add_u32 m0, s44, 30720
    s_add_u32 s58, s58, 8192
    buffer_load_dwordx4 v6, s[32:35], s58 offen lds
    s_add_u32 m0, s44, 31744
    s_add_u32 s58, s58, 8192
    buffer_load_dwordx4 v6, s[32:35], s58 offen lds
    s_add_u32 m0, s44, 32768
    s_add_u32 s58, s58, 8192
    buffer_load_dwordx4 v6, s[32:35], s58 offen lds
    s_add_u32 m0, s44, 33792
    s_add_u32 s58, s58, 8192
    buffer_load_dwordx4 v6, s[32:35], s58 offen lds
    s_add_u32 m0, s44, 34816
    s_add_u32 s58, s58, 8192
    buffer_load_dwordx4 v6, s[32:35], s58 offen lds
    s_add_u32 m0, s44, 35840
    s_add_u32 s58, s58, 8192
    buffer_load_dwordx4 v6, s[32:35], s58 offen lds
    s_add_u32 m0, s44, 36864
    s_add_u32 s58, s58, 8192
    buffer_load_dwordx4 v6, s[32:35], s58 offen lds
    s_add_u32 m0, s44, 37888
    s_add_u32 s58, s58, 8192
    buffer_load_dwordx4 v6, s[32:35], s58 offen lds
    s_add_u32 m0, s44, 38912
    s_add_u32 s58, s58, 8192
    buffer_load_dwordx4 v6, s[32:35], s58 offen lds
    s_add_u32 m0, s44, 39936
    s_add_u32 s58, s58, 8192
    buffer_load_dwordx4 v6, s[32:35], s58 offen lds
.Lkr_nz2:
    s_cmp_lg_u32 s40, 7
    s_cbranch_scc1 .Lpl0_done
    v_and_b32 v3, 7, v1
    v_lshlrev_b32 v3, 3, v3
    v_add_u32 v3, s96, v3
    s_mov_b32 s98, 0
    s_mov_b32 s99, 0
.Lpl0x_poll:
    buffer_load_dwordx2 v[248:249], v3, s[92:95], 0 offen sc1
    s_add_u32 s99, s99, 1
    s_waitcnt vmcnt(0)
    v_xor_b32 v248, s100, v248
    v_xor_b32 v249, s101, v249
    v_or_b32 v248, v248, v249
    v_cmp_ne_u32 vcc, 0, v248
    s_cmp_lt_u32 s99, 0x40000
    s_cbranch_scc0 .Lpl0x_done
    s_cbranch_vccnz .Lpl0x_poll
.Lpl0x_done:
.Lpl0_done:
    s_barrier
    s_mul_i32 s48, s41, 458752
    s_add_u32 s48, s48, s3
    buffer_load_dwordx4 v[64:67], v9, s[16:19], s48 offen
    s_add_u32 s48, s48, 65536
    buffer_load_dwordx4 v[68:71], v9, s[16:19], s48 offen
    s_add_u32 s48, s48, 65536
    buffer_load_dwordx4 v[72:75], v9, s[16:19], s48 offen
    s_add_u32 s48, s48, 65536
    buffer_load_dwordx4 v[76:79], v9, s[16:19], s48 offen
    s_add_u32 s48, s48, 65536
    buffer_load_dwordx4 v[80:83], v9, s[16:19], s48 offen
    s_add_u32 s48, s48, 65536
    buffer_load_dwordx4 v[84:87], v9, s[16:19], s48 offen
    s_add_u32 s48, s48, 65536
    buffer_load_dwordx4 v[88:91], v9, s[16:19], s48 offen
    s_add_u32 s48, s48, 65536
    buffer_load_dwordx4 v[92:95], v9, s[16:19], s48 offen
    s_waitcnt vmcnt(8)
    v_lshlrev_b32 v96, 16, v16
    v_and_b32 v97, s43, v16
    v_lshlrev_b32 v98, 16, v17
    v_and_b32 v99, s43, v17
    v_lshlrev_b32 v100, 16, v18
    v_and_b32 v101, s43, v18
    v_lshlrev_b32 v102, 16, v19
    v_and_b32 v103, s43, v19
    v_mov_b32 v56, 0x3f80
    v_mov_b32 v57, 1.0
    s_mov_b32 s50, 0x3f803f80
    s_waitcnt vmcnt(7)
    v_dot2_f32_bf16 v48, v64, v56, 0
    v_dot2_f32_bf16 v49, v64, v57, 0
    v_dot2_f32_bf16 v50, v65, v56, 0
    v_dot2_f32_bf16 v51, v65, v57, 0
    v_dot2_f32_bf16 v52, v66, v56, 0
    v_dot2_f32_bf16 v53, v66, v57, 0
    v_dot2_f32_bf16 v54, v67, v56, 0
    v_dot2_f32_bf16 v55, v67, v57, 0
    s_waitcnt vmcnt(6)
    v_dot2_f32_bf16 v48, v68, v56, v48
    v_dot2_f32_bf16 v49, v68, v57, v49
    v_dot2_f32_bf16 v50, v69, v56, v50
    v_dot2_f32_bf16 v51, v69, v57, v51
    v_dot2_f32_bf16 v52, v70, v56, v52
    v_dot2_f32_bf16 v53, v70, v57, v53
    v_dot2_f32_bf16 v54, v71, v56, v54
    v_dot2_f32_bf16 v55, v71, v57, v55
    s_waitcnt vmcnt(5)
    v_dot2_f32_bf16 v48, v72, v56, v48
    v_dot2_f32_bf16 v49, v72, v57, v49
    v_dot2_f32_bf16 v50, v73, v56, v50
    v_dot2_f32_bf16 v51, v73, v57, v51
    v_dot2_f32_bf16 v52, v74, v56, v52
    v_dot2_f32_bf16 v53, v74, v57, v53
    v_dot2_f32_bf16 v54, v75, v56, v54
    v_dot2_f32_bf16 v55, v75, v57, v55
    s_waitcnt vmcnt(4)
    v_dot2_f32_bf16 v48, v76, v56, v48
    v_dot2_f32_bf16 v49, v76, v57, v49
    v_dot2_f32_bf16 v50, v77, v56, v50
    v_dot2_f32_bf16 v51, v77, v57, v51
    v_dot2_f32_bf16 v52, v78, v56, v52
    v_dot2_f32_bf16 v53, v78, v57, v53
    v_dot2_f32_bf16 v54, v79, v56, v54
    v_dot2_f32_bf16 v55, v79, v57, v55
    s_waitcnt vmcnt(3)
    v_dot2_f32_bf16 v48, v80, v56, v48
    v_dot2_f32_bf16 v49, v80, v57, v49
    v_dot2_f32_bf16 v50, v81, v56, v50
    v_dot2_f32_bf16 v51, v81, v57, v51
    v_dot2_f32_bf16 v52, v82, v56, v52
    v_dot2_f32_bf16 v53, v82, v57, v53
    v_dot2_f32_bf16 v54, v83, v56, v54
    v_dot2_f32_bf16 v55, v83, v57, v55
    s_waitcnt vmcnt(2)
    v_dot2_f32_bf16 v48, v84, v56, v48
    v_dot2_f32_bf16 v49, v84, v57, v49
    v_dot2_f32_bf16 v50, v85, v56, v50
    v_dot2_f32_bf16 v51, v85, v57, v51
    v_dot2_f32_bf16 v52, v86, v56, v52
    v_dot2_f32_bf16 v53, v86, v57, v53
    v_dot2_f32_bf16 v54, v87, v56, v54
    v_dot2_f32_bf16 v55, v87, v57, v55
    s_waitcnt vmcnt(1)
    v_dot2_f32_bf16 v48, v88, v56, v48
    v_dot2_f32_bf16 v49, v88, v57, v49
    v_dot2_f32_bf16 v50, v89, v56, v50
    v_dot2_f32_bf16 v51, v89, v57, v51
    v_dot2_f32_bf16 v52, v90, v56, v52
    v_dot2_f32_bf16 v53, v90, v57, v53
    v_dot2_f32_bf16 v54, v91, v56, v54
    v_dot2_f32_bf16 v55, v91, v57, v55
    s_waitcnt vmcnt(0)
    v_dot2_f32_bf16 v48, v92, v56, v48
    v_dot2_f32_bf16 v49, v92, v57, v49
    v_dot2_f32_bf16 v50, v93, v56, v50
    v_dot2_f32_bf16 v51, v93, v57, v51
    v_dot2_f32_bf16 v52, v94, v56, v52
    v_dot2_f32_bf16 v53, v94, v57, v53
    v_dot2_f32_bf16 v54, v95, v56, v54
    v_dot2_f32_bf16 v55, v95, v57, v55
    v_cvt_pk_bf16_f32 v48, 0, v48
    v_cvt_pk_bf16_f32 v49, 0, v49
    v_cvt_pk_bf16_f32 v50, 0, v50
    v_cvt_pk_bf16_f32 v51, 0, v51
    v_cvt_pk_bf16_f32 v52, 0, v52
    v_cvt_pk_bf16_f32 v53, 0, v53
    v_cvt_pk_bf16_f32 v54, 0, v54
    v_cvt_pk_bf16_f32 v55, 0, v55
    v_pk_mul_f32 v[48:49], v[48:49], v[24:25]
    v_pk_mul_f32 v[50:51], v[50:51], v[26:27]
    v_pk_mul_f32 v[52:53], v[52:53], v[28:29]
    v_pk_mul_f32 v[54:55], v[54:55], v[30:31]
    v_cvt_pk_bf16_f32 v48, 0, v48
    v_cvt_pk_bf16_f32 v49, 0, v49
    v_cvt_pk_bf16_f32 v50, 0, v50
    v_cvt_pk_bf16_f32 v51, 0, v51
    v_cvt_pk_bf16_f32 v52, 0, v52
    v_cvt_pk_bf16_f32 v53, 0, v53
    v_cvt_pk_bf16_f32 v54, 0, v54
    v_cvt_pk_bf16_f32 v55, 0, v55
    v_pk_add_f32 v[48:49], v[48:49], v[96:97]
    v_pk_add_f32 v[50:51], v[50:51], v[98:99]
    v_pk_add_f32 v[52:53], v[52:53], v[100:101]
    v_pk_add_f32 v[54:55], v[54:55], v[102:103]
    v_cvt_pk_bf16_f32 v16, v48, v49
    v_cvt_pk_bf16_f32 v17, v50, v51
    v_cvt_pk_bf16_f32 v18, v52, v53
    v_cvt_pk_bf16_f32 v19, v54, v55
    buffer_store_dwordx4 v[16:19], v9, s[20:23], s3 offen sc1
    v_dot2_f32_bf16 v58, v16, s50, 0
    v_dot2_f32_bf16 v59, v16, v16, 0
    v_dot2_f32_bf16 v58, v17, s50, v58
    v_dot2_f32_bf16 v59, v17, v17, v59
    v_dot2_f32_bf16 v58, v18, s50, v58
    v_dot2_f32_bf16 v59, v18, v18, v59
    v_dot2_f32_bf16 v58, v19, s50, v58
    v_dot2_f32_bf16 v59, v19, v19, v59
    s_nop 1
    v_add_f32_dpp v58, v58, v58 quad_perm:[1,0,3,2] row_mask:0xf bank_mask:0xf
    v_add_f32_dpp v59, v59, v59 quad_perm:[1,0,3,2] row_mask:0xf bank_mask:0xf
    s_nop 0
    v_add_f32_dpp v58, v58, v58 quad_perm:[2,3,0,1] row_mask:0xf bank_mask:0xf
    v_add_f32_dpp v59, v59, v59 quad_perm:[2,3,0,1] row_mask:0xf bank_mask:0xf
    s_nop 0
    v_add_f32_dpp v58, v58, v58 row_half_mirror row_mask:0xf bank_mask:0xf
    v_add_f32_dpp v59, v59, v59 row_half_mirror row_mask:0xf bank_mask:0xf
    s_nop 0
    v_add_f32_dpp v58, v58, v58 row_mirror row_mask:0xf bank_mask:0xf
    v_add_f32_dpp v59, v59, v59 row_mirror row_mask:0xf bank_mask:0xf
    s_nop 0
    v_add_f32_dpp v58, v58, v58 row_bcast:15 row_mask:0xa bank_mask:0xf
    v_add_f32_dpp v59, v59, v59 row_bcast:15 row_mask:0xa bank_mask:0xf
    s_nop 0
    v_add_f32_dpp v58, v58, v58 row_bcast:31 row_mask:0xc bank_mask:0xf
    v_add_f32_dpp v59, v59, v59 row_bcast:31 row_mask:0xc bank_mask:0xf
    v_mul_f32 v58, 0x3b000000, v58
    v_mul_f32 v59, 0x3b000000, v59
    v_fma_f32 v59, -v58, v58, v59
    v_cvt_pk_bf16_f32 v58, 0, -v58
    v_max_f32 v59, 0, v59
    v_readlane_b32 s52, v58, 63
    v_cvt_pk_bf16_f32 v59, 0, v59
    v_add_f32 v59, 0x3727c5ac, v59
    v_cvt_pk_bf16_f32 v59, 0, v59
    v_sqrt_f32 v59, v59
    v_dot2_f32_bf16 v48, v16, v56, s52
    v_dot2_f32_bf16 v49, v16, v57, s52
    v_dot2_f32_bf16 v50, v17, v56, s52
    v_dot2_f32_bf16 v51, v17, v57, s52
    v_cvt_pk_bf16_f32 v59, 0, v59
    v_rcp_f32 v59, v59
    v_dot2_f32_bf16 v52, v18, v56, s52
    v_dot2_f32_bf16 v53, v18, v57, s52
    v_dot2_f32_bf16 v54, v19, v56, s52
    v_dot2_f32_bf16 v55, v19, v57, s52
    v_readlane_b32 s54, v59, 63
    v_cvt_pk_bf16_f32 v48, 0, v48
    v_cvt_pk_bf16_f32 v49, 0, v49
    v_cvt_pk_bf16_f32 v50, 0, v50
    v_cvt_pk_bf16_f32 v51, 0, v51
    v_cvt_pk_bf16_f32 v52, 0, v52
    v_cvt_pk_bf16_f32 v53, 0, v53
    v_cvt_pk_bf16_f32 v54, 0, v54
    v_cvt_pk_bf16_f32 v55, 0, v55
    v_pk_mul_f32 v[48:49], v[48:49], s[54:55] op_sel_hi:[1,0]
    v_pk_mul_f32 v[50:51], v[50:51], s[54:55] op_sel_hi:[1,0]
    v_pk_mul_f32 v[52:53], v[52:53], s[54:55] op_sel_hi:[1,0]
    v_pk_mul_f32 v[54:55], v[54:55], s[54:55] op_sel_hi:[1,0]
    v_cvt_pk_bf16_f32 v48, 0, v48
    v_cvt_pk_bf16_f32 v49, 0, v49
    v_cvt_pk_bf16_f32 v50, 0, v50
    v_cvt_pk_bf16_f32 v51, 0, v51
    v_cvt_pk_bf16_f32 v52, 0, v52
    v_cvt_pk_bf16_f32 v53, 0, v53
    v_cvt_pk_bf16_f32 v54, 0, v54
    v_cvt_pk_bf16_f32 v55, 0, v55
    v_pk_mul_f32 v[48:49], v[48:49], v[32:33]
    v_pk_mul_f32 v[50:51], v[50:51], v[34:35]
    v_pk_mul_f32 v[52:53], v[52:53], v[36:37]
    v_pk_mul_f32 v[54:55], v[54:55], v[38:39]
    v_cvt_pk_bf16_f32 v48, 0, v48
    v_cvt_pk_bf16_f32 v49, 0, v49
    v_cvt_pk_bf16_f32 v50, 0, v50
    v_cvt_pk_bf16_f32 v51, 0, v51
    v_cvt_pk_bf16_f32 v52, 0, v52
    v_cvt_pk_bf16_f32 v53, 0, v53
    v_cvt_pk_bf16_f32 v54, 0, v54
    v_cvt_pk_bf16_f32 v55, 0, v55
    v_pk_add_f32 v[48:49], v[48:49], v[40:41]
    v_pk_add_f32 v[50:51], v[50:51], v[42:43]
    v_pk_add_f32 v[52:53], v[52:53], v[44:45]
    v_pk_add_f32 v[54:55], v[54:55], v[46:47]
    v_cvt_pk_bf16_f32 v80, v48, v49
    v_cvt_pk_bf16_f32 v81, v50, v51
    v_cvt_pk_bf16_f32 v82, v52, v53
    v_cvt_pk_bf16_f32 v83, v54, v55
    buffer_store_dwordx4 v[80:83], v9, s[24:27], s3 offen sc1
    v_dot2_f32_bf16 v58, v80, s50, 0
    v_dot2_f32_bf16 v59, v80, v80, 0
    v_dot2_f32_bf16 v58, v81, s50, v58
    v_dot2_f32_bf16 v59, v81, v81, v59
    v_dot2_f32_bf16 v58, v82, s50, v58
    v_dot2_f32_bf16 v59, v82, v82, v59
    v_dot2_f32_bf16 v58, v83, s50, v58
    v_dot2_f32_bf16 v59, v83, v83, v59
    s_nop 1
    v_add_f32_dpp v58, v58, v58 quad_perm:[1,0,3,2] row_mask:0xf bank_mask:0xf
    v_add_f32_dpp v59, v59, v59 quad_perm:[1,0,3,2] row_mask:0xf bank_mask:0xf
    s_nop 0
    v_add_f32_dpp v58, v58, v58 quad_perm:[2,3,0,1] row_mask:0xf bank_mask:0xf
    v_add_f32_dpp v59, v59, v59 quad_perm:[2,3,0,1] row_mask:0xf bank_mask:0xf
    s_nop 0
    v_add_f32_dpp v58, v58, v58 row_half_mirror row_mask:0xf bank_mask:0xf
    v_add_f32_dpp v59, v59, v59 row_half_mirror row_mask:0xf bank_mask:0xf
    s_nop 0
    v_add_f32_dpp v58, v58, v58 row_mirror row_mask:0xf bank_mask:0xf
    v_add_f32_dpp v59, v59, v59 row_mirror row_mask:0xf bank_mask:0xf
    s_nop 0
    v_add_f32_dpp v58, v58, v58 row_bcast:15 row_mask:0xa bank_mask:0xf
    v_add_f32_dpp v59, v59, v59 row_bcast:15 row_mask:0xa bank_mask:0xf
    s_nop 0
    v_add_f32_dpp v58, v58, v58 row_bcast:31 row_mask:0xc bank_mask:0xf
    v_add_f32_dpp v59, v59, v59 row_bcast:31 row_mask:0xc bank_mask:0xf
    v_mul_f32 v58, 0x3b000000, v58
    v_mul_f32 v59, 0x3b000000, v59
    v_fma_f32 v59, -v58, v58, v59
    v_cvt_pk_bf16_f32 v58, 0, -v58
    v_max_f32 v59, 0, v59
    v_readlane_b32 s52, v58, 63
    v_cvt_pk_bf16_f32 v59, 0, v59
    v_add_f32 v59, 0x3727c5ac, v59
    v_cvt_pk_bf16_f32 v59, 0, v59
    v_sqrt_f32 v59, v59
    v_dot2_f32_bf16 v48, v80, v56, s52
    v_dot2_f32_bf16 v49, v80, v57, s52
    v_dot2_f32_bf16 v50, v81, v56, s52
    v_dot2_f32_bf16 v51, v81, v57, s52
    v_cvt_pk_bf16_f32 v59, 0, v59
    v_rcp_f32 v59, v59
    v_dot2_f32_bf16 v52, v82, v56, s52
    v_dot2_f32_bf16 v53, v82, v57, s52
    v_dot2_f32_bf16 v54, v83, v56, s52
    v_dot2_f32_bf16 v55, v83, v57, s52
    v_readlane_b32 s54, v59, 63
    v_cvt_pk_bf16_f32 v48, 0, v48
    v_cvt_pk_bf16_f32 v49, 0, v49
    v_cvt_pk_bf16_f32 v50, 0, v50
    v_cvt_pk_bf16_f32 v51, 0, v51
    v_cvt_pk_bf16_f32 v52, 0, v52
    v_cvt_pk_bf16_f32 v53, 0, v53
    v_cvt_pk_bf16_f32 v54, 0, v54
    v_cvt_pk_bf16_f32 v55, 0, v55
    v_pk_mul_f32 v[48:49], v[48:49], s[54:55] op_sel_hi:[1,0]
    v_pk_mul_f32 v[50:51], v[50:51], s[54:55] op_sel_hi:[1,0]
    v_pk_mul_f32 v[52:53], v[52:53], s[54:55] op_sel_hi:[1,0]
    v_pk_mul_f32 v[54:55], v[54:55], s[54:55] op_sel_hi:[1,0]
    v_cvt_pk_bf16_f32 v84, v48, v49
    v_cvt_pk_bf16_f32 v85, v50, v51
    v_cvt_pk_bf16_f32 v86, v52, v53
    v_cvt_pk_bf16_f32 v87, v54, v55
    buffer_store_dwordx4 v[84:87], v9, s[28:31], s3 offen sc1
    s_waitcnt vmcnt(0)
    s_add_u32 s92, s68, 0x1a02000
    s_addc_u32 s93, s69, 0
    s_mov_b32 s94, 0x2000
    s_mov_b32 s95, 0x00020000
    s_lshl_b32 s96, s41, 8
    s_lshl_b32 s97, s42, 3
    s_add_u32 s97, s97, s96
    v_mov_b32 v246, s100
    v_mov_b32 v247, s101
    v_mov_b32 v2, 1
    v_mov_b32 v3, s97
    s_waitcnt lgkmcnt(0)
    s_barrier
    s_cmp_lg_u32 s40, 7
    s_cbranch_scc1 .Lpub1
    s_mov_b64 exec, 1
    buffer_store_dwordx2 v[246:247], v3, s[92:95], 0 offen sc1
    s_mov_b64 exec, -1
.Lpub1:
    s_cmp_ge_u32 s40, 4
    s_cbranch_scc1 .Lk3_help
    v_lshrrev_b32 v7, 3, v1
    v_and_b32 v8, 7, v1
    v_lshrrev_b32 v9, 1, v7
    v_xor_b32 v9, v8, v9
    s_movk_i32 s48, 1024
    v_mul_lo_u32 v10, v7, s48
    v_lshl_add_u32 v4, v9, 4, v10
    v_xor_b32 v9, 4, v9
    v_lshl_add_u32 v5, v9, 4, v10
    s_mul_i32 s45, s41, 65536
    s_mul_i32 s48, s40, 256
    s_add_u32 s45, s45, s48
    s_add_u32 s8, s68, 0x1400000
    s_addc_u32 s9, s69, 0
    s_mov_b32 s10, 0x200000
    s_mov_b32 s11, 0x00020000
    v_lshrrev_b32 v7, 5, v1
    v_bfe_u32 v8, v1, 4, 1
    v_bfe_u32 v9, v1, 2, 2
    v_and_b32 v10, 1, v1
    v_bfe_u32 v11, v1, 1, 1
    v_lshl_or_b32 v10, v10, 1, v11
    v_lshlrev_b32 v10, 3, v10
    v_lshl_add_u32 v10, v8, 5, v10
    v_lshl_add_u32 v11, v7, 3, v9
    v_lshrrev_b32 v12, 1, v9
    v_xor_b32 v13, 0, v12
    v_lshl_add_u32 v13, v13, 6, v10
    v_lshl_add_u32 v13, v11, 7, v13
    v_add_u32 v16, s44, v13
    v_xor_b32 v13, 1, v12
    v_lshl_add_u32 v13, v13, 6, v10
    v_lshl_add_u32 v13, v11, 7, v13
    v_add_u32 v17, s44, v13
    v_and_b32 v8, 31, v1
    v_bfe_u32 v9, v8, 1, 3
    v_or_b32 v10, 0, v7
    v_xor_b32 v10, v10, v9
    v_lshlrev_b32 v10, 4, v10
    v_lshl_add_u32 v10, v8, 7, v10
    v_add_u32 v18, s44, v10
    v_or_b32 v10, 2, v7
    v_xor_b32 v10, v10, v9
    v_lshlrev_b32 v10, 4, v10
    v_lshl_add_u32 v10, v8, 7, v10
    v_add_u32 v19, s44, v10
    v_or_b32 v10, 4, v7
    v_xor_b32 v10, v10, v9
    v_lshlrev_b32 v10, 4, v10
    v_lshl_add_u32 v10, v8, 7, v10
    v_add_u32 v20, s44, v10
    v_or_b32 v10, 6, v7
    v_xor_b32 v10, v10, v9
    v_lshlrev_b32 v10, 4, v10
    v_lshl_add_u32 v10, v8, 7, v10
    v_add_u32 v21, s44, v10
    v_mul_u32_u24 v48, 272, v8
    v_lshl_add_u32 v48, v7, 5, v48
    v_add_u32 v48, s44, v48
    v_lshrrev_b32 v10, 3, v1
    v_and_b32 v11, 7, v1
    v_mul_u32_u24 v49, 272, v10
    v_lshl_add_u32 v49, v11, 5, v49
    s_mul_i32 s51, s40, 2176
    v_add_u32 v49, s51, v49
    v_add_u32 v50, 81920, v49
    v_lshlrev_b32 v51, 4, v11
    v_lshl_add_u32 v51, v10, 10, v51
    s_lshl_b32 s50, s41, 16
    s_lshl_b32 s51, s40, 13
    s_add_u32 s50, s50, s51
    s_lshl_b32 s51, s42, 7
    s_add_u32 s50, s50, s51
    v_mov_b32 v12, 0xbdd2d3e8
    v_mov_b32 v14, 0xc0135761
    v_mov_b32 v54, 1.0
    s_add_u32 s28, s68, 0x1600800
    s_addc_u32 s29, s69, 0
    s_mov_b32 s30, 0x200000
    s_mov_b32 s31, 0x00020000
    s_barrier
    s_add_u32 m0, s44, 0
    s_add_u32 s48, s45, 0
    buffer_load_dwordx4 v4, s[8:11], s48 offen lds
    s_add_u32 m0, s44, 1024
    s_add_u32 s48, s45, 8192
    buffer_load_dwordx4 v5, s[8:11], s48 offen lds
    s_add_u32 m0, s44, 2048
    s_add_u32 s48, s45, 16384
    buffer_load_dwordx4 v4, s[8:11], s48 offen lds
    s_add_u32 m0, s44, 3072
    s_add_u32 s48, s45, 24576
    buffer_load_dwordx4 v5, s[8:11], s48 offen lds
    s_add_u32 m0, s44, 4096
    s_add_u32 s48, s45, 32768
    buffer_load_dwordx4 v4, s[8:11], s48 offen lds
    s_add_u32 m0, s44, 5120
    s_add_u32 s48, s45, 40960
    buffer_load_dwordx4 v5, s[8:11], s48 offen lds
    s_add_u32 m0, s44, 6144
    s_add_u32 s48, s45, 49152
    buffer_load_dwordx4 v4, s[8:11], s48 offen lds
    s_add_u32 m0, s44, 7168
    s_add_u32 s48, s45, 57344
    buffer_load_dwordx4 v5, s[8:11], s48 offen lds
    s_add_u32 m0, s44, 8192
    s_add_u32 s48, s45, 128
    buffer_load_dwordx4 v4, s[8:11], s48 offen lds
    s_add_u32 m0, s44, 9216
    s_add_u32 s48, s45, 8320
    buffer_load_dwordx4 v5, s[8:11], s48 offen lds
    s_add_u32 m0, s44, 10240
    s_add_u32 s48, s45, 16512
    buffer_load_dwordx4 v4, s[8:11], s48 offen lds
    s_add_u32 m0, s44, 11264
    s_add_u32 s48, s45, 24704
    buffer_load_dwordx4 v5, s[8:11], s48 offen lds
    s_add_u32 m0, s44, 12288
    s_add_u32 s48, s45, 32896
    buffer_load_dwordx4 v4, s[8:11], s48 offen lds
    s_add_u32 m0, s44, 13312
    s_add_u32 s48, s45, 41088
    buffer_load_dwordx4 v5, s[8:11], s48 offen lds
    s_add_u32 m0, s44, 14336
    s_add_u32 s48, s45, 49280
    buffer_load_dwordx4 v4, s[8:11], s48 offen lds
    s_add_u32 m0, s44, 15360
    s_add_u32 s48, s45, 57472
    buffer_load_dwordx4 v5, s[8:11], s48 offen lds
    s_waitcnt vmcnt(8)
    ds_read_b64_tr_b16 v[128:129], v16 offset:24576
    ds_read_b64_tr_b16 v[130:131], v16 offset:25088
    ds_read_b64_tr_b16 v[132:133], v17 offset:24576
    ds_read_b64_tr_b16 v[134:135], v17 offset:25088
    ds_read_b128 v[136:139], v18 offset:0
    ds_read_b128 v[140:143], v18 offset:4096
    ds_read_b64_tr_b16 v[144:145], v16 offset:26624
    ds_read_b64_tr_b16 v[146:147], v16 offset:27136
    ds_read_b64_tr_b16 v[148:149], v17 offset:26624
    ds_read_b64_tr_b16 v[150:151], v17 offset:27136
    ds_read_b128 v[152:155], v19 offset:0
    ds_read_b128 v[156:159], v19 offset:4096
    s_waitcnt lgkmcnt(6)
    v_mfma_f32_32x32x16_bf16 v[64:79], v[128:131], v[136:139], 0
    ds_read_b64_tr_b16 v[160:161], v16 offset:28672
    ds_read_b64_tr_b16 v[162:163], v16 offset:29184
    ds_read_b64_tr_b16 v[164:165], v17 offset:28672
    ds_read_b64_tr_b16 v[166:167], v17 offset:29184
    ds_read_b128 v[168:171], v20 offset:0
    ds_read_b128 v[172:175], v20 offset:4096
    s_mov_b32 s32, s86
    s_mov_b32 s33, s87
    s_mov_b32 s34, 0x80000
    s_mov_b32 s35, 0x00020000
    v_lshrrev_b32 v2, 3, v1
    v_mfma_f32_32x32x16_bf16 v[80:95], v[128:131], v[140:143], 0
    v_and_b32 v3, 7, v1
    v_lshlrev_b32 v6, 1, v2
    v_and_b32 v6, 4, v6
    v_xor_b32 v3, v3, v6
    v_mfma_f32_32x32x16_bf16 v[96:111], v[132:135], v[136:139], 0
    v_lshlrev_b32 v3, 4, v3
    s_movk_i32 s58, 1024
    v_mul_lo_u32 v2, v2, s58
    v_add_u32 v6, v2, v3
    s_mul_i32 s58, s40, 131072
    s_lshl_b32 s59, s42, 7
    s_add_u32 s58, s58, s59
    s_sub_u32 s58, s58, 8192
    s_add_u32 m0, s44, 24576
    s_add_u32 s58, s58, 8192
    buffer_load_dwordx4 v6, s[32:35], s58 offen lds
    v_mfma_f32_32x32x16_bf16 v[112:127], v[132:135], v[140:143], 0
    s_add_u32 m0, s44, 25600
    s_add_u32 s58, s58, 8192
    buffer_load_dwordx4 v6, s[32:35], s58 offen lds
    s_waitcnt lgkmcnt(6)
    v_mfma_f32_32x32x16_bf16 v[64:79], v[144:147], v[152:155], v[64:79]
    ds_read_b64_tr_b16 v[128:129], v16 offset:30720
    ds_read_b64_tr_b16 v[130:131], v16 offset:31232
    ds_read_b64_tr_b16 v[132:133], v17 offset:30720
    v_mfma_f32_32x32x16_bf16 v[80:95], v[144:147], v[156:159], v[80:95]
    ds_read_b64_tr_b16 v[134:135], v17 offset:31232
    ds_read_b128 v[136:139], v21 offset:0
    ds_read_b128 v[140:143], v21 offset:4096
    v_mfma_f32_32x32x16_bf16 v[96:111], v[148:151], v[152:155], v[96:111]
    s_add_u32 m0, s44, 26624
    s_add_u32 s58, s58, 8192
    buffer_load_dwordx4 v6, s[32:35], s58 offen lds
    v_mfma_f32_32x32x16_bf16 v[112:127], v[148:151], v[156:159], v[112:127]
    s_add_u32 m0, s44, 27648
    s_add_u32 s58, s58, 8192
    buffer_load_dwordx4 v6, s[32:35], s58 offen lds
    s_waitcnt lgkmcnt(6)
    v_mfma_f32_32x32x16_bf16 v[64:79], v[160:163], v[168:171], v[64:79]
    s_waitcnt vmcnt(4)
    ds_read_b64_tr_b16 v[144:145], v16 offset:32768
    ds_read_b64_tr_b16 v[146:147], v16 offset:33280
    ds_read_b64_tr_b16 v[148:149], v17 offset:32768
    v_mfma_f32_32x32x16_bf16 v[80:95], v[160:163], v[172:175], v[80:95]
    ds_read_b64_tr_b16 v[150:151], v17 offset:33280
    ds_read_b128 v[152:155], v18 offset:8192
    ds_read_b128 v[156:159], v18 offset:12288
    v_mfma_f32_32x32x16_bf16 v[96:111], v[164:167], v[168:171], v[96:111]
    s_add_u32 m0, s44, 28672
    s_add_u32 s58, s58, 8192
    buffer_load_dwordx4 v6, s[32:35], s58 offen lds
    v_mfma_f32_32x32x16_bf16 v[112:127], v[164:167], v[172:175], v[112:127]
    s_add_u32 m0, s44, 29696
    s_add_u32 s58, s58, 8192
    buffer_load_dwordx4 v6, s[32:35], s58 offen lds
    s_waitcnt lgkmcnt(6)
    v_mfma_f32_32x32x16_bf16 v[64:79], v[128:131], v[136:139], v[64:79]
    ds_read_b64_tr_b16 v[160:161], v16 offset:34816
    ds_read_b64_tr_b16 v[162:163], v16 offset:35328
    ds_read_b64_tr_b16 v[164:165], v17 offset:34816
    v_mfma_f32_32x32x16_bf16 v[80:95], v[128:131], v[140:143], v[80:95]
    ds_read_b64_tr_b16 v[166:167], v17 offset:35328
    ds_read_b128 v[168:171], v19 offset:8192
    ds_read_b128 v[172:175], v19 offset:12288
    v_mfma_f32_32x32x16_bf16 v[96:111], v[132:135], v[136:139], v[96:111]
    s_add_u32 m0, s44, 30720
    s_add_u32 s58, s58, 8192
    buffer_load_dwordx4 v6, s[32:35], s58 offen lds
    v_mfma_f32_32x32x16_bf16 v[112:127], v[132:135], v[140:143], v[112:127]
    s_add_u32 m0, s44, 31744
    s_add_u32 s58, s58, 8192
    buffer_load_dwordx4 v6, s[32:35], s58 offen lds
    s_waitcnt lgkmcnt(6)
    v_mfma_f32_32x32x16_bf16 v[64:79], v[144:147], v[152:155], v[64:79]
    ds_read_b64_tr_b16 v[128:129], v16 offset:36864
    ds_read_b64_tr_b16 v[130:131], v16 offset:37376
    ds_read_b64_tr_b16 v[132:133], v17 offset:36864
    v_mfma_f32_32x32x16_bf16 v[80:95], v[144:147], v[156:159], v[80:95]
    ds_read_b64_tr_b16 v[134:135], v17 offset:37376
    ds_read_b128 v[136:139], v20 offset:8192
    ds_read_b128 v[140:143], v20 offset:12288
    v_mfma_f32_32x32x16_bf16 v[96:111], v[148:151], v[152:155], v[96:111]
    s_add_u32 m0, s44, 32768
    s_add_u32 s58, s58, 8192
    buffer_load_dwordx4 v6, s[32:35], s58 offen lds
    v_mfma_f32_32x32x16_bf16 v[112:127], v[148:151], v[156:159], v[112:127]
    s_add_u32 m0, s44, 33792
    s_add_u32 s58, s58, 8192
    buffer_load_dwordx4 v6, s[32:35], s58 offen lds
    s_waitcnt lgkmcnt(6)
    v_mfma_f32_32x32x16_bf16 v[64:79], v[160:163], v[168:171], v[64:79]
    ds_read_b64_tr_b16 v[144:145], v16 offset:38912
    ds_read_b64_tr_b16 v[146:147], v16 offset:39424
    ds_read_b64_tr_b16 v[148:149], v17 offset:38912
    v_mfma_f32_32x32x16_bf16 v[80:95], v[160:163], v[172:175], v[80:95]
    ds_read_b64_tr_b16 v[150:151], v17 offset:39424
    ds_read_b128 v[152:155], v21 offset:8192
    ds_read_b128 v[156:159], v21 offset:12288
    v_mfma_f32_32x32x16_bf16 v[96:111], v[164:167], v[168:171], v[96:111]
    s_add_u32 m0, s44, 34816
    s_add_u32 s58, s58, 8192
    buffer_load_dwordx4 v6, s[32:35], s58 offen lds
    v_mfma_f32_32x32x16_bf16 v[112:127], v[164:167], v[172:175], v[112:127]
    s_add_u32 m0, s44, 35840
    s_add_u32 s58, s58, 8192
    buffer_load_dwordx4 v6, s[32:35], s58 offen lds
    s_waitcnt lgkmcnt(6)
    v_mfma_f32_32x32x16_bf16 v[64:79], v[128:131], v[136:139], v[64:79]
    s_add_u32 m0, s44, 36864
    s_add_u32 s58, s58, 8192
    buffer_load_dwordx4 v6, s[32:35], s58 offen lds
    v_mfma_f32_32x32x16_bf16 v[80:95], v[128:131], v[140:143], v[80:95]
    v_mfma_f32_32x32x16_bf16 v[96:111], v[132:135], v[136:139], v[96:111]
    s_add_u32 m0, s44, 37888
    s_add_u32 s58, s58, 8192
    buffer_load_dwordx4 v6, s[32:35], s58 offen lds
    v_mfma_f32_32x32x16_bf16 v[112:127], v[132:135], v[140:143], v[112:127]
    s_waitcnt lgkmcnt(0)
    v_mfma_f32_32x32x16_bf16 v[64:79], v[144:147], v[152:155], v[64:79]
    s_add_u32 m0, s44, 38912
    s_add_u32 s58, s58, 8192
    buffer_load_dwordx4 v6, s[32:35], s58 offen lds
    v_mfma_f32_32x32x16_bf16 v[80:95], v[144:147], v[156:159], v[80:95]
    v_mfma_f32_32x32x16_bf16 v[96:111], v[148:151], v[152:155], v[96:111]
    s_add_u32 m0, s44, 39936
    s_add_u32 s58, s58, 8192
    buffer_load_dwordx4 v6, s[32:35], s58 offen lds
    v_mfma_f32_32x32x16_bf16 v[112:127], v[148:151], v[156:159], v[112:127]
    s_nop 7
    s_nop 1
    ds_write_b128 v48, v[64:67] offset:0
    ds_write_b128 v48, v[68:71] offset:16
    ds_write_b128 v48, v[72:75] offset:64
    ds_write_b128 v48, v[76:79] offset:80
    ds_write_b128 v48, v[80:83] offset:8704
    ds_write_b128 v48, v[84:87] offset:8720
    ds_write_b128 v48, v[88:91] offset:8768
    ds_write_b128 v48, v[92:95] offset:8784
    s_waitcnt lgkmcnt(0)
    ds_write_b128 v48, v[96:99] offset:128
    ds_write_b128 v48, v[100:103] offset:144
    ds_write_b128 v48, v[104:107] offset:192
    ds_write_b128 v48, v[108:111] offset:208
    ds_write_b128 v48, v[112:115] offset:8832
    ds_write_b128 v48, v[116:119] offset:8848
    ds_write_b128 v48, v[120:123] offset:8896
    ds_write_b128 v48, v[124:127] offset:8912
    s_waitcnt lgkmcnt(0)
    s_branch .Lk3_join
.Lk3_help:
    v_lshrrev_b32 v10, 3, v1
    v_and_b32 v11, 7, v1
    v_mul_u32_u24 v49, 272, v10
    v_lshl_add_u32 v49, v11, 5, v49
    s_mul_i32 s51, s40, 2176
    v_add_u32 v49, s51, v49
    v_add_u32 v50, 81920, v49
    v_lshlrev_b32 v51, 4, v11
    v_lshl_add_u32 v51, v10, 10, v51
    s_lshl_b32 s50, s41, 16
    s_lshl_b32 s51, s40, 13
    s_add_u32 s50, s50, s51
    s_lshl_b32 s51, s42, 7
    s_add_u32 s50, s50, s51
    v_mov_b32 v12, 0xbdd2d3e8
    v_mov_b32 v14, 0xc0135761
    v_mov_b32 v54, 1.0
    s_add_u32 s28, s68, 0x1600800
    s_addc_u32 s29, s69, 0
    s_mov_b32 s30, 0x200000
    s_mov_b32 s31, 0x00020000
    s_cmp_lg_u32 s40, 7
    s_cbranch_scc1 .Lpl1_done
    v_and_b32 v3, 7, v1
    v_lshlrev_b32 v3, 3, v3
    v_add_u32 v3, s96, v3
    s_mov_b32 s98, 0
    s_mov_b32 s99, 0
.Lpl1_sp:
    s_buffer_load_dwordx16 s[8:23], s[92:95], s96 glc
    s_add_u32 s99, s99, 1
    s_waitcnt lgkmcnt(0)
    s_xor_b64 s[8:9], s[8:9], s[100:101]
    s_xor_b64 s[10:11], s[10:11], s[100:101]
    s_xor_b64 s[12:13], s[12:13], s[100:101]
    s_xor_b64 s[14:15], s[14:15], s[100:101]
    s_xor_b64 s[16:17], s[16:17], s[100:101]
    s_xor_b64 s[18:19], s[18:19], s[100:101]
    s_xor_b64 s[20:21], s[20:21], s[100:101]
    s_xor_b64 s[22:23], s[22:23], s[100:101]
    s_or_b64 s[8:9], s[8:9], s[10:11]
    s_or_b64 s[8:9], s[8:9], s[12:13]
    s_or_b64 s[8:9], s[8:9], s[14:15]
    s_or_b64 s[8:9], s[8:9], s[16:17]
    s_or_b64 s[8:9], s[8:9], s[18:19]
    s_or_b64 s[8:9], s[8:9], s[20:21]
    s_or_b64 s[8:9], s[8:9], s[22:23]
    s_cbranch_scc0 .Lpl1_sd
    s_and_b32 s98, s99, 3
    s_cbranch_scc1 .Lpl1_sp
    buffer_load_dwordx2 v[248:249], v3, s[92:95], 0 offen sc1
    s_waitcnt vmcnt(0)
    v_xor_b32 v248, s100, v248
    v_xor_b32 v249, s101, v249
    v_or_b32 v248, v248, v249
    v_cmp_ne_u32 vcc, 0, v248
    s_cmp_lt_u32 s99, 0x80000
    s_cbranch_scc0 .Lpl1_sd
    s_cbranch_vccnz .Lpl1_sp
.Lpl1_sd:
.Lpl1_done:
    s_barrier
    s_waitcnt vmcnt(0)
.Lk3_join:
    s_barrier
    ds_read_b128 v[64:67], v49 offset:0
    ds_read_b128 v[68:71], v49 offset:16
    ds_read_b128 v[80:83], v49 offset:40960
    ds_read_b128 v[84:87], v49 offset:40976
    ds_read_b128 v[96:99], v50 offset:0
    ds_read_b128 v[100:103], v50 offset:16
    ds_read_b128 v[112:115], v50 offset:40960
    ds_read_b128 v[116:119], v50 offset:40976
    s_waitcnt lgkmcnt(4)
    v_pk_add_f32 v[64:65], v[64:65], v[80:81]
    v_pk_add_f32 v[66:67], v[66:67], v[82:83]
    v_pk_add_f32 v[68:69], v[68:69], v[84:85]
    v_pk_add_f32 v[70:71], v[70:71], v[86:87]
    s_waitcnt lgkmcnt(0)
    v_pk_add_f32 v[96:97], v[96:97], v[112:113]
    v_pk_add_f32 v[98:99], v[98:99], v[114:115]
    v_pk_add_f32 v[100:101], v[100:101], v[116:117]
    v_pk_add_f32 v[102:103], v[102:103], v[118:119]
    v_pk_add_f32 v[64:65], v[64:65], v[96:97]
    v_pk_add_f32 v[66:67], v[66:67], v[98:99]
    v_pk_add_f32 v[68:69], v[68:69], v[100:101]
    v_pk_add_f32 v[70:71], v[70:71], v[102:103]
    v_cvt_pk_bf16_f32 v64, 0, v64
    v_cvt_pk_bf16_f32 v65, 0, v65
    v_cvt_pk_bf16_f32 v66, 0, v66
    v_cvt_pk_bf16_f32 v67, 0, v67
    v_cvt_pk_bf16_f32 v68, 0, v68
    v_cvt_pk_bf16_f32 v69, 0, v69
    v_cvt_pk_bf16_f32 v70, 0, v70
    v_cvt_pk_bf16_f32 v71, 0, v71
    v_pk_mul_f32 v[72:73], v[64:65], v[64:65]
    v_pk_mul_f32 v[74:75], v[66:67], v[66:67]
    v_pk_mul_f32 v[76:77], v[68:69], v[68:69]
    v_pk_mul_f32 v[78:79], v[70:71], v[70:71]
    v_pk_fma_f32 v[72:73], v[72:73], v[12:13], v[14:15] op_sel_hi:[1,0,0]
    v_pk_fma_f32 v[74:75], v[74:75], v[12:13], v[14:15] op_sel_hi:[1,0,0]
    v_pk_fma_f32 v[76:77], v[76:77], v[12:13], v[14:15] op_sel_hi:[1,0,0]
    v_pk_fma_f32 v[78:79], v[78:79], v[12:13], v[14:15] op_sel_hi:[1,0,0]
    v_pk_mul_f32 v[72:73], v[72:73], v[64:65]
    v_pk_mul_f32 v[74:75], v[74:75], v[66:67]
    v_pk_mul_f32 v[76:77], v[76:77], v[68:69]
    v_pk_mul_f32 v[78:79], v[78:79], v[70:71]
    v_exp_f32 v72, v72
    v_exp_f32 v73, v73
    v_exp_f32 v74, v74
    v_exp_f32 v75, v75
    v_exp_f32 v76, v76
    v_exp_f32 v77, v77
    v_exp_f32 v78, v78
    v_exp_f32 v79, v79
    v_pk_add_f32 v[72:73], v[72:73], v[54:55] op_sel_hi:[1,0]
    v_pk_add_f32 v[74:75], v[74:75], v[54:55] op_sel_hi:[1,0]
    v_pk_add_f32 v[76:77], v[76:77], v[54:55] op_sel_hi:[1,0]
    v_pk_add_f32 v[78:79], v[78:79], v[54:55] op_sel_hi:[1,0]
    v_rcp_f32 v72, v72
    v_rcp_f32 v73, v73
    v_rcp_f32 v74, v74
    v_rcp_f32 v75, v75
    v_rcp_f32 v76, v76
    v_rcp_f32 v77, v77
    v_rcp_f32 v78, v78
    v_rcp_f32 v79, v79
    s_nop 0
    v_pk_mul_f32 v[64:65], v[64:65], v[72:73]
    v_pk_mul_f32 v[66:67], v[66:67], v[74:75]
    v_pk_mul_f32 v[68:69], v[68:69], v[76:77]
    v_pk_mul_f32 v[70:71], v[70:71], v[78:79]
    v_cvt_pk_bf16_f32 v56, v64, v65
    v_cvt_pk_bf16_f32 v57, v66, v67
    v_cvt_pk_bf16_f32 v58, v68, v69
    v_cvt_pk_bf16_f32 v59, v70, v71
    buffer_store_dwordx4 v[56:59], v51, s[28:31], s50 offen sc1
    s_waitcnt vmcnt(0)
    s_add_u32 s92, s68, 0x1a04000
    s_addc_u32 s93, s69, 0
    s_mov_b32 s94, 0x2000
    s_mov_b32 s95, 0x00020000
    s_lshl_b32 s96, s41, 8
    s_lshl_b32 s97, s42, 3
    s_add_u32 s97, s97, s96
    v_mov_b32 v246, s100
    v_mov_b32 v247, s101
    v_mov_b32 v2, 1
    v_mov_b32 v3, s97
    s_waitcnt lgkmcnt(0)
    s_barrier
    s_cmp_lg_u32 s40, 7
    s_cbranch_scc1 .Lpub2
    s_mov_b64 exec, 1
    buffer_store_dwordx2 v[246:247], v3, s[92:95], 0 offen sc1
    s_mov_b64 exec, -1
.Lpub2:
    s_cmp_ge_u32 s40, 4
    s_cbranch_scc1 .Lk4_help
    v_lshrrev_b32 v7, 3, v1
    v_and_b32 v8, 7, v1
    v_lshrrev_b32 v9, 1, v7
    v_xor_b32 v9, v8, v9
    s_movk_i32 s48, 1024
    v_mul_lo_u32 v10, v7, s48
    v_lshl_add_u32 v4, v9, 4, v10
    v_xor_b32 v9, 4, v9
    v_lshl_add_u32 v5, v9, 4, v10
    s_mul_i32 s45, s41, 65536
    s_mul_i32 s48, s40, 256
    s_add_u32 s45, s45, s48
    s_lshl_b32 s48, s40, 2
    s_lshr_b32 s49, 0x4031, s48
    s_and_b32 s49, s49, 15
    s_lshl_b32 s49, s49, 10
    s_add_u32 s45, s45, s49
    s_add_u32 s8, s68, 0x1600000
    s_addc_u32 s9, s69, 0
    s_mov_b32 s10, 0x201000
    s_mov_b32 s11, 0x00020000
    v_lshrrev_b32 v7, 5, v1
    v_bfe_u32 v8, v1, 4, 1
    v_bfe_u32 v9, v1, 2, 2
    v_and_b32 v10, 1, v1
    v_bfe_u32 v11, v1, 1, 1
    v_lshl_or_b32 v10, v10, 1, v11
    v_lshlrev_b32 v10, 3, v10
    v_lshl_add_u32 v10, v8, 5, v10
    v_lshl_add_u32 v11, v7, 3, v9
    v_lshrrev_b32 v12, 1, v9
    v_xor_b32 v13, 0, v12
    v_lshl_add_u32 v13, v13, 6, v10
    v_lshl_add_u32 v13, v11, 7, v13
    v_add_u32 v16, s44, v13
    v_xor_b32 v13, 1, v12
    v_lshl_add_u32 v13, v13, 6, v10
    v_lshl_add_u32 v13, v11, 7, v13
    v_add_u32 v17, s44, v13
    v_and_b32 v8, 31, v1
    v_bfe_u32 v9, v8, 1, 3
    v_or_b32 v10, 0, v7
    v_xor_b32 v10, v10, v9
    v_lshlrev_b32 v10, 4, v10
    v_lshl_add_u32 v10, v8, 7, v10
    v_add_u32 v18, s44, v10
    v_or_b32 v10, 2, v7
    v_xor_b32 v10, v10, v9
    v_lshlrev_b32 v10, 4, v10
    v_lshl_add_u32 v10, v8, 7, v10
    v_add_u32 v19, s44, v10
    v_or_b32 v10, 4, v7
    v_xor_b32 v10, v10, v9
    v_lshlrev_b32 v10, 4, v10
    v_lshl_add_u32 v10, v8, 7, v10
    v_add_u32 v20, s44, v10
    v_or_b32 v10, 6, v7
    v_xor_b32 v10, v10, v9
    v_lshlrev_b32 v10, 4, v10
    v_lshl_add_u32 v10, v8, 7, v10
    v_add_u32 v21, s44, v10
    v_mul_u32_u24 v48, 272, v8
    v_lshl_add_u32 v48, v7, 5, v48
    v_add_u32 v48, s44, v48
    v_lshrrev_b32 v10, 3, v1
    v_and_b32 v11, 7, v1
    v_mul_u32_u24 v49, 272, v10
    v_lshl_add_u32 v49, v11, 5, v49
    s_mul_i32 s51, s40, 2176
    v_add_u32 v49, s51, v49
    v_add_u32 v50, 81920, v49
    v_lshlrev_b32 v51, 4, v11
    v_lshl_add_u32 v51, v10, 10, v51
    s_lshl_b32 s50, s41, 16
    s_lshl_b32 s51, s40, 13
    s_add_u32 s50, s50, s51
    s_lshl_b32 s51, s42, 7
    s_add_u32 s50, s50, s51
    v_lshlrev_b32 v52, 3, v10
    s_lshl_b32 s54, s41, 9
    s_lshl_b32 s51, s40, 6
    s_add_u32 s54, s54, s51
    s_lshl_b32 s51, s42, 14
    s_add_u32 s54, s54, s51
    s_add_u32 s16, s68, 0x1200000
    s_addc_u32 s17, s69, 0
    s_mov_b32 s18, 0x200000
    s_mov_b32 s19, 0x00020000
    s_add_u32 s28, s68, 0x600000
    s_addc_u32 s29, s69, 0
    s_mov_b32 s30, 0x200000
    s_mov_b32 s31, 0x00020000
    s_add_u32 s36, s68, 0x1900000
    s_addc_u32 s37, s69, 0
    s_mov_b32 s38, 0x40000
    s_mov_b32 s39, 0x00020000
    buffer_load_dwordx4 v[24:27], v51, s[16:19], s50 offen
    s_barrier
    s_add_u32 m0, s44, 0
    s_add_u32 s48, s45, 0
    buffer_load_dwordx4 v4, s[8:11], s48 offen lds
    s_add_u32 m0, s44, 1024
    s_add_u32 s48, s45, 8192
    buffer_load_dwordx4 v5, s[8:11], s48 offen lds
    s_add_u32 m0, s44, 2048
    s_add_u32 s48, s45, 16384
    buffer_load_dwordx4 v4, s[8:11], s48 offen lds
    s_add_u32 m0, s44, 3072
    s_add_u32 s48, s45, 24576
    buffer_load_dwordx4 v5, s[8:11], s48 offen lds
    s_add_u32 m0, s44, 4096
    s_add_u32 s48, s45, 32768
    buffer_load_dwordx4 v4, s[8:11], s48 offen lds
    s_add_u32 m0, s44, 5120
    s_add_u32 s48, s45, 40960
    buffer_load_dwordx4 v5, s[8:11], s48 offen lds
    s_add_u32 m0, s44, 6144
    s_add_u32 s48, s45, 49152
    buffer_load_dwordx4 v4, s[8:11], s48 offen lds
    s_add_u32 m0, s44, 7168
    s_add_u32 s48, s45, 57344
    buffer_load_dwordx4 v5, s[8:11], s48 offen lds
    s_add_u32 m0, s44, 8192
    s_add_u32 s48, s45, 128
    buffer_load_dwordx4 v4, s[8:11], s48 offen lds
    s_add_u32 m0, s44, 9216
    s_add_u32 s48, s45, 8320
    buffer_load_dwordx4 v5, s[8:11], s48 offen lds
    s_add_u32 m0, s44, 10240
    s_add_u32 s48, s45, 16512
    buffer_load_dwordx4 v4, s[8:11], s48 offen lds
    s_add_u32 m0, s44, 11264
    s_add_u32 s48, s45, 24704
    buffer_load_dwordx4 v5, s[8:11], s48 offen lds
    s_add_u32 m0, s44, 12288
    s_add_u32 s48, s45, 32896
    buffer_load_dwordx4 v4, s[8:11], s48 offen lds
    s_add_u32 m0, s44, 13312
    s_add_u32 s48, s45, 41088
    buffer_load_dwordx4 v5, s[8:11], s48 offen lds
    s_add_u32 m0, s44, 14336
    s_add_u32 s48, s45, 49280
    buffer_load_dwordx4 v4, s[8:11], s48 offen lds
    s_add_u32 m0, s44, 15360
    s_add_u32 s48, s45, 57472
    buffer_load_dwordx4 v5, s[8:11], s48 offen lds
    s_waitcnt vmcnt(8)
    ds_read_b64_tr_b16 v[128:129], v16 offset:24576
    ds_read_b64_tr_b16 v[130:131], v16 offset:25088
    ds_read_b64_tr_b16 v[132:133], v17 offset:24576
    ds_read_b64_tr_b16 v[134:135], v17 offset:25088
    ds_read_b128 v[136:139], v18 offset:0
    ds_read_b128 v[140:143], v18 offset:4096
    ds_read_b64_tr_b16 v[144:145], v16 offset:26624
    ds_read_b64_tr_b16 v[146:147], v16 offset:27136
    ds_read_b64_tr_b16 v[148:149], v17 offset:26624
    ds_read_b64_tr_b16 v[150:151], v17 offset:27136
    ds_read_b128 v[152:155], v19 offset:0
    ds_read_b128 v[156:159], v19 offset:4096
    s_waitcnt lgkmcnt(6)
    v_mfma_f32_32x32x16_bf16 v[64:79], v[128:131], v[136:139], 0
    ds_read_b64_tr_b16 v[160:161], v16 offset:28672
    ds_read_b64_tr_b16 v[162:163], v16 offset:29184
    ds_read_b64_tr_b16 v[164:165], v17 offset:28672
    ds_read_b64_tr_b16 v[166:167], v17 offset:29184
    ds_read_b128 v[168:171], v20 offset:0
    ds_read_b128 v[172:175], v20 offset:4096
    s_mov_b32 s32, s88
    s_mov_b32 s33, s89
    s_mov_b32 s34, 0x1c0000
    s_mov_b32 s35, 0x00020000
    v_lshrrev_b32 v2, 3, v1
    v_and_b32 v3, 7, v1
    v_mfma_f32_32x32x16_bf16 v[80:95], v[128:131], v[140:143], 0
    v_lshlrev_b32 v6, 1, v2
    v_and_b32 v6, 4, v6
    v_xor_b32 v3, v3, v6
    v_lshlrev_b32 v3, 4, v3
    s_movk_i32 s58, 3584
    v_mul_lo_u32 v2, v2, s58
    v_add_u32 v6, v2, v3
    s_min_u32 s58, s42, 6
    s_lshl_b32 s58, s58, 9
    s_lshl_b32 s59, s40, 7
    s_add_u32 s58, s58, s59
    s_sub_u32 s58, s58, 28672
    s_add_u32 m0, s44, 18432
    s_add_u32 s58, s58, 28672
    buffer_load_dwordx4 v6, s[32:35], s58 offen lds
    v_mfma_f32_32x32x16_bf16 v[96:111], v[132:135], v[136:139], 0
    s_add_u32 m0, s44, 19456
    s_add_u32 s58, s58, 28672
    buffer_load_dwordx4 v6, s[32:35], s58 offen lds
    s_add_u32 m0, s44, 20480
    s_add_u32 s58, s58, 28672
    buffer_load_dwordx4 v6, s[32:35], s58 offen lds
    s_add_u32 m0, s44, 21504
    s_add_u32 s58, s58, 28672
    buffer_load_dwordx4 v6, s[32:35], s58 offen lds
    v_mfma_f32_32x32x16_bf16 v[112:127], v[132:135], v[140:143], 0
    s_add_u32 m0, s44, 22528
    s_add_u32 s58, s58, 28672
    buffer_load_dwordx4 v6, s[32:35], s58 offen lds
    s_add_u32 m0, s44, 23552
    s_add_u32 s58, s58, 28672
    buffer_load_dwordx4 v6, s[32:35], s58 offen lds
    s_add_u32 m0, s44, 24576
    s_add_u32 s58, s58, 28672
    buffer_load_dwordx4 v6, s[32:35], s58 offen lds
    s_add_u32 m0, s44, 25600
    s_add_u32 s58, s58, 28672
    buffer_load_dwordx4 v6, s[32:35], s58 offen lds
    s_waitcnt lgkmcnt(6)
    v_mfma_f32_32x32x16_bf16 v[64:79], v[144:147], v[152:155], v[64:79]
    ds_read_b64_tr_b16 v[128:129], v16 offset:30720
    ds_read_b64_tr_b16 v[130:131], v16 offset:31232
    ds_read_b64_tr_b16 v[132:133], v17 offset:30720
    v_mfma_f32_32x32x16_bf16 v[80:95], v[144:147], v[156:159], v[80:95]
    ds_read_b64_tr_b16 v[134:135], v17 offset:31232
    ds_read_b128 v[136:139], v21 offset:0
    ds_read_b128 v[140:143], v21 offset:4096
    v_mfma_f32_32x32x16_bf16 v[96:111], v[148:151], v[152:155], v[96:111]
    s_add_u32 m0, s44, 26624
    s_add_u32 s58, s58, 28672
    buffer_load_dwordx4 v6, s[32:35], s58 offen lds
    v_mfma_f32_32x32x16_bf16 v[112:127], v[148:151], v[156:159], v[112:127]
    s_add_u32 m0, s44, 27648
    s_add_u32 s58, s58, 28672
    buffer_load_dwordx4 v6, s[32:35], s58 offen lds
    s_waitcnt lgkmcnt(6)
    v_mfma_f32_32x32x16_bf16 v[64:79], v[160:163], v[168:171], v[64:79]
    s_waitcnt vmcnt(10)
    ds_read_b64_tr_b16 v[144:145], v16 offset:32768
    ds_read_b64_tr_b16 v[146:147], v16 offset:33280
    ds_read_b64_tr_b16 v[148:149], v17 offset:32768
    v_mfma_f32_32x32x16_bf16 v[80:95], v[160:163], v[172:175], v[80:95]
    ds_read_b64_tr_b16 v[150:151], v17 offset:33280
    ds_read_b128 v[152:155], v18 offset:8192
    ds_read_b128 v[156:159], v18 offset:12288
    v_mfma_f32_32x32x16_bf16 v[96:111], v[164:167], v[168:171], v[96:111]
    s_add_u32 m0, s44, 28672
    s_add_u32 s58, s58, 28672
    buffer_load_dwordx4 v6, s[32:35], s58 offen lds
    v_mfma_f32_32x32x16_bf16 v[112:127], v[164:167], v[172:175], v[112:127]
    s_add_u32 m0, s44, 29696
    s_add_u32 s58, s58, 28672
    buffer_load_dwordx4 v6, s[32:35], s58 offen lds
    s_waitcnt lgkmcnt(6)
    v_mfma_f32_32x32x16_bf16 v[64:79], v[128:131], v[136:139], v[64:79]
    ds_read_b64_tr_b16 v[160:161], v16 offset:34816
    ds_read_b64_tr_b16 v[162:163], v16 offset:35328
    ds_read_b64_tr_b16 v[164:165], v17 offset:34816
    v_mfma_f32_32x32x16_bf16 v[80:95], v[128:131], v[140:143], v[80:95]
    ds_read_b64_tr_b16 v[166:167], v17 offset:35328
    ds_read_b128 v[168:171], v19 offset:8192
    ds_read_b128 v[172:175], v19 offset:12288
    v_mfma_f32_32x32x16_bf16 v[96:111], v[132:135], v[136:139], v[96:111]
    s_add_u32 m0, s44, 30720
    s_add_u32 s58, s58, 28672
    buffer_load_dwordx4 v6, s[32:35], s58 offen lds
    v_mfma_f32_32x32x16_bf16 v[112:127], v[132:135], v[140:143], v[112:127]
    s_add_u32 m0, s44, 31744
    s_add_u32 s58, s58, 28672
    buffer_load_dwordx4 v6, s[32:35], s58 offen lds
    s_waitcnt lgkmcnt(6)
    v_mfma_f32_32x32x16_bf16 v[64:79], v[144:147], v[152:155], v[64:79]
    ds_read_b64_tr_b16 v[128:129], v16 offset:36864
    ds_read_b64_tr_b16 v[130:131], v16 offset:37376
    ds_read_b64_tr_b16 v[132:133], v17 offset:36864
    v_mfma_f32_32x32x16_bf16 v[80:95], v[144:147], v[156:159], v[80:95]
    ds_read_b64_tr_b16 v[134:135], v17 offset:37376
    ds_read_b128 v[136:139], v20 offset:8192
    ds_read_b128 v[140:143], v20 offset:12288
    v_mfma_f32_32x32x16_bf16 v[96:111], v[148:151], v[152:155], v[96:111]
    s_add_u32 m0, s44, 32768
    s_add_u32 s58, s58, 28672
    buffer_load_dwordx4 v6, s[32:35], s58 offen lds
    v_mfma_f32_32x32x16_bf16 v[112:127], v[148:151], v[156:159], v[112:127]
    s_add_u32 m0, s44, 33792
    s_add_u32 s58, s58, 28672
    buffer_load_dwordx4 v6, s[32:35], s58 offen lds
    s_waitcnt lgkmcnt(6)
    v_mfma_f32_32x32x16_bf16 v[64:79], v[160:163], v[168:171], v[64:79]
    ds_read_b64_tr_b16 v[144:145], v16 offset:38912
    ds_read_b64_tr_b16 v[146:147], v16 offset:39424
    ds_read_b64_tr_b16 v[148:149], v17 offset:38912
    v_mfma_f32_32x32x16_bf16 v[80:95], v[160:163], v[172:175], v[80:95]
    ds_read_b64_tr_b16 v[150:151], v17 offset:39424
    ds_read_b128 v[152:155], v21 offset:8192
    ds_read_b128 v[156:159], v21 offset:12288
    v_mfma_f32_32x32x16_bf16 v[96:111], v[164:167], v[168:171], v[96:111]
    s_add_u32 m0, s44, 34816
    s_add_u32 s58, s58, 28672
    buffer_load_dwordx4 v6, s[32:35], s58 offen lds
    v_mfma_f32_32x32x16_bf16 v[112:127], v[164:167], v[172:175], v[112:127]
    s_add_u32 m0, s44, 35840
    s_add_u32 s58, s58, 28672
    buffer_load_dwordx4 v6, s[32:35], s58 offen lds
    s_waitcnt lgkmcnt(6)
    v_mfma_f32_32x32x16_bf16 v[64:79], v[128:131], v[136:139], v[64:79]
    s_add_u32 m0, s44, 36864
    s_add_u32 s58, s58, 28672
    buffer_load_dwordx4 v6, s[32:35], s58 offen lds
    v_mfma_f32_32x32x16_bf16 v[80:95], v[128:131], v[140:143], v[80:95]
    v_mfma_f32_32x32x16_bf16 v[96:111], v[132:135], v[136:139], v[96:111]
    s_add_u32 m0, s44, 37888
    s_add_u32 s58, s58, 28672
    buffer_load_dwordx4 v6, s[32:35], s58 offen lds
    v_mfma_f32_32x32x16_bf16 v[112:127], v[132:135], v[140:143], v[112:127]
    s_waitcnt lgkmcnt(0)
    v_mfma_f32_32x32x16_bf16 v[64:79], v[144:147], v[152:155], v[64:79]
    s_add_u32 m0, s44, 38912
    s_add_u32 s58, s58, 28672
    buffer_load_dwordx4 v6, s[32:35], s58 offen lds
    v_mfma_f32_32x32x16_bf16 v[80:95], v[144:147], v[156:159], v[80:95]
    v_mfma_f32_32x32x16_bf16 v[96:111], v[148:151], v[152:155], v[96:111]
    s_add_u32 m0, s44, 39936
    s_add_u32 s58, s58, 28672
    buffer_load_dwordx4 v6, s[32:35], s58 offen lds
    v_mfma_f32_32x32x16_bf16 v[112:127], v[148:151], v[156:159], v[112:127]
    s_nop 7
    s_nop 1
    ds_write_b128 v48, v[64:67] offset:0
    ds_write_b128 v48, v[68:71] offset:16
    ds_write_b128 v48, v[72:75] offset:64
    ds_write_b128 v48, v[76:79] offset:80
    ds_write_b128 v48, v[80:83] offset:8704
    ds_write_b128 v48, v[84:87] offset:8720
    ds_write_b128 v48, v[88:91] offset:8768
    ds_write_b128 v48, v[92:95] offset:8784
    s_waitcnt lgkmcnt(0)
    ds_write_b128 v48, v[96:99] offset:128
    ds_write_b128 v48, v[100:103] offset:144
    ds_write_b128 v48, v[104:107] offset:192
    ds_write_b128 v48, v[108:111] offset:208
    ds_write_b128 v48, v[112:115] offset:8832
    ds_write_b128 v48, v[116:119] offset:8848
    ds_write_b128 v48, v[120:123] offset:8896
    ds_write_b128 v48, v[124:127] offset:8912
    s_waitcnt lgkmcnt(0)
    s_branch .Lk4_join
.Lk4_help:
    v_lshrrev_b32 v10, 3, v1
    v_and_b32 v11, 7, v1
    v_mul_u32_u24 v49, 272, v10
    v_lshl_add_u32 v49, v11, 5, v49
    s_mul_i32 s51, s40, 2176
    v_add_u32 v49, s51, v49
    v_add_u32 v50, 81920, v49
    v_lshlrev_b32 v51, 4, v11
    v_lshl_add_u32 v51, v10, 10, v51
    s_lshl_b32 s50, s41, 16
    s_lshl_b32 s51, s40, 13
    s_add_u32 s50, s50, s51
    s_lshl_b32 s51, s42, 7
    s_add_u32 s50, s50, s51
    v_lshlrev_b32 v52, 3, v10
    s_lshl_b32 s54, s41, 9
    s_lshl_b32 s51, s40, 6
    s_add_u32 s54, s54, s51
    s_lshl_b32 s51, s42, 14
    s_add_u32 s54, s54, s51
    s_add_u32 s16, s68, 0x1200000
    s_addc_u32 s17, s69, 0
    s_mov_b32 s18, 0x200000
    s_mov_b32 s19, 0x00020000
    s_add_u32 s28, s68, 0x600000
    s_addc_u32 s29, s69, 0
    s_mov_b32 s30, 0x200000
    s_mov_b32 s31, 0x00020000
    s_add_u32 s36, s68, 0x1900000
    s_addc_u32 s37, s69, 0
    s_mov_b32 s38, 0x40000
    s_mov_b32 s39, 0x00020000
    buffer_load_dwordx4 v[24:27], v51, s[16:19], s50 offen
    s_cmp_lg_u32 s40, 7
    s_cbranch_scc1 .Lpl2_done
    v_and_b32 v3, 7, v1
    v_lshlrev_b32 v3, 3, v3
    v_bfe_u32 v2, v1, 3, 2
    v_min_u32 v2, 2, v2
    v_add_u32 v2, s41, v2
    v_max_u32 v2, 1, v2
    v_min_u32 v2, 32, v2
    v_subrev_u32 v2, 1, v2
    v_lshl_add_u32 v3, v2, 8, v3
    s_mov_b32 s98, 0
    s_mov_b32 s99, 0
.Lpl2x_poll:
    buffer_load_dwordx2 v[248:249], v3, s[92:95], 0 offen sc1
    s_add_u32 s99, s99, 1
    s_waitcnt vmcnt(0)
    v_xor_b32 v248, s100, v248
    v_xor_b32 v249, s101, v249
    v_or_b32 v248, v248, v249
    v_cmp_ne_u32 vcc, 0, v248
    s_cmp_lt_u32 s99, 0x40000
    s_cbranch_scc0 .Lpl2x_done
    s_cbranch_vccnz .Lpl2x_poll
.Lpl2x_done:
.Lpl2_done:
    s_barrier
    s_waitcnt vmcnt(0)
.Lk4_join:
    s_barrier
    ds_read_b128 v[64:67], v49 offset:0
    ds_read_b128 v[68:71], v49 offset:16
    ds_read_b128 v[80:83], v49 offset:40960
    ds_read_b128 v[84:87], v49 offset:40976
    ds_read_b128 v[96:99], v50 offset:0
    ds_read_b128 v[100:103], v50 offset:16
    ds_read_b128 v[112:115], v50 offset:40960
    ds_read_b128 v[116:119], v50 offset:40976
    v_lshlrev_b32 v72, 16, v24
    v_and_b32 v73, s43, v24
    v_lshlrev_b32 v74, 16, v25
    v_and_b32 v75, s43, v25
    v_lshlrev_b32 v76, 16, v26
    v_and_b32 v77, s43, v26
    v_lshlrev_b32 v78, 16, v27
    v_and_b32 v79, s43, v27
    s_waitcnt lgkmcnt(4)
    v_pk_add_f32 v[64:65], v[64:65], v[80:81]
    v_pk_add_f32 v[66:67], v[66:67], v[82:83]
    v_pk_add_f32 v[68:69], v[68:69], v[84:85]
    v_pk_add_f32 v[70:71], v[70:71], v[86:87]
    s_waitcnt lgkmcnt(0)
    v_pk_add_f32 v[96:97], v[96:97], v[112:113]
    v_pk_add_f32 v[98:99], v[98:99], v[114:115]
    v_pk_add_f32 v[100:101], v[100:101], v[116:117]
    v_pk_add_f32 v[102:103], v[102:103], v[118:119]
    v_pk_add_f32 v[64:65], v[64:65], v[96:97]
    v_pk_add_f32 v[66:67], v[66:67], v[98:99]
    v_pk_add_f32 v[68:69], v[68:69], v[100:101]
    v_pk_add_f32 v[70:71], v[70:71], v[102:103]
    v_cvt_pk_bf16_f32 v64, 0, v64
    v_cvt_pk_bf16_f32 v65, 0, v65
    v_cvt_pk_bf16_f32 v66, 0, v66
    v_cvt_pk_bf16_f32 v67, 0, v67
    v_cvt_pk_bf16_f32 v68, 0, v68
    v_cvt_pk_bf16_f32 v69, 0, v69
    v_cvt_pk_bf16_f32 v70, 0, v70
    v_cvt_pk_bf16_f32 v71, 0, v71
    v_pk_add_f32 v[64:65], v[64:65], v[72:73]
    v_pk_add_f32 v[66:67], v[66:67], v[74:75]
    v_pk_add_f32 v[68:69], v[68:69], v[76:77]
    v_pk_add_f32 v[70:71], v[70:71], v[78:79]
    v_cvt_pk_bf16_f32 v56, v64, v65
    v_cvt_pk_bf16_f32 v57, v66, v67
    v_cvt_pk_bf16_f32 v58, v68, v69
    v_cvt_pk_bf16_f32 v59, v70, v71
    buffer_store_dwordx4 v[56:59], v51, s[28:31], s50 offen sc1
    v_lshlrev_b32 v64, 16, v56
    v_and_b32 v65, s43, v56
    v_lshlrev_b32 v66, 16, v57
    v_and_b32 v67, s43, v57
    v_lshlrev_b32 v68, 16, v58
    v_and_b32 v69, s43, v58
    v_lshlrev_b32 v70, 16, v59
    v_and_b32 v71, s43, v59
    v_pk_mul_f32 v[72:73], v[64:65], v[64:65]
    v_pk_add_f32 v[74:75], v[64:65], v[66:67]
    v_pk_fma_f32 v[72:73], v[66:67], v[66:67], v[72:73]
    v_pk_fma_f32 v[72:73], v[68:69], v[68:69], v[72:73]
    v_pk_add_f32 v[74:75], v[74:75], v[68:69]
    v_pk_fma_f32 v[72:73], v[70:71], v[70:71], v[72:73]
    v_pk_add_f32 v[74:75], v[74:75], v[70:71]
    v_add_f32 v20, v74, v75
    v_add_f32 v21, v72, v73
    s_nop 1
    v_add_f32_dpp v20, v20, v20 quad_perm:[1,0,3,2] row_mask:0xf bank_mask:0xf
    v_add_f32_dpp v21, v21, v21 quad_perm:[1,0,3,2] row_mask:0xf bank_mask:0xf
    s_nop 1
    v_add_f32_dpp v20, v20, v20 quad_perm:[2,3,0,1] row_mask:0xf bank_mask:0xf
    v_add_f32_dpp v21, v21, v21 quad_perm:[2,3,0,1] row_mask:0xf bank_mask:0xf
    s_nop 1
    v_add_f32_dpp v20, v20, v20 row_half_mirror row_mask:0xf bank_mask:0xf
    v_add_f32_dpp v21, v21, v21 row_half_mirror row_mask:0xf bank_mask:0xf
    s_nop 1
    v_and_b32 v10, 7, v1
    v_cmp_eq_u32 vcc, 0, v10
    s_and_saveexec_b64 s[78:79], vcc
    buffer_store_dwordx2 v[20:21], v52, s[36:39], s54 offen sc1
    s_mov_b64 exec, s[78:79]
    s_waitcnt vmcnt(0)
    s_add_u32 s92, s68, 0x1a06000
    s_addc_u32 s93, s69, 0
    s_mov_b32 s94, 0x2000
    s_mov_b32 s95, 0x00020000
    s_lshl_b32 s96, s41, 8
    s_lshl_b32 s97, s42, 3
    s_add_u32 s97, s97, s96
    v_mov_b32 v246, s100
    v_mov_b32 v247, s101
    v_mov_b32 v2, 1
    v_mov_b32 v3, s97
    s_waitcnt lgkmcnt(0)
    s_barrier
    s_cmp_lg_u32 s40, 7
    s_cbranch_scc1 .Lpub3
    s_mov_b64 exec, 1
    buffer_store_dwordx2 v[246:247], v3, s[92:95], 0 offen sc1
    s_mov_b64 exec, -1
.Lpub3:
    s_cmp_lt_u32 s40, 4
    s_cbranch_scc1 .Lk5_main
    s_cmp_eq_u32 s42, 7
    s_cbranch_scc1 .Lk5_h7
    s_cmp_ge_u32 s40, 6
    s_cbranch_scc1 .Lk5_cse
    s_add_u32 s8, s68, 0x1b00000
    s_addc_u32 s9, s69, 0
    s_mov_b32 s10, 0x1c000
    s_mov_b32 s11, 0x00020000
    s_sub_u32 s48, s40, 4
    s_lshl_b32 s49, s42, 11
    s_lshl_b32 s50, s48, 10
    s_add_u32 s49, s49, s50
    v_lshlrev_b32 v4, 4, v1
    s_mul_i32 s50, s48, 81920
    s_add_u32 s50, s50, 16384
    v_lshrrev_b32 v5, 5, v1
    v_mul_u32_u24 v5, 40960, v5
    v_and_b32 v6, 31, v1
    v_lshl_add_u32 v5, v6, 3, v5
    v_add_u32 v5, s50, v5
    s_mov_b32 s52, 0
.Lk5_csl:
    s_mov_b32 s51, s49
    buffer_load_dwordx4 v[64:67], v4, s[8:11], s51 offen sc1
    s_add_u32 s51, s51, 14336
    buffer_load_dwordx4 v[68:71], v4, s[8:11], s51 offen sc1
    s_add_u32 s51, s51, 14336
    buffer_load_dwordx4 v[72:75], v4, s[8:11], s51 offen sc1
    s_add_u32 s51, s51, 14336
    buffer_load_dwordx4 v[76:79], v4, s[8:11], s51 offen sc1
    s_add_u32 s51, s51, 14336
    buffer_load_dwordx4 v[80:83], v4, s[8:11], s51 offen sc1
    s_add_u32 s51, s51, 14336
    buffer_load_dwordx4 v[84:87], v4, s[8:11], s51 offen sc1
    s_add_u32 s51, s51, 14336
    buffer_load_dwordx4 v[88:91], v4, s[8:11], s51 offen sc1
    s_add_u32 s51, s51, 14336
    buffer_load_dwordx4 v[92:95], v4, s[8:11], s51 offen sc1
    s_add_u32 s52, s52, 1
    v_mov_b32 v6, 0
    s_waitcnt vmcnt(0)
    v_xor_b32 v65, s100, v65
    v_xor_b32 v67, s100, v67
    v_or3_b32 v6, v6, v65, v67
    v_xor_b32 v69, s100, v69
    v_xor_b32 v71, s100, v71
    v_or3_b32 v6, v6, v69, v71
    v_xor_b32 v73, s100, v73
    v_xor_b32 v75, s100, v75
    v_or3_b32 v6, v6, v73, v75
    v_xor_b32 v77, s100, v77
    v_xor_b32 v79, s100, v79
    v_or3_b32 v6, v6, v77, v79
    v_xor_b32 v81, s100, v81
    v_xor_b32 v83, s100, v83
    v_or3_b32 v6, v6, v81, v83
    v_xor_b32 v85, s100, v85
    v_xor_b32 v87, s100, v87
    v_or3_b32 v6, v6, v85, v87
    v_xor_b32 v89, s100, v89
    v_xor_b32 v91, s100, v91
    v_or3_b32 v6, v6, v89, v91
    v_xor_b32 v93, s100, v93
    v_xor_b32 v95, s100, v95
    v_or3_b32 v6, v6, v93, v95
    v_cmp_ne_u32 vcc, 0, v6
    s_cmp_lt_u32 s52, 0x40000
    s_cbranch_scc0 .Lk5_csd
    s_cbranch_vccnz .Lk5_csl
.Lk5_csd:
    v_add_f32 v64, v64, v68
    v_add_f32 v66, v66, v70
    v_add_f32 v72, v72, v76
    v_add_f32 v74, v74, v78
    v_add_f32 v80, v80, v84
    v_add_f32 v82, v82, v86
    v_add_f32 v88, v88, v92
    v_add_f32 v90, v90, v94
    v_add_f32 v64, v64, v72
    v_add_f32 v66, v66, v74
    v_add_f32 v80, v80, v88
    v_add_f32 v82, v82, v90
    v_add_f32 v64, v64, v80
    v_add_f32 v66, v66, v82
    v_mov_b32 v65, v66
    ds_write_b64 v5, v[64:65]
    s_waitcnt lgkmcnt(0)
.Lk5_cse:
    s_cmp_lg_u32 s40, 7
    s_cbranch_scc1 .Lpl3_done
    v_and_b32 v3, 7, v1
    v_lshlrev_b32 v3, 3, v3
    v_add_u32 v3, s96, v3
    s_mov_b32 s98, 0
    s_mov_b32 s99, 0
.Lpl3_sp:
    s_buffer_load_dwordx16 s[8:23], s[92:95], s96 glc
    s_add_u32 s99, s99, 1
    s_waitcnt lgkmcnt(0)
    s_xor_b64 s[8:9], s[8:9], s[100:101]
    s_xor_b64 s[10:11], s[10:11], s[100:101]
    s_xor_b64 s[12:13], s[12:13], s[100:101]
    s_xor_b64 s[14:15], s[14:15], s[100:101]
    s_xor_b64 s[16:17], s[16:17], s[100:101]
    s_xor_b64 s[18:19], s[18:19], s[100:101]
    s_xor_b64 s[20:21], s[20:21], s[100:101]
    s_xor_b64 s[22:23], s[22:23], s[100:101]
    s_or_b64 s[8:9], s[8:9], s[10:11]
    s_or_b64 s[8:9], s[8:9], s[12:13]
    s_or_b64 s[8:9], s[8:9], s[14:15]
    s_or_b64 s[8:9], s[8:9], s[16:17]
    s_or_b64 s[8:9], s[8:9], s[18:19]
    s_or_b64 s[8:9], s[8:9], s[20:21]
    s_or_b64 s[8:9], s[8:9], s[22:23]
    s_cbranch_scc0 .Lpl3_sd
    s_and_b32 s98, s99, 3
    s_cbranch_scc1 .Lpl3_sp
    buffer_load_dwordx2 v[248:249], v3, s[92:95], 0 offen sc1
    s_waitcnt vmcnt(0)
    v_xor_b32 v248, s100, v248
    v_xor_b32 v249, s101, v249
    v_or_b32 v248, v248, v249
    v_cmp_ne_u32 vcc, 0, v248
    s_cmp_lt_u32 s99, 0x80000
    s_cbranch_scc0 .Lpl3_sd
    s_cbranch_vccnz .Lpl3_sp
.Lpl3_sd:
.Lpl3_done:
    s_barrier
    s_barrier
    s_mov_b32 s32, s90
    s_mov_b32 s33, s91
    s_mov_b32 s34, 0x1c0000
    s_mov_b32 s35, 0x00020000
    v_lshrrev_b32 v2, 3, v1
    v_and_b32 v3, 7, v1
    v_lshlrev_b32 v6, 1, v2
    v_and_b32 v6, 4, v6
    v_xor_b32 v3, v3, v6
    v_lshlrev_b32 v3, 4, v3
    s_movk_i32 s58, 1024
    v_mul_lo_u32 v2, v2, s58
    v_add_u32 v6, v2, v3
    s_sub_u32 s48, s40, 4
    s_mul_i32 s58, s48, 458752
    s_lshl_b32 s59, s42, 7
    s_add_u32 s58, s58, s59
    s_add_u32 s58, s58, 180224
    s_mul_i32 s44, s48, 40960
    s_sub_u32 s58, s58, 8192
    v_and_b32 v37, 3, v1
    v_mul_u32_u24 v37, 40960, v37
    s_sleep 60
.Lk5_tgh:
    s_sleep 2
    ds_read_b64 v[38:39], v37 offset:17408
    s_waitcnt lgkmcnt(0)
    v_xor_b32 v38, s100, v38
    v_xor_b32 v39, s101, v39
    v_or_b32 v38, v38, v39
    v_cmp_ne_u32 vcc, 0, v38
    s_nop 0
    s_cbranch_vccnz .Lk5_tgh
    s_add_u32 m0, s44, 0
    s_add_u32 s58, s58, 8192
    buffer_load_dwordx4 v6, s[32:35], s58 offen lds
    s_add_u32 m0, s44, 1024
    s_add_u32 s58, s58, 8192
    buffer_load_dwordx4 v6, s[32:35], s58 offen lds
    s_add_u32 m0, s44, 2048
    s_add_u32 s58, s58, 8192
    buffer_load_dwordx4 v6, s[32:35], s58 offen lds
    s_add_u32 m0, s44, 3072
    s_add_u32 s58, s58, 8192
    buffer_load_dwordx4 v6, s[32:35], s58 offen lds
    s_add_u32 m0, s44, 4096
    s_add_u32 s58, s58, 8192
    buffer_load_dwordx4 v6, s[32:35], s58 offen lds
    s_add_u32 m0, s44, 5120
    s_add_u32 s58, s58, 8192
    buffer_load_dwordx4 v6, s[32:35], s58 offen lds
    s_add_u32 m0, s44, 6144
    s_add_u32 s58, s58, 8192
    buffer_load_dwordx4 v6, s[32:35], s58 offen lds
    s_add_u32 m0, s44, 7168
    s_add_u32 s58, s58, 8192
    buffer_load_dwordx4 v6, s[32:35], s58 offen lds
    s_add_u32 m0, s44, 8192
    s_add_u32 s58, s58, 8192
    buffer_load_dwordx4 v6, s[32:35], s58 offen lds
    s_add_u32 m0, s44, 9216
    s_add_u32 s58, s58, 8192
    buffer_load_dwordx4 v6, s[32:35], s58 offen lds
    s_add_u32 m0, s44, 10240
    s_add_u32 s58, s58, 8192
    buffer_load_dwordx4 v6, s[32:35], s58 offen lds
    s_add_u32 m0, s44, 11264
    s_add_u32 s58, s58, 8192
    buffer_load_dwordx4 v6, s[32:35], s58 offen lds
    s_add_u32 m0, s44, 12288
    s_add_u32 s58, s58, 8192
    buffer_load_dwordx4 v6, s[32:35], s58 offen lds
    s_add_u32 m0, s44, 13312
    s_add_u32 s58, s58, 8192
    buffer_load_dwordx4 v6, s[32:35], s58 offen lds
    s_add_u32 m0, s44, 14336
    s_add_u32 s58, s58, 8192
    buffer_load_dwordx4 v6, s[32:35], s58 offen lds
    s_add_u32 m0, s44, 15360
    s_add_u32 s58, s58, 8192
    buffer_load_dwordx4 v6, s[32:35], s58 offen lds
    s_mul_i32 s44, s40, 40960
.Lk5_h7:
    s_branch .Lk5_end
.Lk5_main:
    s_cmp_eq_u32 s42, 7
    s_cbranch_scc1 .Lk5_pf
    s_add_u32 s8, s68, 0x600000
    s_addc_u32 s9, s69, 0
    s_mov_b32 s10, 0x200000
    s_mov_b32 s11, 0x00020000
    s_add_u32 s24, s68, 0x1900000
    s_addc_u32 s25, s69, 0
    s_mov_b32 s26, 0x40000
    s_mov_b32 s27, 0x00020000
    s_add_u32 s20, s68, 0xa00000
    s_addc_u32 s21, s69, 0
    s_mov_b32 s22, 0x700000
    s_mov_b32 s23, 0x00020000
    v_lshlrev_b32 v4, 4, v1
    s_lshl_b32 s48, s41, 16
    s_lshl_b32 s49, s40, 14
    s_add_u32 s48, s48, s49
    s_lshl_b32 s54, s42, 9
    s_lshl_b32 s50, s40, 7
    s_add_u32 s54, s54, s50
    v_lshrrev_b32 v5, 5, v1
    v_bfe_u32 v7, v1, 4, 1
    v_bfe_u32 v8, v1, 2, 2
    v_and_b32 v9, 1, v1
    v_bfe_u32 v10, v1, 1, 1
    v_lshl_or_b32 v9, v9, 1, v10
    v_lshlrev_b32 v9, 3, v9
    v_lshl_add_u32 v9, v7, 5, v9
    v_lshl_add_u32 v10, v5, 3, v8
    v_lshrrev_b32 v11, 1, v8
    v_xor_b32 v12, 0, v11
    v_lshl_add_u32 v12, v12, 6, v9
    v_lshl_add_u32 v12, v10, 7, v12
    v_add_u32 v24, s44, v12
    v_xor_b32 v12, 1, v11
    v_lshl_add_u32 v12, v12, 6, v9
    v_lshl_add_u32 v12, v10, 7, v12
    v_add_u32 v25, s44, v12
    v_and_b32 v13, 31, v1
    v_lshrrev_b32 v7, 4, v13
    v_mul_u32_u24 v7, 40, v7
    v_and_b32 v8, 15, v13
    v_add_u32 v7, v7, v8
    v_or_b32 v8, 0, v5
    v_xor_b32 v8, v8, v13
    v_and_b32 v8, 15, v8
    v_lshlrev_b32 v8, 4, v8
    v_lshl_add_u32 v16, v7, 10, v8
    v_add_u32 v28, 81920, v16
    v_or_b32 v8, 2, v5
    v_xor_b32 v8, v8, v13
    v_and_b32 v8, 15, v8
    v_lshlrev_b32 v8, 4, v8
    v_lshl_add_u32 v17, v7, 10, v8
    v_add_u32 v29, 81920, v17
    v_or_b32 v8, 4, v5
    v_xor_b32 v8, v8, v13
    v_and_b32 v8, 15, v8
    v_lshlrev_b32 v8, 4, v8
    v_lshl_add_u32 v18, v7, 10, v8
    v_add_u32 v30, 81920, v18
    v_or_b32 v8, 6, v5
    v_xor_b32 v8, v8, v13
    v_and_b32 v8, 15, v8
    v_lshlrev_b32 v8, 4, v8
    v_lshl_add_u32 v19, v7, 10, v8
    v_add_u32 v31, 81920, v19
    v_or_b32 v8, 8, v5
    v_xor_b32 v8, v8, v13
    v_and_b32 v8, 15, v8
    v_lshlrev_b32 v8, 4, v8
    v_lshl_add_u32 v20, v7, 10, v8
    v_add_u32 v32, 81920, v20
    v_or_b32 v8, 10, v5
    v_xor_b32 v8, v8, v13
    v_and_b32 v8, 15, v8
    v_lshlrev_b32 v8, 4, v8
    v_lshl_add_u32 v21, v7, 10, v8
    v_add_u32 v33, 81920, v21
    v_or_b32 v8, 12, v5
    v_xor_b32 v8, v8, v13
    v_and_b32 v8, 15, v8
    v_lshlrev_b32 v8, 4, v8
    v_lshl_add_u32 v22, v7, 10, v8
    v_add_u32 v34, 81920, v22
    v_or_b32 v8, 14, v5
    v_xor_b32 v8, v8, v13
    v_and_b32 v8, 15, v8
    v_lshlrev_b32 v8, 4, v8
    v_lshl_add_u32 v23, v7, 10, v8
    v_add_u32 v35, 81920, v23
    v_lshlrev_b32 v42, 5, v5
    s_add_u32 s51, s44, 16384
    v_add_u32 v42, s51, v42
    v_and_b32 v7, 7, v13
    s_add_u32 s51, s44, 18432
    v_or_b32 v14, 0, v5
    v_xor_b32 v14, v14, v7
    v_lshlrev_b32 v14, 4, v14
    v_lshl_add_u32 v14, v13, 7, v14
    v_add_u32 v36, s51, v14
    v_or_b32 v14, 2, v5
    v_xor_b32 v14, v14, v7
    v_lshlrev_b32 v14, 4, v14
    v_lshl_add_u32 v14, v13, 7, v14
    v_add_u32 v37, s51, v14
    v_or_b32 v14, 4, v5
    v_xor_b32 v14, v14, v7
    v_lshlrev_b32 v14, 4, v14
    v_lshl_add_u32 v14, v13, 7, v14
    v_add_u32 v38, s51, v14
    v_or_b32 v14, 6, v5
    v_xor_b32 v14, v14, v7
    v_lshlrev_b32 v14, 4, v14
    v_lshl_add_u32 v14, v13, 7, v14
    v_add_u32 v39, s51, v14
    v_lshrrev_b32 v7, 3, v1
    v_and_b32 v14, 7, v1
    v_xor_b32 v40, v14, v7
    v_lshlrev_b32 v40, 4, v40
    v_lshl_add_u32 v40, v7, 7, v40
    v_add_u32 v40, s51, v40
    s_movk_i32 s50, 3584
    v_mul_lo_u32 v7, v7, s50
    v_lshl_add_u32 v41, v14, 4, v7
    s_mul_i32 s52, s41, 229376
    s_lshl_b32 s53, s54, 6
    s_add_u32 s52, s52, s53
    s_add_u32 s53, s52, 4096
    v_lshlrev_b32 v7, 3, v13
    v_lshl_add_u32 v7, v5, 16, v7
    s_lshl_b32 s55, s41, 9
    s_barrier
    v_xor_b32 v8, 0, v4
    s_add_u32 m0, s44, 0
    s_add_u32 s50, s48, 0
    buffer_load_dwordx4 v8, s[8:11], s50 offen lds
    v_xor_b32 v9, 16, v4
    s_add_u32 m0, s44, 1024
    s_add_u32 s50, s48, 1024
    buffer_load_dwordx4 v9, s[8:11], s50 offen lds
    v_xor_b32 v8, 32, v4
    s_add_u32 m0, s44, 2048
    s_add_u32 s50, s48, 2048
    buffer_load_dwordx4 v8, s[8:11], s50 offen lds
    v_xor_b32 v9, 48, v4
    s_add_u32 m0, s44, 3072
    s_add_u32 s50, s48, 3072
    buffer_load_dwordx4 v9, s[8:11], s50 offen lds
    v_xor_b32 v8, 64, v4
    s_add_u32 m0, s44, 4096
    s_add_u32 s50, s48, 4096
    buffer_load_dwordx4 v8, s[8:11], s50 offen lds
    v_xor_b32 v9, 80, v4
    s_add_u32 m0, s44, 5120
    s_add_u32 s50, s48, 5120
    buffer_load_dwordx4 v9, s[8:11], s50 offen lds
    v_xor_b32 v8, 96, v4
    s_add_u32 m0, s44, 6144
    s_add_u32 s50, s48, 6144
    buffer_load_dwordx4 v8, s[8:11], s50 offen lds
    v_xor_b32 v9, 112, v4
    s_add_u32 m0, s44, 7168
    s_add_u32 s50, s48, 7168
    buffer_load_dwordx4 v9, s[8:11], s50 offen lds
    v_xor_b32 v8, 128, v4
    s_add_u32 m0, s44, 8192
    s_add_u32 s50, s48, 8192
    buffer_load_dwordx4 v8, s[8:11], s50 offen lds
    v_xor_b32 v9, 144, v4
    s_add_u32 m0, s44, 9216
    s_add_u32 s50, s48, 9216
    buffer_load_dwordx4 v9, s[8:11], s50 offen lds
    v_xor_b32 v8, 160, v4
    s_add_u32 m0, s44, 10240
    s_add_u32 s50, s48, 10240
    buffer_load_dwordx4 v8, s[8:11], s50 offen lds
    v_xor_b32 v9, 176, v4
    s_add_u32 m0, s44, 11264
    s_add_u32 s50, s48, 11264
    buffer_load_dwordx4 v9, s[8:11], s50 offen lds
    v_xor_b32 v8, 192, v4
    s_add_u32 m0, s44, 12288
    s_add_u32 s50, s48, 12288
    buffer_load_dwordx4 v8, s[8:11], s50 offen lds
    v_xor_b32 v9, 208, v4
    s_add_u32 m0, s44, 13312
    s_add_u32 s50, s48, 13312
    buffer_load_dwordx4 v9, s[8:11], s50 offen lds
    v_xor_b32 v8, 224, v4
    s_add_u32 m0, s44, 14336
    s_add_u32 s50, s48, 14336
    buffer_load_dwordx4 v8, s[8:11], s50 offen lds
    v_xor_b32 v9, 240, v4
    s_add_u32 m0, s44, 15360
    s_add_u32 s50, s48, 15360
    buffer_load_dwordx4 v9, s[8:11], s50 offen lds
    s_add_u32 s51, s55, 0
    buffer_load_dwordx2 v[192:193], v7, s[24:27], s51 offen offset:0
    buffer_load_dwordx2 v[208:209], v7, s[24:27], s51 offen offset:256
    s_add_u32 s51, s55, 16384
    buffer_load_dwordx2 v[194:195], v7, s[24:27], s51 offen offset:0
    buffer_load_dwordx2 v[210:211], v7, s[24:27], s51 offen offset:256
    s_add_u32 s51, s55, 32768
    buffer_load_dwordx2 v[196:197], v7, s[24:27], s51 offen offset:0
    buffer_load_dwordx2 v[212:213], v7, s[24:27], s51 offen offset:256
    s_add_u32 s51, s55, 49152
    buffer_load_dwordx2 v[198:199], v7, s[24:27], s51 offen offset:0
    buffer_load_dwordx2 v[214:215], v7, s[24:27], s51 offen offset:256
    ds_read_b128 v[224:227], v42 offset:0
    ds_read_b128 v[228:231], v42 offset:16
    ds_read_b128 v[232:235], v42 offset:64
    ds_read_b128 v[236:239], v42 offset:80
    ds_read_b128 v[240:243], v42 offset:128
    ds_read_b128 v[244:247], v42 offset:144
    ds_read_b128 v[248:251], v42 offset:192
    ds_read_b128 v[252:255], v42 offset:208
    s_waitcnt vmcnt(8)
    s_waitcnt lgkmcnt(0)
    s_barrier
    ds_read_b64_tr_b16 v[128:129], v24 offset:18432
    ds_read_b64_tr_b16 v[130:131], v24 offset:18944
    ds_read_b64_tr_b16 v[132:133], v25 offset:18432
    ds_read_b64_tr_b16 v[134:135], v25 offset:18944
    ds_read_b128 v[136:139], v16 offset:0
    ds_read_b128 v[140:143], v28 offset:0
    ds_read_b64_tr_b16 v[144:145], v24 offset:20480
    ds_read_b64_tr_b16 v[146:147], v24 offset:20992
    ds_read_b64_tr_b16 v[148:149], v25 offset:20480
    ds_read_b64_tr_b16 v[150:151], v25 offset:20992
    ds_read_b128 v[152:155], v17 offset:0
    ds_read_b128 v[156:159], v29 offset:0
    s_waitcnt lgkmcnt(6)
    v_mfma_f32_32x32x16_bf16 v[64:79], v[128:131], v[136:139], 0
    ds_read_b64_tr_b16 v[160:161], v24 offset:22528
    ds_read_b64_tr_b16 v[162:163], v24 offset:23040
    ds_read_b64_tr_b16 v[164:165], v25 offset:22528
    v_mfma_f32_32x32x16_bf16 v[80:95], v[128:131], v[140:143], 0
    ds_read_b64_tr_b16 v[166:167], v25 offset:23040
    ds_read_b128 v[168:171], v18 offset:0
    ds_read_b128 v[172:175], v30 offset:0
    v_mfma_f32_32x32x16_bf16 v[96:111], v[132:135], v[136:139], 0
    s_add_u32 m0, s44, 18432
    s_add_u32 s58, s58, 28672
    buffer_load_dwordx4 v6, s[32:35], s58 offen lds
    v_mfma_f32_32x32x16_bf16 v[112:127], v[132:135], v[140:143], 0
    s_add_u32 m0, s44, 19456
    s_add_u32 s58, s58, 28672
    buffer_load_dwordx4 v6, s[32:35], s58 offen lds
    s_waitcnt lgkmcnt(6)
    v_mfma_f32_32x32x16_bf16 v[64:79], v[144:147], v[152:155], v[64:79]
    ds_read_b64_tr_b16 v[128:129], v24 offset:24576
    ds_read_b64_tr_b16 v[130:131], v24 offset:25088
    ds_read_b64_tr_b16 v[132:133], v25 offset:24576
    v_mfma_f32_32x32x16_bf16 v[80:95], v[144:147], v[156:159], v[80:95]
    ds_read_b64_tr_b16 v[134:135], v25 offset:25088
    ds_read_b128 v[136:139], v19 offset:0
    ds_read_b128 v[140:143], v31 offset:0
    v_mfma_f32_32x32x16_bf16 v[96:111], v[148:151], v[152:155], v[96:111]
    s_add_u32 m0, s44, 20480
    s_add_u32 s58, s58, 28672
    buffer_load_dwordx4 v6, s[32:35], s58 offen lds
    v_mfma_f32_32x32x16_bf16 v[112:127], v[148:151], v[156:159], v[112:127]
    s_add_u32 m0, s44, 21504
    s_add_u32 s58, s58, 28672
    buffer_load_dwordx4 v6, s[32:35], s58 offen lds
    s_waitcnt lgkmcnt(6)
    v_mfma_f32_32x32x16_bf16 v[64:79], v[160:163], v[168:171], v[64:79]
    ds_read_b64_tr_b16 v[144:145], v24 offset:26624
    ds_read_b64_tr_b16 v[146:147], v24 offset:27136
    ds_read_b64_tr_b16 v[148:149], v25 offset:26624
    v_mfma_f32_32x32x16_bf16 v[80:95], v[160:163], v[172:175], v[80:95]
    ds_read_b64_tr_b16 v[150:151], v25 offset:27136
    ds_read_b128 v[152:155], v20 offset:0
    ds_read_b128 v[156:159], v32 offset:0
    v_mfma_f32_32x32x16_bf16 v[96:111], v[164:167], v[168:171], v[96:111]
    s_add_u32 m0, s44, 22528
    s_add_u32 s58, s58, 28672
    buffer_load_dwordx4 v6, s[32:35], s58 offen lds
    v_mfma_f32_32x32x16_bf16 v[112:127], v[164:167], v[172:175], v[112:127]
    s_add_u32 m0, s44, 23552
    s_add_u32 s58, s58, 28672
    buffer_load_dwordx4 v6, s[32:35], s58 offen lds
    s_waitcnt lgkmcnt(6)
    v_mfma_f32_32x32x16_bf16 v[64:79], v[128:131], v[136:139], v[64:79]
    ds_read_b64_tr_b16 v[160:161], v24 offset:28672
    ds_read_b64_tr_b16 v[162:163], v24 offset:29184
    ds_read_b64_tr_b16 v[164:165], v25 offset:28672
    v_mfma_f32_32x32x16_bf16 v[80:95], v[128:131], v[140:143], v[80:95]
    ds_read_b64_tr_b16 v[166:167], v25 offset:29184
    ds_read_b128 v[168:171], v21 offset:0
    ds_read_b128 v[172:175], v33 offset:0
    v_mfma_f32_32x32x16_bf16 v[96:111], v[132:135], v[136:139], v[96:111]
    s_add_u32 m0, s44, 24576
    s_add_u32 s58, s58, 28672
    buffer_load_dwordx4 v6, s[32:35], s58 offen lds
    v_mfma_f32_32x32x16_bf16 v[112:127], v[132:135], v[140:143], v[112:127]
    s_add_u32 m0, s44, 25600
    s_add_u32 s58, s58, 28672
    buffer_load_dwordx4 v6, s[32:35], s58 offen lds
    s_waitcnt lgkmcnt(6)
    v_mfma_f32_32x32x16_bf16 v[64:79], v[144:147], v[152:155], v[64:79]
    ds_read_b64_tr_b16 v[128:129], v24 offset:30720
    ds_read_b64_tr_b16 v[130:131], v24 offset:31232
    ds_read_b64_tr_b16 v[132:133], v25 offset:30720
    v_mfma_f32_32x32x16_bf16 v[80:95], v[144:147], v[156:159], v[80:95]
    ds_read_b64_tr_b16 v[134:135], v25 offset:31232
    ds_read_b128 v[136:139], v22 offset:0
    ds_read_b128 v[140:143], v34 offset:0
    v_mfma_f32_32x32x16_bf16 v[96:111], v[148:151], v[152:155], v[96:111]
    s_add_u32 m0, s44, 26624
    s_add_u32 s58, s58, 28672
    buffer_load_dwordx4 v6, s[32:35], s58 offen lds
    v_mfma_f32_32x32x16_bf16 v[112:127], v[148:151], v[156:159], v[112:127]
    s_add_u32 m0, s44, 27648
    s_add_u32 s58, s58, 28672
    buffer_load_dwordx4 v6, s[32:35], s58 offen lds
    s_waitcnt lgkmcnt(6)
    v_mfma_f32_32x32x16_bf16 v[64:79], v[160:163], v[168:171], v[64:79]
    ds_read_b64_tr_b16 v[144:145], v24 offset:32768
    ds_read_b64_tr_b16 v[146:147], v24 offset:33280
    ds_read_b64_tr_b16 v[148:149], v25 offset:32768
    v_mfma_f32_32x32x16_bf16 v[80:95], v[160:163], v[172:175], v[80:95]
    ds_read_b64_tr_b16 v[150:151], v25 offset:33280
    ds_read_b128 v[152:155], v23 offset:0
    ds_read_b128 v[156:159], v35 offset:0
    v_mfma_f32_32x32x16_bf16 v[96:111], v[164:167], v[168:171], v[96:111]
    s_add_u32 m0, s44, 28672
    s_add_u32 s58, s58, 28672
    buffer_load_dwordx4 v6, s[32:35], s58 offen lds
    v_mfma_f32_32x32x16_bf16 v[112:127], v[164:167], v[172:175], v[112:127]
    s_add_u32 m0, s44, 29696
    s_add_u32 s58, s58, 28672
    buffer_load_dwordx4 v6, s[32:35], s58 offen lds
    s_waitcnt lgkmcnt(6)
    v_mfma_f32_32x32x16_bf16 v[64:79], v[128:131], v[136:139], v[64:79]
    ds_read_b64_tr_b16 v[160:161], v24 offset:34816
    ds_read_b64_tr_b16 v[162:163], v24 offset:35328
    ds_read_b64_tr_b16 v[164:165], v25 offset:34816
    v_mfma_f32_32x32x16_bf16 v[80:95], v[128:131], v[140:143], v[80:95]
    ds_read_b64_tr_b16 v[166:167], v25 offset:35328
    ds_read_b128 v[168:171], v16 offset:256
    ds_read_b128 v[172:175], v28 offset:256
    v_mfma_f32_32x32x16_bf16 v[96:111], v[132:135], v[136:139], v[96:111]
    s_add_u32 m0, s44, 30720
    s_add_u32 s58, s58, 28672
    buffer_load_dwordx4 v6, s[32:35], s58 offen lds
    v_mfma_f32_32x32x16_bf16 v[112:127], v[132:135], v[140:143], v[112:127]
    s_add_u32 m0, s44, 31744
    s_add_u32 s58, s58, 28672
    buffer_load_dwordx4 v6, s[32:35], s58 offen lds
    s_waitcnt lgkmcnt(6)
    v_mfma_f32_32x32x16_bf16 v[64:79], v[144:147], v[152:155], v[64:79]
    ds_read_b64_tr_b16 v[128:129], v24 offset:36864
    ds_read_b64_tr_b16 v[130:131], v24 offset:37376
    ds_read_b64_tr_b16 v[132:133], v25 offset:36864
    v_mfma_f32_32x32x16_bf16 v[80:95], v[144:147], v[156:159], v[80:95]
    ds_read_b64_tr_b16 v[134:135], v25 offset:37376
    ds_read_b128 v[136:139], v17 offset:256
    ds_read_b128 v[140:143], v29 offset:256
    v_mfma_f32_32x32x16_bf16 v[96:111], v[148:151], v[152:155], v[96:111]
    s_add_u32 m0, s44, 32768
    s_add_u32 s58, s58, 28672
    buffer_load_dwordx4 v6, s[32:35], s58 offen lds
    v_mfma_f32_32x32x16_bf16 v[112:127], v[148:151], v[156:159], v[112:127]
    s_add_u32 m0, s44, 33792
    s_add_u32 s58, s58, 28672
    buffer_load_dwordx4 v6, s[32:35], s58 offen lds
    s_waitcnt lgkmcnt(6)
    v_mfma_f32_32x32x16_bf16 v[64:79], v[160:163], v[168:171], v[64:79]
    ds_read_b64_tr_b16 v[144:145], v24 offset:38912
    ds_read_b64_tr_b16 v[146:147], v24 offset:39424
    ds_read_b64_tr_b16 v[148:149], v25 offset:38912
    v_mfma_f32_32x32x16_bf16 v[80:95], v[160:163], v[172:175], v[80:95]
    ds_read_b64_tr_b16 v[150:151], v25 offset:39424
    ds_read_b128 v[152:155], v18 offset:256
    ds_read_b128 v[156:159], v30 offset:256
    v_mfma_f32_32x32x16_bf16 v[96:111], v[164:167], v[168:171], v[96:111]
    s_add_u32 m0, s44, 34816
    s_add_u32 s58, s58, 28672
    buffer_load_dwordx4 v6, s[32:35], s58 offen lds
    v_mfma_f32_32x32x16_bf16 v[112:127], v[164:167], v[172:175], v[112:127]
    s_add_u32 m0, s44, 35840
    s_add_u32 s58, s58, 28672
    buffer_load_dwordx4 v6, s[32:35], s58 offen lds
    s_waitcnt lgkmcnt(6)
    v_mfma_f32_32x32x16_bf16 v[64:79], v[128:131], v[136:139], v[64:79]
    s_waitcnt vmcnt(16)
    ds_read_b64_tr_b16 v[160:161], v24 offset:18432
    ds_read_b64_tr_b16 v[162:163], v24 offset:18944
    ds_read_b64_tr_b16 v[164:165], v25 offset:18432
    v_mfma_f32_32x32x16_bf16 v[80:95], v[128:131], v[140:143], v[80:95]
    ds_read_b64_tr_b16 v[166:167], v25 offset:18944
    ds_read_b128 v[168:171], v19 offset:256
    ds_read_b128 v[172:175], v31 offset:256
    v_mfma_f32_32x32x16_bf16 v[96:111], v[132:135], v[136:139], v[96:111]
    s_add_u32 m0, s44, 36864
    s_add_u32 s58, s58, 28672
    buffer_load_dwordx4 v6, s[32:35], s58 offen lds
    v_mfma_f32_32x32x16_bf16 v[112:127], v[132:135], v[140:143], v[112:127]
    s_add_u32 m0, s44, 37888
    s_add_u32 s58, s58, 28672
    buffer_load_dwordx4 v6, s[32:35], s58 offen lds
    s_waitcnt lgkmcnt(6)
    v_mfma_f32_32x32x16_bf16 v[64:79], v[144:147], v[152:155], v[64:79]
    s_waitcnt vmcnt(16)
    ds_read_b64_tr_b16 v[128:129], v24 offset:20480
    ds_read_b64_tr_b16 v[130:131], v24 offset:20992
    ds_read_b64_tr_b16 v[132:133], v25 offset:20480
    v_mfma_f32_32x32x16_bf16 v[80:95], v[144:147], v[156:159], v[80:95]
    ds_read_b64_tr_b16 v[134:135], v25 offset:20992
    ds_read_b128 v[136:139], v20 offset:256
    ds_read_b128 v[140:143], v32 offset:256
    v_mfma_f32_32x32x16_bf16 v[96:111], v[148:151], v[152:155], v[96:111]
    s_add_u32 m0, s44, 38912
    s_add_u32 s58, s58, 28672
    buffer_load_dwordx4 v6, s[32:35], s58 offen lds
    v_mfma_f32_32x32x16_bf16 v[112:127], v[148:151], v[156:159], v[112:127]
    s_add_u32 m0, s44, 39936
    s_add_u32 s58, s58, 28672
    buffer_load_dwordx4 v6, s[32:35], s58 offen lds
    s_waitcnt lgkmcnt(6)
    v_mfma_f32_32x32x16_bf16 v[64:79], v[160:163], v[168:171], v[64:79]
    s_waitcnt vmcnt(16)
    ds_read_b64_tr_b16 v[144:145], v24 offset:22528
    ds_read_b64_tr_b16 v[146:147], v24 offset:23040
    ds_read_b64_tr_b16 v[148:149], v25 offset:22528
    v_mfma_f32_32x32x16_bf16 v[80:95], v[160:163], v[172:175], v[80:95]
    ds_read_b64_tr_b16 v[150:151], v25 offset:23040
    ds_read_b128 v[152:155], v21 offset:256
    ds_read_b128 v[156:159], v33 offset:256
    v_mfma_f32_32x32x16_bf16 v[96:111], v[164:167], v[168:171], v[96:111]
    s_add_u32 m0, s44, 18432
    s_add_u32 s58, s58, 28672
    buffer_load_dwordx4 v6, s[32:35], s58 offen lds
    v_mfma_f32_32x32x16_bf16 v[112:127], v[164:167], v[172:175], v[112:127]
    s_add_u32 m0, s44, 19456
    s_add_u32 s58, s58, 28672
    buffer_load_dwordx4 v6, s[32:35], s58 offen lds
    s_waitcnt lgkmcnt(6)
    v_mfma_f32_32x32x16_bf16 v[64:79], v[128:131], v[136:139], v[64:79]
    s_waitcnt vmcnt(16)
    ds_read_b64_tr_b16 v[160:161], v24 offset:24576
    ds_read_b64_tr_b16 v[162:163], v24 offset:25088
    ds_read_b64_tr_b16 v[164:165], v25 offset:24576
    v_mfma_f32_32x32x16_bf16 v[80:95], v[128:131], v[140:143], v[80:95]
    ds_read_b64_tr_b16 v[166:167], v25 offset:25088
    ds_read_b128 v[168:171], v22 offset:256
    ds_read_b128 v[172:175], v34 offset:256
    v_mfma_f32_32x32x16_bf16 v[96:111], v[132:135], v[136:139], v[96:111]
    s_add_u32 m0, s44, 20480
    s_add_u32 s58, s58, 28672
    buffer_load_dwordx4 v6, s[32:35], s58 offen lds
    v_mfma_f32_32x32x16_bf16 v[112:127], v[132:135], v[140:143], v[112:127]
    s_add_u32 m0, s44, 21504
    s_add_u32 s58, s58, 28672
    buffer_load_dwordx4 v6, s[32:35], s58 offen lds
    s_waitcnt lgkmcnt(6)
    v_mfma_f32_32x32x16_bf16 v[64:79], v[144:147], v[152:155], v[64:79]
    s_waitcnt vmcnt(16)
    ds_read_b64_tr_b16 v[128:129], v24 offset:26624
    ds_read_b64_tr_b16 v[130:131], v24 offset:27136
    ds_read_b64_tr_b16 v[132:133], v25 offset:26624
    v_mfma_f32_32x32x16_bf16 v[80:95], v[144:147], v[156:159], v[80:95]
    ds_read_b64_tr_b16 v[134:135], v25 offset:27136
    ds_read_b128 v[136:139], v23 offset:256
    ds_read_b128 v[140:143], v35 offset:256
    v_mfma_f32_32x32x16_bf16 v[96:111], v[148:151], v[152:155], v[96:111]
    s_add_u32 m0, s44, 22528
    s_add_u32 s58, s58, 28672
    buffer_load_dwordx4 v6, s[32:35], s58 offen lds
    v_mfma_f32_32x32x16_bf16 v[112:127], v[148:151], v[156:159], v[112:127]
    s_add_u32 m0, s44, 23552
    s_add_u32 s58, s58, 28672
    buffer_load_dwordx4 v6, s[32:35], s58 offen lds
    s_waitcnt lgkmcnt(6)
    v_mfma_f32_32x32x16_bf16 v[64:79], v[160:163], v[168:171], v[64:79]
    s_waitcnt vmcnt(16)
    ds_read_b64_tr_b16 v[144:145], v24 offset:28672
    ds_read_b64_tr_b16 v[146:147], v24 offset:29184
    ds_read_b64_tr_b16 v[148:149], v25 offset:28672
    v_mfma_f32_32x32x16_bf16 v[80:95], v[160:163], v[172:175], v[80:95]
    ds_read_b64_tr_b16 v[150:151], v25 offset:29184
    ds_read_b128 v[152:155], v16 offset:512
    ds_read_b128 v[156:159], v28 offset:512
    s_add_u32 m0, s44, 24576
    s_add_u32 s58, s58, 28672
    buffer_load_dwordx4 v6, s[32:35], s58 offen lds
    v_mfma_f32_32x32x16_bf16 v[96:111], v[164:167], v[168:171], v[96:111]
    s_add_u32 m0, s44, 25600
    s_add_u32 s58, s58, 28672
    buffer_load_dwordx4 v6, s[32:35], s58 offen lds
    v_mfma_f32_32x32x16_bf16 v[112:127], v[164:167], v[172:175], v[112:127]
    v_add_f32 v192, v192, v194
    v_add_f32 v208, v208, v210
    v_add_f32 v193, v193, v195
    s_waitcnt lgkmcnt(6)
    v_mfma_f32_32x32x16_bf16 v[64:79], v[128:131], v[136:139], v[64:79]
    s_waitcnt vmcnt(16)
    ds_read_b64_tr_b16 v[160:161], v24 offset:30720
    ds_read_b64_tr_b16 v[162:163], v24 offset:31232
    ds_read_b64_tr_b16 v[164:165], v25 offset:30720
    ds_read_b64_tr_b16 v[166:167], v25 offset:31232
    v_mfma_f32_32x32x16_bf16 v[80:95], v[128:131], v[140:143], v[80:95]
    ds_read_b128 v[168:171], v17 offset:512
    ds_read_b128 v[172:175], v29 offset:512
    s_add_u32 m0, s44, 26624
    s_add_u32 s58, s58, 28672
    buffer_load_dwordx4 v6, s[32:35], s58 offen lds
    v_mfma_f32_32x32x16_bf16 v[96:111], v[132:135], v[136:139], v[96:111]
    s_add_u32 m0, s44, 27648
    s_add_u32 s58, s58, 28672
    buffer_load_dwordx4 v6, s[32:35], s58 offen lds
    v_mfma_f32_32x32x16_bf16 v[112:127], v[132:135], v[140:143], v[112:127]
    v_add_f32 v209, v209, v211
    v_add_f32 v196, v196, v198
    v_add_f32 v212, v212, v214
    v_add_f32 v197, v197, v199
    s_waitcnt lgkmcnt(6)
    v_mfma_f32_32x32x16_bf16 v[64:79], v[144:147], v[152:155], v[64:79]
    s_waitcnt vmcnt(16)
    ds_read_b64_tr_b16 v[128:129], v24 offset:32768
    ds_read_b64_tr_b16 v[130:131], v24 offset:33280
    ds_read_b64_tr_b16 v[132:133], v25 offset:32768
    ds_read_b64_tr_b16 v[134:135], v25 offset:33280
    v_mfma_f32_32x32x16_bf16 v[80:95], v[144:147], v[156:159], v[80:95]
    ds_read_b128 v[136:139], v18 offset:512
    ds_read_b128 v[140:143], v30 offset:512
    s_add_u32 m0, s44, 28672
    s_add_u32 s58, s58, 28672
    buffer_load_dwordx4 v6, s[32:35], s58 offen lds
    v_mfma_f32_32x32x16_bf16 v[96:111], v[148:151], v[152:155], v[96:111]
    s_add_u32 m0, s44, 29696
    s_add_u32 s58, s58, 28672
    buffer_load_dwordx4 v6, s[32:35], s58 offen lds
    v_mfma_f32_32x32x16_bf16 v[112:127], v[148:151], v[156:159], v[112:127]
    v_add_f32 v213, v213, v215
    v_add_f32 v192, v192, v196
    v_add_f32 v208, v208, v212
    v_add_f32 v193, v193, v197
    s_waitcnt lgkmcnt(6)
    v_mfma_f32_32x32x16_bf16 v[64:79], v[160:163], v[168:171], v[64:79]
    s_waitcnt vmcnt(16)
    ds_read_b64_tr_b16 v[144:145], v24 offset:34816
    ds_read_b64_tr_b16 v[146:147], v24 offset:35328
    ds_read_b64_tr_b16 v[148:149], v25 offset:34816
    v_mfma_f32_32x32x16_bf16 v[80:95], v[160:163], v[172:175], v[80:95]
    ds_read_b64_tr_b16 v[150:151], v25 offset:35328
    ds_read_b128 v[152:155], v19 offset:512
    ds_read_b128 v[156:159], v31 offset:512
    s_add_u32 m0, s44, 30720
    s_add_u32 s58, s58, 28672
    buffer_load_dwordx4 v6, s[32:35], s58 offen lds
    v_mfma_f32_32x32x16_bf16 v[96:111], v[164:167], v[168:171], v[96:111]
    s_add_u32 m0, s44, 31744
    s_add_u32 s58, s58, 28672
    buffer_load_dwordx4 v6, s[32:35], s58 offen lds
    v_mfma_f32_32x32x16_bf16 v[112:127], v[164:167], v[172:175], v[112:127]
    v_add_f32 v209, v209, v213
    v_mov_b32 v194, v192
    v_mov_b32 v210, v208
    s_waitcnt lgkmcnt(6)
    v_mfma_f32_32x32x16_bf16 v[64:79], v[128:131], v[136:139], v[64:79]
    s_waitcnt vmcnt(16)
    ds_read_b64_tr_b16 v[160:161], v24 offset:36864
    ds_read_b64_tr_b16 v[162:163], v24 offset:37376
    ds_read_b64_tr_b16 v[164:165], v25 offset:36864
    ds_read_b64_tr_b16 v[166:167], v25 offset:37376
    v_mfma_f32_32x32x16_bf16 v[80:95], v[128:131], v[140:143], v[80:95]
    ds_read_b128 v[168:171], v20 offset:512
    ds_read_b128 v[172:175], v32 offset:512
    s_add_u32 m0, s44, 32768
    s_add_u32 s58, s58, 28672
    buffer_load_dwordx4 v6, s[32:35], s58 offen lds
    v_mfma_f32_32x32x16_bf16 v[96:111], v[132:135], v[136:139], v[96:111]
    s_add_u32 m0, s44, 33792
    s_add_u32 s58, s58, 28672
    buffer_load_dwordx4 v6, s[32:35], s58 offen lds
    v_mfma_f32_32x32x16_bf16 v[112:127], v[132:135], v[140:143], v[112:127]
    v_mov_b32 v195, v193
    v_mov_b32 v211, v209
    s_nop 1
    s_nop 1
    s_waitcnt lgkmcnt(6)
    v_mfma_f32_32x32x16_bf16 v[64:79], v[144:147], v[152:155], v[64:79]
    s_waitcnt vmcnt(16)
    ds_read_b64_tr_b16 v[128:129], v24 offset:38912
    ds_read_b64_tr_b16 v[130:131], v24 offset:39424
    ds_read_b64_tr_b16 v[132:133], v25 offset:38912
    ds_read_b64_tr_b16 v[134:135], v25 offset:39424
    v_mfma_f32_32x32x16_bf16 v[80:95], v[144:147], v[156:159], v[80:95]
    ds_read_b128 v[136:139], v21 offset:512
    ds_read_b128 v[140:143], v33 offset:512
    s_add_u32 m0, s44, 34816
    s_add_u32 s58, s58, 28672
    buffer_load_dwordx4 v6, s[32:35], s58 offen lds
    v_mfma_f32_32x32x16_bf16 v[96:111], v[148:151], v[152:155], v[96:111]
    s_add_u32 m0, s44, 35840
    s_add_u32 s58, s58, 28672
    buffer_load_dwordx4 v6, s[32:35], s58 offen lds
    v_mfma_f32_32x32x16_bf16 v[112:127], v[148:151], v[156:159], v[112:127]
    v_permlane32_swap_b32 v192, v194
    v_permlane32_swap_b32 v208, v210
    v_permlane32_swap_b32 v193, v195
    v_permlane32_swap_b32 v209, v211
    s_waitcnt lgkmcnt(6)
    v_mfma_f32_32x32x16_bf16 v[64:79], v[160:163], v[168:171], v[64:79]
    s_waitcnt vmcnt(16)
    ds_read_b64_tr_b16 v[144:145], v24 offset:18432
    ds_read_b64_tr_b16 v[146:147], v24 offset:18944
    ds_read_b64_tr_b16 v[148:149], v25 offset:18432
    ds_read_b64_tr_b16 v[150:151], v25 offset:18944
    v_mfma_f32_32x32x16_bf16 v[80:95], v[160:163], v[172:175], v[80:95]
    ds_read_b128 v[152:155], v22 offset:512
    ds_read_b128 v[156:159], v34 offset:512
    s_add_u32 m0, s44, 36864
    s_add_u32 s58, s58, 28672
    buffer_load_dwordx4 v6, s[32:35], s58 offen lds
    v_mfma_f32_32x32x16_bf16 v[96:111], v[164:167], v[168:171], v[96:111]
    s_add_u32 m0, s44, 37888
    s_add_u32 s58, s58, 28672
    buffer_load_dwordx4 v6, s[32:35], s58 offen lds
    v_mfma_f32_32x32x16_bf16 v[112:127], v[164:167], v[172:175], v[112:127]
    s_nop 1
    s_nop 1
    v_add_f32 v192, v192, v194
    v_add_f32 v208, v208, v210
    s_waitcnt lgkmcnt(6)
    v_mfma_f32_32x32x16_bf16 v[64:79], v[128:131], v[136:139], v[64:79]
    s_waitcnt vmcnt(16)
    ds_read_b64_tr_b16 v[160:161], v24 offset:20480
    ds_read_b64_tr_b16 v[162:163], v24 offset:20992
    ds_read_b64_tr_b16 v[164:165], v25 offset:20480
    ds_read_b64_tr_b16 v[166:167], v25 offset:20992
    ds_read_b128 v[168:171], v23 offset:512
    ds_read_b128 v[172:175], v35 offset:512
    s_mov_b32 s32, s90
    s_mov_b32 s33, s91
    s_mov_b32 s34, 0x1c0000
    s_mov_b32 s35, 0x00020000
    v_lshrrev_b32 v2, 3, v1
    v_mfma_f32_32x32x16_bf16 v[80:95], v[128:131], v[140:143], v[80:95]
    v_and_b32 v3, 7, v1
    v_lshlrev_b32 v6, 1, v2
    v_and_b32 v6, 4, v6
    v_xor_b32 v3, v3, v6
    v_lshlrev_b32 v3, 4, v3
    v_mfma_f32_32x32x16_bf16 v[96:111], v[132:135], v[136:139], v[96:111]
    s_movk_i32 s58, 1024
    v_mul_lo_u32 v2, v2, s58
    v_add_u32 v6, v2, v3
    s_mul_i32 s58, s40, 458752
    s_lshl_b32 s59, s42, 7
    s_add_u32 s58, s58, s59
    s_sub_u32 s58, s58, 8192
    s_add_u32 m0, s44, 38912
    s_add_u32 s58, s58, 8192
    buffer_load_dwordx4 v6, s[32:35], s58 offen lds
    v_mfma_f32_32x32x16_bf16 v[112:127], v[132:135], v[140:143], v[112:127]
    s_add_u32 m0, s44, 39936
    s_add_u32 s58, s58, 8192
    buffer_load_dwordx4 v6, s[32:35], s58 offen lds
    v_add_f32 v193, v193, v195
    v_add_f32 v209, v209, v211
    v_mul_f32 v44, 0xbb000000, v192
    s_waitcnt lgkmcnt(6)
    v_mfma_f32_32x32x16_bf16 v[64:79], v[144:147], v[152:155], v[64:79]
    s_waitcnt vmcnt(16)
    ds_read_b64_tr_b16 v[128:129], v24 offset:22528
    ds_read_b64_tr_b16 v[130:131], v24 offset:23040
    ds_read_b64_tr_b16 v[132:133], v25 offset:22528
    ds_read_b64_tr_b16 v[134:135], v25 offset:23040
    v_mfma_f32_32x32x16_bf16 v[80:95], v[144:147], v[156:159], v[80:95]
    ds_read_b128 v[136:139], v16 offset:768
    ds_read_b128 v[140:143], v28 offset:768
    s_add_u32 m0, s44, 18432
    s_add_u32 s58, s58, 8192
    buffer_load_dwordx4 v6, s[32:35], s58 offen lds
    v_mfma_f32_32x32x16_bf16 v[96:111], v[148:151], v[152:155], v[96:111]
    s_add_u32 m0, s44, 19456
    s_add_u32 s58, s58, 8192
    buffer_load_dwordx4 v6, s[32:35], s58 offen lds
    v_mfma_f32_32x32x16_bf16 v[112:127], v[148:151], v[156:159], v[112:127]
    v_mul_f32 v52, 0xbb000000, v208
    v_mul_f32 v193, 0x3b000000, v193
    v_mul_f32 v209, 0x3b000000, v209
    v_fma_f32 v193, -v44, v44, v193
    s_waitcnt lgkmcnt(6)
    v_mfma_f32_32x32x16_bf16 v[64:79], v[160:163], v[168:171], v[64:79]
    s_waitcnt vmcnt(16)
    ds_read_b64_tr_b16 v[144:145], v24 offset:24576
    ds_read_b64_tr_b16 v[146:147], v24 offset:25088
    ds_read_b64_tr_b16 v[148:149], v25 offset:24576
    ds_read_b64_tr_b16 v[150:151], v25 offset:25088
    v_mfma_f32_32x32x16_bf16 v[80:95], v[160:163], v[172:175], v[80:95]
    ds_read_b128 v[152:155], v17 offset:768
    ds_read_b128 v[156:159], v29 offset:768
    s_add_u32 m0, s44, 20480
    s_add_u32 s58, s58, 8192
    buffer_load_dwordx4 v6, s[32:35], s58 offen lds
    v_mfma_f32_32x32x16_bf16 v[96:111], v[164:167], v[168:171], v[96:111]
    s_add_u32 m0, s44, 21504
    s_add_u32 s58, s58, 8192
    buffer_load_dwordx4 v6, s[32:35], s58 offen lds
    v_mfma_f32_32x32x16_bf16 v[112:127], v[164:167], v[172:175], v[112:127]
    v_fma_f32 v209, -v52, v52, v209
    v_max_f32 v193, 0, v193
    v_max_f32 v209, 0, v209
    v_add_f32 v193, 0x3727c5ac, v193
    s_waitcnt lgkmcnt(6)
    v_mfma_f32_32x32x16_bf16 v[64:79], v[128:131], v[136:139], v[64:79]
    s_waitcnt vmcnt(16)
    ds_read_b64_tr_b16 v[160:161], v24 offset:26624
    ds_read_b64_tr_b16 v[162:163], v24 offset:27136
    ds_read_b64_tr_b16 v[164:165], v25 offset:26624
    v_mfma_f32_32x32x16_bf16 v[80:95], v[128:131], v[140:143], v[80:95]
    ds_read_b64_tr_b16 v[166:167], v25 offset:27136
    ds_read_b128 v[168:171], v18 offset:768
    ds_read_b128 v[172:175], v30 offset:768
    s_add_u32 m0, s44, 22528
    s_add_u32 s58, s58, 8192
    buffer_load_dwordx4 v6, s[32:35], s58 offen lds
    v_mfma_f32_32x32x16_bf16 v[96:111], v[132:135], v[136:139], v[96:111]
    s_add_u32 m0, s44, 23552
    s_add_u32 s58, s58, 8192
    buffer_load_dwordx4 v6, s[32:35], s58 offen lds
    v_mfma_f32_32x32x16_bf16 v[112:127], v[132:135], v[140:143], v[112:127]
    v_add_f32 v209, 0x3727c5ac, v209
    v_rsq_f32 v194, v193
    v_rsq_f32 v210, v209
    s_waitcnt lgkmcnt(6)
    v_mfma_f32_32x32x16_bf16 v[64:79], v[144:147], v[152:155], v[64:79]
    s_waitcnt vmcnt(16)
    ds_read_b64_tr_b16 v[128:129], v24 offset:28672
    ds_read_b64_tr_b16 v[130:131], v24 offset:29184
    ds_read_b64_tr_b16 v[132:133], v25 offset:28672
    ds_read_b64_tr_b16 v[134:135], v25 offset:29184
    v_mfma_f32_32x32x16_bf16 v[80:95], v[144:147], v[156:159], v[80:95]
    ds_read_b128 v[136:139], v19 offset:768
    ds_read_b128 v[140:143], v31 offset:768
    s_add_u32 m0, s44, 24576
    s_add_u32 s58, s58, 8192
    buffer_load_dwordx4 v6, s[32:35], s58 offen lds
    v_mfma_f32_32x32x16_bf16 v[96:111], v[148:151], v[152:155], v[96:111]
    s_add_u32 m0, s44, 25600
    s_add_u32 s58, s58, 8192
    buffer_load_dwordx4 v6, s[32:35], s58 offen lds
    v_mfma_f32_32x32x16_bf16 v[112:127], v[148:151], v[156:159], v[112:127]
    v_sqrt_f32 v50, v193
    v_sqrt_f32 v58, v209
    s_nop 0
    s_nop 0
    s_waitcnt lgkmcnt(6)
    v_mfma_f32_32x32x16_bf16 v[64:79], v[160:163], v[168:171], v[64:79]
    s_waitcnt vmcnt(16)
    ds_read_b64_tr_b16 v[144:145], v24 offset:30720
    ds_read_b64_tr_b16 v[146:147], v24 offset:31232
    ds_read_b64_tr_b16 v[148:149], v25 offset:30720
    ds_read_b64_tr_b16 v[150:151], v25 offset:31232
    v_mfma_f32_32x32x16_bf16 v[80:95], v[160:163], v[172:175], v[80:95]
    ds_read_b128 v[152:155], v20 offset:768
    ds_read_b128 v[156:159], v32 offset:768
    s_add_u32 m0, s44, 26624
    s_add_u32 s58, s58, 8192
    buffer_load_dwordx4 v6, s[32:35], s58 offen lds
    v_mfma_f32_32x32x16_bf16 v[96:111], v[164:167], v[168:171], v[96:111]
    s_add_u32 m0, s44, 27648
    s_add_u32 s58, s58, 8192
    buffer_load_dwordx4 v6, s[32:35], s58 offen lds
    v_mfma_f32_32x32x16_bf16 v[112:127], v[164:167], v[172:175], v[112:127]
    v_mul_f32 v48, 0xc0135761, v194
    v_mul_f32 v56, 0xc0135761, v210
    v_mul_f32 v46, v194, v194
    v_mul_f32 v54, v210, v210
    s_waitcnt lgkmcnt(6)
    v_mfma_f32_32x32x16_bf16 v[64:79], v[128:131], v[136:139], v[64:79]
    s_waitcnt vmcnt(16)
    ds_read_b64_tr_b16 v[160:161], v24 offset:32768
    ds_read_b64_tr_b16 v[162:163], v24 offset:33280
    ds_read_b64_tr_b16 v[164:165], v25 offset:32768
    ds_read_b64_tr_b16 v[166:167], v25 offset:33280
    v_mfma_f32_32x32x16_bf16 v[80:95], v[128:131], v[140:143], v[80:95]
    ds_read_b128 v[168:171], v21 offset:768
    ds_read_b128 v[172:175], v33 offset:768
    s_add_u32 m0, s44, 28672
    s_add_u32 s58, s58, 8192
    buffer_load_dwordx4 v6, s[32:35], s58 offen lds
    v_mfma_f32_32x32x16_bf16 v[96:111], v[132:135], v[136:139], v[96:111]
    s_add_u32 m0, s44, 29696
    s_add_u32 s58, s58, 8192
    buffer_load_dwordx4 v6, s[32:35], s58 offen lds
    v_mfma_f32_32x32x16_bf16 v[112:127], v[132:135], v[140:143], v[112:127]
    v_mul_f32 v46, v46, v194
    v_mul_f32 v54, v54, v210
    v_mul_f32 v46, 0xbdd2d3e8, v46
    v_mul_f32 v54, 0xbdd2d3e8, v54
    s_waitcnt lgkmcnt(6)
    v_mfma_f32_32x32x16_bf16 v[64:79], v[144:147], v[152:155], v[64:79]
    s_waitcnt vmcnt(16)
    ds_read_b64_tr_b16 v[128:129], v24 offset:34816
    ds_read_b64_tr_b16 v[130:131], v24 offset:35328
    ds_read_b64_tr_b16 v[132:133], v25 offset:34816
    v_mfma_f32_32x32x16_bf16 v[80:95], v[144:147], v[156:159], v[80:95]
    ds_read_b64_tr_b16 v[134:135], v25 offset:35328
    ds_read_b128 v[136:139], v22 offset:768
    ds_read_b128 v[140:143], v34 offset:768
    v_mfma_f32_32x32x16_bf16 v[96:111], v[148:151], v[152:155], v[96:111]
    s_add_u32 m0, s44, 30720
    s_add_u32 s58, s58, 8192
    buffer_load_dwordx4 v6, s[32:35], s58 offen lds
    v_mfma_f32_32x32x16_bf16 v[112:127], v[148:151], v[156:159], v[112:127]
    s_add_u32 m0, s44, 31744
    s_add_u32 s58, s58, 8192
    buffer_load_dwordx4 v6, s[32:35], s58 offen lds
    s_waitcnt lgkmcnt(6)
    v_mfma_f32_32x32x16_bf16 v[64:79], v[160:163], v[168:171], v[64:79]
    s_waitcnt vmcnt(16)
    ds_read_b64_tr_b16 v[144:145], v24 offset:36864
    ds_read_b64_tr_b16 v[146:147], v24 offset:37376
    ds_read_b64_tr_b16 v[148:149], v25 offset:36864
    v_mfma_f32_32x32x16_bf16 v[80:95], v[160:163], v[172:175], v[80:95]
    ds_read_b64_tr_b16 v[150:151], v25 offset:37376
    ds_read_b128 v[152:155], v23 offset:768
    ds_read_b128 v[156:159], v35 offset:768
    v_mfma_f32_32x32x16_bf16 v[96:111], v[164:167], v[168:171], v[96:111]
    s_add_u32 m0, s44, 32768
    s_add_u32 s58, s58, 8192
    buffer_load_dwordx4 v6, s[32:35], s58 offen lds
    v_mfma_f32_32x32x16_bf16 v[112:127], v[164:167], v[172:175], v[112:127]
    s_add_u32 m0, s44, 33792
    s_add_u32 s58, s58, 8192
    buffer_load_dwordx4 v6, s[32:35], s58 offen lds
    s_waitcnt lgkmcnt(6)
    v_mfma_f32_32x32x16_bf16 v[64:79], v[128:131], v[136:139], v[64:79]
    s_add_u32 m0, s44, 34816
    s_add_u32 s58, s58, 8192
    buffer_load_dwordx4 v6, s[32:35], s58 offen lds
    v_mfma_f32_32x32x16_bf16 v[80:95], v[128:131], v[140:143], v[80:95]
    v_mfma_f32_32x32x16_bf16 v[96:111], v[132:135], v[136:139], v[96:111]
    s_add_u32 m0, s44, 35840
    s_add_u32 s58, s58, 8192
    buffer_load_dwordx4 v6, s[32:35], s58 offen lds
    v_mfma_f32_32x32x16_bf16 v[112:127], v[132:135], v[140:143], v[112:127]
    s_waitcnt lgkmcnt(0)
    v_mfma_f32_32x32x16_bf16 v[64:79], v[144:147], v[152:155], v[64:79]
    s_add_u32 m0, s44, 36864
    s_add_u32 s58, s58, 8192
    buffer_load_dwordx4 v6, s[32:35], s58 offen lds
    v_mfma_f32_32x32x16_bf16 v[80:95], v[144:147], v[156:159], v[80:95]
    v_mfma_f32_32x32x16_bf16 v[96:111], v[148:151], v[152:155], v[96:111]
    s_add_u32 m0, s44, 37888
    s_add_u32 s58, s58, 8192
    buffer_load_dwordx4 v6, s[32:35], s58 offen lds
    v_mfma_f32_32x32x16_bf16 v[112:127], v[148:151], v[156:159], v[112:127]
    s_add_u32 s51, s44, 17408
    v_mov_b32 v36, s51
    v_mov_b32 v38, s100
    v_mov_b32 v39, s101
    ds_write_b64 v36, v[38:39]
    v_and_b32 v37, 3, v1
    v_mul_u32_u24 v37, 40960, v37
    s_nop 7
    s_nop 3
    v_pk_fma_f32 v[64:65], v[224:225], v[44:45], v[64:65] op_sel_hi:[1,0,1]
    v_pk_fma_f32 v[66:67], v[226:227], v[44:45], v[66:67] op_sel_hi:[1,0,1]
    v_pk_fma_f32 v[68:69], v[228:229], v[44:45], v[68:69] op_sel_hi:[1,0,1]
    v_pk_fma_f32 v[70:71], v[230:231], v[44:45], v[70:71] op_sel_hi:[1,0,1]
    v_pk_mul_f32 v[128:129], v[64:65], v[64:65]
    v_pk_mul_f32 v[130:131], v[66:67], v[66:67]
    v_pk_mul_f32 v[132:133], v[68:69], v[68:69]
    v_pk_mul_f32 v[134:135], v[70:71], v[70:71]
    v_pk_fma_f32 v[128:129], v[128:129], v[46:47], v[48:49] op_sel_hi:[1,0,0]
    v_pk_fma_f32 v[130:131], v[130:131], v[46:47], v[48:49] op_sel_hi:[1,0,0]
    v_pk_fma_f32 v[132:133], v[132:133], v[46:47], v[48:49] op_sel_hi:[1,0,0]
    v_pk_fma_f32 v[134:135], v[134:135], v[46:47], v[48:49] op_sel_hi:[1,0,0]
    v_pk_mul_f32 v[128:129], v[128:129], v[64:65]
    v_pk_mul_f32 v[130:131], v[130:131], v[66:67]
    v_pk_mul_f32 v[132:133], v[132:133], v[68:69]
    v_pk_mul_f32 v[134:135], v[134:135], v[70:71]
    v_exp_f32 v128, v128
    v_exp_f32 v129, v129
    v_exp_f32 v130, v130
    v_exp_f32 v131, v131
    v_exp_f32 v132, v132
    v_exp_f32 v133, v133
    v_exp_f32 v134, v134
    v_exp_f32 v135, v135
    v_pk_fma_f32 v[128:129], v[128:129], v[50:51], v[50:51] op_sel_hi:[1,0,0]
    v_pk_fma_f32 v[130:131], v[130:131], v[50:51], v[50:51] op_sel_hi:[1,0,0]
    v_pk_fma_f32 v[132:133], v[132:133], v[50:51], v[50:51] op_sel_hi:[1,0,0]
    v_pk_fma_f32 v[134:135], v[134:135], v[50:51], v[50:51] op_sel_hi:[1,0,0]
    v_rcp_f32 v128, v128
    v_rcp_f32 v129, v129
    v_rcp_f32 v130, v130
    v_rcp_f32 v131, v131
    v_rcp_f32 v132, v132
    v_rcp_f32 v133, v133
    v_rcp_f32 v134, v134
    v_rcp_f32 v135, v135
    s_nop 0
    v_pk_mul_f32 v[64:65], v[64:65], v[128:129]
    v_pk_mul_f32 v[66:67], v[66:67], v[130:131]
    v_pk_mul_f32 v[68:69], v[68:69], v[132:133]
    v_pk_mul_f32 v[70:71], v[70:71], v[134:135]
    v_cvt_pk_bf16_f32 v160, v64, v65
    v_cvt_pk_bf16_f32 v161, v66, v67
    v_cvt_pk_bf16_f32 v162, v68, v69
    v_cvt_pk_bf16_f32 v163, v70, v71
    buffer_store_dwordx4 v[160:163], v4, s[20:23], s52 offen offset:0 sc1
    v_pk_fma_f32 v[72:73], v[232:233], v[44:45], v[72:73] op_sel_hi:[1,0,1]
    v_pk_fma_f32 v[74:75], v[234:235], v[44:45], v[74:75] op_sel_hi:[1,0,1]
    v_pk_fma_f32 v[76:77], v[236:237], v[44:45], v[76:77] op_sel_hi:[1,0,1]
    v_pk_fma_f32 v[78:79], v[238:239], v[44:45], v[78:79] op_sel_hi:[1,0,1]
    v_pk_mul_f32 v[128:129], v[72:73], v[72:73]
    v_pk_mul_f32 v[130:131], v[74:75], v[74:75]
    v_pk_mul_f32 v[132:133], v[76:77], v[76:77]
    v_pk_mul_f32 v[134:135], v[78:79], v[78:79]
    v_pk_fma_f32 v[128:129], v[128:129], v[46:47], v[48:49] op_sel_hi:[1,0,0]
    v_pk_fma_f32 v[130:131], v[130:131], v[46:47], v[48:49] op_sel_hi:[1,0,0]
    v_pk_fma_f32 v[132:133], v[132:133], v[46:47], v[48:49] op_sel_hi:[1,0,0]
    v_pk_fma_f32 v[134:135], v[134:135], v[46:47], v[48:49] op_sel_hi:[1,0,0]
    v_pk_mul_f32 v[128:129], v[128:129], v[72:73]
    v_pk_mul_f32 v[130:131], v[130:131], v[74:75]
    v_pk_mul_f32 v[132:133], v[132:133], v[76:77]
    v_pk_mul_f32 v[134:135], v[134:135], v[78:79]
    v_exp_f32 v128, v128
    v_exp_f32 v129, v129
    v_exp_f32 v130, v130
    v_exp_f32 v131, v131
    v_exp_f32 v132, v132
    v_exp_f32 v133, v133
    v_exp_f32 v134, v134
    v_exp_f32 v135, v135
    v_pk_fma_f32 v[128:129], v[128:129], v[50:51], v[50:51] op_sel_hi:[1,0,0]
    v_pk_fma_f32 v[130:131], v[130:131], v[50:51], v[50:51] op_sel_hi:[1,0,0]
    v_pk_fma_f32 v[132:133], v[132:133], v[50:51], v[50:51] op_sel_hi:[1,0,0]
    v_pk_fma_f32 v[134:135], v[134:135], v[50:51], v[50:51] op_sel_hi:[1,0,0]
    v_rcp_f32 v128, v128
    v_rcp_f32 v129, v129
    v_rcp_f32 v130, v130
    v_rcp_f32 v131, v131
    v_rcp_f32 v132, v132
    v_rcp_f32 v133, v133
    v_rcp_f32 v134, v134
    v_rcp_f32 v135, v135
    s_nop 0
    v_pk_mul_f32 v[72:73], v[72:73], v[128:129]
    v_pk_mul_f32 v[74:75], v[74:75], v[130:131]
    v_pk_mul_f32 v[76:77], v[76:77], v[132:133]
    v_pk_mul_f32 v[78:79], v[78:79], v[134:135]
    v_cvt_pk_bf16_f32 v164, v72, v73
    v_cvt_pk_bf16_f32 v165, v74, v75
    v_cvt_pk_bf16_f32 v166, v76, v77
    v_cvt_pk_bf16_f32 v167, v78, v79
    buffer_store_dwordx4 v[164:167], v4, s[20:23], s52 offen offset:2048 sc1
    v_pk_fma_f32 v[96:97], v[240:241], v[44:45], v[96:97] op_sel_hi:[1,0,1]
    v_pk_fma_f32 v[98:99], v[242:243], v[44:45], v[98:99] op_sel_hi:[1,0,1]
    v_pk_fma_f32 v[100:101], v[244:245], v[44:45], v[100:101] op_sel_hi:[1,0,1]
    v_pk_fma_f32 v[102:103], v[246:247], v[44:45], v[102:103] op_sel_hi:[1,0,1]
    v_pk_mul_f32 v[128:129], v[96:97], v[96:97]
    v_pk_mul_f32 v[130:131], v[98:99], v[98:99]
    v_pk_mul_f32 v[132:133], v[100:101], v[100:101]
    v_pk_mul_f32 v[134:135], v[102:103], v[102:103]
    v_pk_fma_f32 v[128:129], v[128:129], v[46:47], v[48:49] op_sel_hi:[1,0,0]
    v_pk_fma_f32 v[130:131], v[130:131], v[46:47], v[48:49] op_sel_hi:[1,0,0]
    v_pk_fma_f32 v[132:133], v[132:133], v[46:47], v[48:49] op_sel_hi:[1,0,0]
    v_pk_fma_f32 v[134:135], v[134:135], v[46:47], v[48:49] op_sel_hi:[1,0,0]
    v_pk_mul_f32 v[128:129], v[128:129], v[96:97]
    v_pk_mul_f32 v[130:131], v[130:131], v[98:99]
    v_pk_mul_f32 v[132:133], v[132:133], v[100:101]
    v_pk_mul_f32 v[134:135], v[134:135], v[102:103]
    v_exp_f32 v128, v128
    v_exp_f32 v129, v129
    v_exp_f32 v130, v130
    v_exp_f32 v131, v131
    v_exp_f32 v132, v132
    v_exp_f32 v133, v133
    v_exp_f32 v134, v134
    v_exp_f32 v135, v135
    v_pk_fma_f32 v[128:129], v[128:129], v[50:51], v[50:51] op_sel_hi:[1,0,0]
    v_pk_fma_f32 v[130:131], v[130:131], v[50:51], v[50:51] op_sel_hi:[1,0,0]
    v_pk_fma_f32 v[132:133], v[132:133], v[50:51], v[50:51] op_sel_hi:[1,0,0]
    v_pk_fma_f32 v[134:135], v[134:135], v[50:51], v[50:51] op_sel_hi:[1,0,0]
    v_rcp_f32 v128, v128
    v_rcp_f32 v129, v129
    v_rcp_f32 v130, v130
    v_rcp_f32 v131, v131
    v_rcp_f32 v132, v132
    v_rcp_f32 v133, v133
    v_rcp_f32 v134, v134
    v_rcp_f32 v135, v135
    s_nop 0
    v_pk_mul_f32 v[96:97], v[96:97], v[128:129]
    v_pk_mul_f32 v[98:99], v[98:99], v[130:131]
    v_pk_mul_f32 v[100:101], v[100:101], v[132:133]
    v_pk_mul_f32 v[102:103], v[102:103], v[134:135]
    v_cvt_pk_bf16_f32 v176, v96, v97
    v_cvt_pk_bf16_f32 v177, v98, v99
    v_cvt_pk_bf16_f32 v178, v100, v101
    v_cvt_pk_bf16_f32 v179, v102, v103
    buffer_store_dwordx4 v[176:179], v4, s[20:23], s53 offen offset:0 sc1
    v_pk_fma_f32 v[104:105], v[248:249], v[44:45], v[104:105] op_sel_hi:[1,0,1]
    v_pk_fma_f32 v[106:107], v[250:251], v[44:45], v[106:107] op_sel_hi:[1,0,1]
    v_pk_fma_f32 v[108:109], v[252:253], v[44:45], v[108:109] op_sel_hi:[1,0,1]
    v_pk_fma_f32 v[110:111], v[254:255], v[44:45], v[110:111] op_sel_hi:[1,0,1]
    v_pk_mul_f32 v[128:129], v[104:105], v[104:105]
    v_pk_mul_f32 v[130:131], v[106:107], v[106:107]
    v_pk_mul_f32 v[132:133], v[108:109], v[108:109]
    v_pk_mul_f32 v[134:135], v[110:111], v[110:111]
    v_pk_fma_f32 v[128:129], v[128:129], v[46:47], v[48:49] op_sel_hi:[1,0,0]
    v_pk_fma_f32 v[130:131], v[130:131], v[46:47], v[48:49] op_sel_hi:[1,0,0]
    v_pk_fma_f32 v[132:133], v[132:133], v[46:47], v[48:49] op_sel_hi:[1,0,0]
    v_pk_fma_f32 v[134:135], v[134:135], v[46:47], v[48:49] op_sel_hi:[1,0,0]
    v_pk_mul_f32 v[128:129], v[128:129], v[104:105]
    v_pk_mul_f32 v[130:131], v[130:131], v[106:107]
    v_pk_mul_f32 v[132:133], v[132:133], v[108:109]
    v_pk_mul_f32 v[134:135], v[134:135], v[110:111]
    v_exp_f32 v128, v128
    v_exp_f32 v129, v129
    v_exp_f32 v130, v130
    v_exp_f32 v131, v131
    v_exp_f32 v132, v132
    v_exp_f32 v133, v133
    v_exp_f32 v134, v134
    v_exp_f32 v135, v135
    v_pk_fma_f32 v[128:129], v[128:129], v[50:51], v[50:51] op_sel_hi:[1,0,0]
    v_pk_fma_f32 v[130:131], v[130:131], v[50:51], v[50:51] op_sel_hi:[1,0,0]
    v_pk_fma_f32 v[132:133], v[132:133], v[50:51], v[50:51] op_sel_hi:[1,0,0]
    v_pk_fma_f32 v[134:135], v[134:135], v[50:51], v[50:51] op_sel_hi:[1,0,0]
    v_rcp_f32 v128, v128
    v_rcp_f32 v129, v129
    v_rcp_f32 v130, v130
    v_rcp_f32 v131, v131
    v_rcp_f32 v132, v132
    v_rcp_f32 v133, v133
    v_rcp_f32 v134, v134
    v_rcp_f32 v135, v135
    s_nop 0
    v_pk_mul_f32 v[104:105], v[104:105], v[128:129]
    v_pk_mul_f32 v[106:107], v[106:107], v[130:131]
    v_pk_mul_f32 v[108:109], v[108:109], v[132:133]
    v_pk_mul_f32 v[110:111], v[110:111], v[134:135]
    v_cvt_pk_bf16_f32 v180, v104, v105
    v_cvt_pk_bf16_f32 v181, v106, v107
    v_cvt_pk_bf16_f32 v182, v108, v109
    v_cvt_pk_bf16_f32 v183, v110, v111
    buffer_store_dwordx4 v[180:183], v4, s[20:23], s53 offen offset:2048 sc1
    v_pk_fma_f32 v[80:81], v[224:225], v[52:53], v[80:81] op_sel_hi:[1,0,1]
    v_pk_fma_f32 v[82:83], v[226:227], v[52:53], v[82:83] op_sel_hi:[1,0,1]
    v_pk_fma_f32 v[84:85], v[228:229], v[52:53], v[84:85] op_sel_hi:[1,0,1]
    v_pk_fma_f32 v[86:87], v[230:231], v[52:53], v[86:87] op_sel_hi:[1,0,1]
    v_pk_mul_f32 v[128:129], v[80:81], v[80:81]
    v_pk_mul_f32 v[130:131], v[82:83], v[82:83]
    v_pk_mul_f32 v[132:133], v[84:85], v[84:85]
    v_pk_mul_f32 v[134:135], v[86:87], v[86:87]
    v_pk_fma_f32 v[128:129], v[128:129], v[54:55], v[56:57] op_sel_hi:[1,0,0]
    v_pk_fma_f32 v[130:131], v[130:131], v[54:55], v[56:57] op_sel_hi:[1,0,0]
    v_pk_fma_f32 v[132:133], v[132:133], v[54:55], v[56:57] op_sel_hi:[1,0,0]
    v_pk_fma_f32 v[134:135], v[134:135], v[54:55], v[56:57] op_sel_hi:[1,0,0]
    v_pk_mul_f32 v[128:129], v[128:129], v[80:81]
    v_pk_mul_f32 v[130:131], v[130:131], v[82:83]
    v_pk_mul_f32 v[132:133], v[132:133], v[84:85]
    v_pk_mul_f32 v[134:135], v[134:135], v[86:87]
    v_exp_f32 v128, v128
    v_exp_f32 v129, v129
    v_exp_f32 v130, v130
    v_exp_f32 v131, v131
    v_exp_f32 v132, v132
    v_exp_f32 v133, v133
    v_exp_f32 v134, v134
    v_exp_f32 v135, v135
    v_pk_fma_f32 v[128:129], v[128:129], v[58:59], v[58:59] op_sel_hi:[1,0,0]
    v_pk_fma_f32 v[130:131], v[130:131], v[58:59], v[58:59] op_sel_hi:[1,0,0]
    v_pk_fma_f32 v[132:133], v[132:133], v[58:59], v[58:59] op_sel_hi:[1,0,0]
    v_pk_fma_f32 v[134:135], v[134:135], v[58:59], v[58:59] op_sel_hi:[1,0,0]
    v_rcp_f32 v128, v128
    v_rcp_f32 v129, v129
    v_rcp_f32 v130, v130
    v_rcp_f32 v131, v131
    v_rcp_f32 v132, v132
    v_rcp_f32 v133, v133
    v_rcp_f32 v134, v134
    v_rcp_f32 v135, v135
    s_nop 0
    v_pk_mul_f32 v[80:81], v[80:81], v[128:129]
    v_pk_mul_f32 v[82:83], v[82:83], v[130:131]
    v_pk_mul_f32 v[84:85], v[84:85], v[132:133]
    v_pk_mul_f32 v[86:87], v[86:87], v[134:135]
    v_cvt_pk_bf16_f32 v168, v80, v81
    v_cvt_pk_bf16_f32 v169, v82, v83
    v_cvt_pk_bf16_f32 v170, v84, v85
    v_cvt_pk_bf16_f32 v171, v86, v87
    buffer_store_dwordx4 v[168:171], v4, s[20:23], s52 offen offset:1024 sc1
    v_pk_fma_f32 v[88:89], v[232:233], v[52:53], v[88:89] op_sel_hi:[1,0,1]
    v_pk_fma_f32 v[90:91], v[234:235], v[52:53], v[90:91] op_sel_hi:[1,0,1]
    v_pk_fma_f32 v[92:93], v[236:237], v[52:53], v[92:93] op_sel_hi:[1,0,1]
    v_pk_fma_f32 v[94:95], v[238:239], v[52:53], v[94:95] op_sel_hi:[1,0,1]
    v_pk_mul_f32 v[128:129], v[88:89], v[88:89]
    v_pk_mul_f32 v[130:131], v[90:91], v[90:91]
    v_pk_mul_f32 v[132:133], v[92:93], v[92:93]
    v_pk_mul_f32 v[134:135], v[94:95], v[94:95]
    v_pk_fma_f32 v[128:129], v[128:129], v[54:55], v[56:57] op_sel_hi:[1,0,0]
    v_pk_fma_f32 v[130:131], v[130:131], v[54:55], v[56:57] op_sel_hi:[1,0,0]
    v_pk_fma_f32 v[132:133], v[132:133], v[54:55], v[56:57] op_sel_hi:[1,0,0]
    v_pk_fma_f32 v[134:135], v[134:135], v[54:55], v[56:57] op_sel_hi:[1,0,0]
    v_pk_mul_f32 v[128:129], v[128:129], v[88:89]
    v_pk_mul_f32 v[130:131], v[130:131], v[90:91]
    v_pk_mul_f32 v[132:133], v[132:133], v[92:93]
    v_pk_mul_f32 v[134:135], v[134:135], v[94:95]
    v_exp_f32 v128, v128
    v_exp_f32 v129, v129
    v_exp_f32 v130, v130
    v_exp_f32 v131, v131
    v_exp_f32 v132, v132
    v_exp_f32 v133, v133
    v_exp_f32 v134, v134
    v_exp_f32 v135, v135
    v_pk_fma_f32 v[128:129], v[128:129], v[58:59], v[58:59] op_sel_hi:[1,0,0]
    v_pk_fma_f32 v[130:131], v[130:131], v[58:59], v[58:59] op_sel_hi:[1,0,0]
    v_pk_fma_f32 v[132:133], v[132:133], v[58:59], v[58:59] op_sel_hi:[1,0,0]
    v_pk_fma_f32 v[134:135], v[134:135], v[58:59], v[58:59] op_sel_hi:[1,0,0]
    v_rcp_f32 v128, v128
    v_rcp_f32 v129, v129
    v_rcp_f32 v130, v130
    v_rcp_f32 v131, v131
    v_rcp_f32 v132, v132
    v_rcp_f32 v133, v133
    v_rcp_f32 v134, v134
    v_rcp_f32 v135, v135
    s_nop 0
    v_pk_mul_f32 v[88:89], v[88:89], v[128:129]
    v_pk_mul_f32 v[90:91], v[90:91], v[130:131]
    v_pk_mul_f32 v[92:93], v[92:93], v[132:133]
    v_pk_mul_f32 v[94:95], v[94:95], v[134:135]
    v_cvt_pk_bf16_f32 v172, v88, v89
    v_cvt_pk_bf16_f32 v173, v90, v91
    v_cvt_pk_bf16_f32 v174, v92, v93
    v_cvt_pk_bf16_f32 v175, v94, v95
    buffer_store_dwordx4 v[172:175], v4, s[20:23], s52 offen offset:3072 sc1
    v_pk_fma_f32 v[112:113], v[240:241], v[52:53], v[112:113] op_sel_hi:[1,0,1]
    v_pk_fma_f32 v[114:115], v[242:243], v[52:53], v[114:115] op_sel_hi:[1,0,1]
    v_pk_fma_f32 v[116:117], v[244:245], v[52:53], v[116:117] op_sel_hi:[1,0,1]
    v_pk_fma_f32 v[118:119], v[246:247], v[52:53], v[118:119] op_sel_hi:[1,0,1]
    v_pk_mul_f32 v[128:129], v[112:113], v[112:113]
    v_pk_mul_f32 v[130:131], v[114:115], v[114:115]
    v_pk_mul_f32 v[132:133], v[116:117], v[116:117]
    v_pk_mul_f32 v[134:135], v[118:119], v[118:119]
    v_pk_fma_f32 v[128:129], v[128:129], v[54:55], v[56:57] op_sel_hi:[1,0,0]
    v_pk_fma_f32 v[130:131], v[130:131], v[54:55], v[56:57] op_sel_hi:[1,0,0]
    v_pk_fma_f32 v[132:133], v[132:133], v[54:55], v[56:57] op_sel_hi:[1,0,0]
    v_pk_fma_f32 v[134:135], v[134:135], v[54:55], v[56:57] op_sel_hi:[1,0,0]
    v_pk_mul_f32 v[128:129], v[128:129], v[112:113]
    v_pk_mul_f32 v[130:131], v[130:131], v[114:115]
    v_pk_mul_f32 v[132:133], v[132:133], v[116:117]
    v_pk_mul_f32 v[134:135], v[134:135], v[118:119]
    v_exp_f32 v128, v128
    v_exp_f32 v129, v129
    v_exp_f32 v130, v130
    v_exp_f32 v131, v131
    v_exp_f32 v132, v132
    v_exp_f32 v133, v133
    v_exp_f32 v134, v134
    v_exp_f32 v135, v135
    v_pk_fma_f32 v[128:129], v[128:129], v[58:59], v[58:59] op_sel_hi:[1,0,0]
    v_pk_fma_f32 v[130:131], v[130:131], v[58:59], v[58:59] op_sel_hi:[1,0,0]
    v_pk_fma_f32 v[132:133], v[132:133], v[58:59], v[58:59] op_sel_hi:[1,0,0]
    v_pk_fma_f32 v[134:135], v[134:135], v[58:59], v[58:59] op_sel_hi:[1,0,0]
    v_rcp_f32 v128, v128
    v_rcp_f32 v129, v129
    v_rcp_f32 v130, v130
    v_rcp_f32 v131, v131
    v_rcp_f32 v132, v132
    v_rcp_f32 v133, v133
    v_rcp_f32 v134, v134
    v_rcp_f32 v135, v135
    s_nop 0
    v_pk_mul_f32 v[112:113], v[112:113], v[128:129]
    v_pk_mul_f32 v[114:115], v[114:115], v[130:131]
    v_pk_mul_f32 v[116:117], v[116:117], v[132:133]
    v_pk_mul_f32 v[118:119], v[118:119], v[134:135]
    v_cvt_pk_bf16_f32 v184, v112, v113
    v_cvt_pk_bf16_f32 v185, v114, v115
    v_cvt_pk_bf16_f32 v186, v116, v117
    v_cvt_pk_bf16_f32 v187, v118, v119
    buffer_store_dwordx4 v[184:187], v4, s[20:23], s53 offen offset:1024 sc1
    v_pk_fma_f32 v[120:121], v[248:249], v[52:53], v[120:121] op_sel_hi:[1,0,1]
    v_pk_fma_f32 v[122:123], v[250:251], v[52:53], v[122:123] op_sel_hi:[1,0,1]
    v_pk_fma_f32 v[124:125], v[252:253], v[52:53], v[124:125] op_sel_hi:[1,0,1]
    v_pk_fma_f32 v[126:127], v[254:255], v[52:53], v[126:127] op_sel_hi:[1,0,1]
    v_pk_mul_f32 v[128:129], v[120:121], v[120:121]
    v_pk_mul_f32 v[130:131], v[122:123], v[122:123]
    v_pk_mul_f32 v[132:133], v[124:125], v[124:125]
    v_pk_mul_f32 v[134:135], v[126:127], v[126:127]
    v_pk_fma_f32 v[128:129], v[128:129], v[54:55], v[56:57] op_sel_hi:[1,0,0]
    v_pk_fma_f32 v[130:131], v[130:131], v[54:55], v[56:57] op_sel_hi:[1,0,0]
    v_pk_fma_f32 v[132:133], v[132:133], v[54:55], v[56:57] op_sel_hi:[1,0,0]
    v_pk_fma_f32 v[134:135], v[134:135], v[54:55], v[56:57] op_sel_hi:[1,0,0]
    v_pk_mul_f32 v[128:129], v[128:129], v[120:121]
    v_pk_mul_f32 v[130:131], v[130:131], v[122:123]
    v_pk_mul_f32 v[132:133], v[132:133], v[124:125]
    v_pk_mul_f32 v[134:135], v[134:135], v[126:127]
    v_exp_f32 v128, v128
    v_exp_f32 v129, v129
    v_exp_f32 v130, v130
    v_exp_f32 v131, v131
    v_exp_f32 v132, v132
    v_exp_f32 v133, v133
    v_exp_f32 v134, v134
    v_exp_f32 v135, v135
    v_pk_fma_f32 v[128:129], v[128:129], v[58:59], v[58:59] op_sel_hi:[1,0,0]
    v_pk_fma_f32 v[130:131], v[130:131], v[58:59], v[58:59] op_sel_hi:[1,0,0]
    v_pk_fma_f32 v[132:133], v[132:133], v[58:59], v[58:59] op_sel_hi:[1,0,0]
    v_pk_fma_f32 v[134:135], v[134:135], v[58:59], v[58:59] op_sel_hi:[1,0,0]
    v_rcp_f32 v128, v128
    v_rcp_f32 v129, v129
    v_rcp_f32 v130, v130
    v_rcp_f32 v131, v131
    v_rcp_f32 v132, v132
    v_rcp_f32 v133, v133
    v_rcp_f32 v134, v134
    v_rcp_f32 v135, v135
    s_nop 0
    v_pk_mul_f32 v[120:121], v[120:121], v[128:129]
    v_pk_mul_f32 v[122:123], v[122:123], v[130:131]
    v_pk_mul_f32 v[124:125], v[124:125], v[132:133]
    v_pk_mul_f32 v[126:127], v[126:127], v[134:135]
    v_cvt_pk_bf16_f32 v188, v120, v121
    v_cvt_pk_bf16_f32 v189, v122, v123
    v_cvt_pk_bf16_f32 v190, v124, v125
    v_cvt_pk_bf16_f32 v191, v126, v127
    buffer_store_dwordx4 v[188:191], v4, s[20:23], s53 offen offset:3072 sc1
    s_add_u32 s58, s58, 131072
    s_branch .Lk5_end
.Lk5_pf:
    s_mov_b32 s32, s90
    s_mov_b32 s33, s91
    s_mov_b32 s34, 0x1c0000
    s_mov_b32 s35, 0x00020000
    v_lshrrev_b32 v2, 3, v1
    v_and_b32 v3, 7, v1
    v_lshlrev_b32 v6, 1, v2
    v_and_b32 v6, 4, v6
    v_xor_b32 v3, v3, v6
    v_lshlrev_b32 v3, 4, v3
    s_movk_i32 s58, 1024
    v_mul_lo_u32 v2, v2, s58
    v_add_u32 v6, v2, v3
    s_mul_i32 s58, s40, 458752
    s_lshl_b32 s59, s42, 7
    s_add_u32 s58, s58, s59
    s_sub_u32 s58, s58, 8192
    s_add_u32 m0, s44, 38912
    s_add_u32 s58, s58, 8192
    buffer_load_dwordx4 v6, s[32:35], s58 offen lds
    s_add_u32 m0, s44, 39936
    s_add_u32 s58, s58, 8192
    buffer_load_dwordx4 v6, s[32:35], s58 offen lds
    s_add_u32 m0, s44, 18432
    s_add_u32 s58, s58, 8192
    buffer_load_dwordx4 v6, s[32:35], s58 offen lds
    s_add_u32 m0, s44, 19456
    s_add_u32 s58, s58, 8192
    buffer_load_dwordx4 v6, s[32:35], s58 offen lds
    s_add_u32 m0, s44, 20480
    s_add_u32 s58, s58, 8192
    buffer_load_dwordx4 v6, s[32:35], s58 offen lds
    s_add_u32 m0, s44, 21504
    s_add_u32 s58, s58, 8192
    buffer_load_dwordx4 v6, s[32:35], s58 offen lds
    s_add_u32 m0, s44, 22528
    s_add_u32 s58, s58, 8192
    buffer_load_dwordx4 v6, s[32:35], s58 offen lds
    s_add_u32 m0, s44, 23552
    s_add_u32 s58, s58, 8192
    buffer_load_dwordx4 v6, s[32:35], s58 offen lds
    s_add_u32 m0, s44, 24576
    s_add_u32 s58, s58, 8192
    buffer_load_dwordx4 v6, s[32:35], s58 offen lds
    s_add_u32 m0, s44, 25600
    s_add_u32 s58, s58, 8192
    buffer_load_dwordx4 v6, s[32:35], s58 offen lds
    s_add_u32 m0, s44, 26624
    s_add_u32 s58, s58, 8192
    buffer_load_dwordx4 v6, s[32:35], s58 offen lds
    s_add_u32 m0, s44, 27648
    s_add_u32 s58, s58, 8192
    buffer_load_dwordx4 v6, s[32:35], s58 offen lds
    s_add_u32 m0, s44, 28672
    s_add_u32 s58, s58, 8192
    buffer_load_dwordx4 v6, s[32:35], s58 offen lds
    s_add_u32 m0, s44, 29696
    s_add_u32 s58, s58, 8192
    buffer_load_dwordx4 v6, s[32:35], s58 offen lds
    s_add_u32 m0, s44, 30720
    s_add_u32 s58, s58, 8192
    buffer_load_dwordx4 v6, s[32:35], s58 offen lds
    s_add_u32 m0, s44, 31744
    s_add_u32 s58, s58, 8192
    buffer_load_dwordx4 v6, s[32:35], s58 offen lds
    s_add_u32 m0, s44, 32768
    s_add_u32 s58, s58, 8192
    buffer_load_dwordx4 v6, s[32:35], s58 offen lds
    s_add_u32 m0, s44, 33792
    s_add_u32 s58, s58, 8192
    buffer_load_dwordx4 v6, s[32:35], s58 offen lds
    s_add_u32 m0, s44, 34816
    s_add_u32 s58, s58, 8192
    buffer_load_dwordx4 v6, s[32:35], s58 offen lds
    s_add_u32 m0, s44, 35840
    s_add_u32 s58, s58, 8192
    buffer_load_dwordx4 v6, s[32:35], s58 offen lds
    s_add_u32 m0, s44, 36864
    s_add_u32 s58, s58, 8192
    buffer_load_dwordx4 v6, s[32:35], s58 offen lds
    s_add_u32 m0, s44, 37888
    s_add_u32 s58, s58, 8192
    buffer_load_dwordx4 v6, s[32:35], s58 offen lds
    s_add_u32 m0, s44, 0
    s_add_u32 s58, s58, 8192
    buffer_load_dwordx4 v6, s[32:35], s58 offen lds
    s_add_u32 m0, s44, 1024
    s_add_u32 s58, s58, 8192
    buffer_load_dwordx4 v6, s[32:35], s58 offen lds
    s_add_u32 m0, s44, 2048
    s_add_u32 s58, s58, 8192
    buffer_load_dwordx4 v6, s[32:35], s58 offen lds
    s_add_u32 m0, s44, 3072
    s_add_u32 s58, s58, 8192
    buffer_load_dwordx4 v6, s[32:35], s58 offen lds
    s_add_u32 m0, s44, 4096
    s_add_u32 s58, s58, 8192
    buffer_load_dwordx4 v6, s[32:35], s58 offen lds
    s_add_u32 m0, s44, 5120
    s_add_u32 s58, s58, 8192
    buffer_load_dwordx4 v6, s[32:35], s58 offen lds
    s_add_u32 m0, s44, 6144
    s_add_u32 s58, s58, 8192
    buffer_load_dwordx4 v6, s[32:35], s58 offen lds
    s_add_u32 m0, s44, 7168
    s_add_u32 s58, s58, 8192
    buffer_load_dwordx4 v6, s[32:35], s58 offen lds
    s_add_u32 m0, s44, 8192
    s_add_u32 s58, s58, 8192
    buffer_load_dwordx4 v6, s[32:35], s58 offen lds
    s_add_u32 m0, s44, 9216
    s_add_u32 s58, s58, 8192
    buffer_load_dwordx4 v6, s[32:35], s58 offen lds
    s_add_u32 m0, s44, 10240
    s_add_u32 s58, s58, 8192
    buffer_load_dwordx4 v6, s[32:35], s58 offen lds
    s_add_u32 m0, s44, 11264
    s_add_u32 s58, s58, 8192
    buffer_load_dwordx4 v6, s[32:35], s58 offen lds
    s_add_u32 m0, s44, 12288
    s_add_u32 s58, s58, 8192
    buffer_load_dwordx4 v6, s[32:35], s58 offen lds
    s_add_u32 m0, s44, 13312
    s_add_u32 s58, s58, 8192
    buffer_load_dwordx4 v6, s[32:35], s58 offen lds
    s_add_u32 m0, s44, 14336
    s_add_u32 s58, s58, 8192
    buffer_load_dwordx4 v6, s[32:35], s58 offen lds
    s_add_u32 m0, s44, 15360
    s_add_u32 s58, s58, 8192
    buffer_load_dwordx4 v6, s[32:35], s58 offen lds
.Lk5_end:
    s_waitcnt vmcnt(0)
    s_add_u32 s92, s68, 0x1a08000
    s_addc_u32 s93, s69, 0
    s_mov_b32 s94, 0x2000
    s_mov_b32 s95, 0x00020000
    s_lshl_b32 s96, s41, 8
    s_lshl_b32 s97, s42, 3
    s_add_u32 s97, s97, s96
    v_mov_b32 v246, s100
    v_mov_b32 v247, s101
    v_mov_b32 v2, 1
    v_mov_b32 v3, s97
    s_waitcnt lgkmcnt(0)
    s_barrier
    s_cmp_lg_u32 s40, 7
    s_cbranch_scc1 .Lpub4
    s_mov_b64 exec, 1
    buffer_store_dwordx2 v[246:247], v3, s[92:95], 0 offen sc1
    s_mov_b64 exec, -1
.Lpub4:
    s_cmp_ge_u32 s40, 4
    s_cbranch_scc1 .Lk6_help
    v_lshrrev_b32 v7, 3, v1
    v_and_b32 v8, 7, v1
    v_lshrrev_b32 v9, 1, v7
    v_xor_b32 v9, v8, v9
    s_movk_i32 s48, 3584
    v_mul_lo_u32 v10, v7, s48
    v_lshl_add_u32 v4, v9, 4, v10
    v_xor_b32 v9, 4, v9
    v_lshl_add_u32 v5, v9, 4, v10
    s_mul_i32 s45, s41, 229376
    s_mul_i32 s48, s40, 57344
    v_lshlrev_b32 v4, 4, v1
    s_add_u32 s45, s45, s48
    s_add_u32 s8, s68, 0xa00000
    s_addc_u32 s9, s69, 0
    s_mov_b32 s10, 0x700000
    s_mov_b32 s11, 0x00020000
    v_lshrrev_b32 v7, 5, v1
    v_bfe_u32 v8, v1, 4, 1
    v_bfe_u32 v9, v1, 2, 2
    v_and_b32 v10, 1, v1
    v_bfe_u32 v11, v1, 1, 1
    v_lshl_or_b32 v10, v10, 1, v11
    v_lshlrev_b32 v10, 3, v10
    v_lshl_add_u32 v10, v8, 5, v10
    v_lshl_add_u32 v11, v7, 3, v9
    v_lshrrev_b32 v12, 1, v9
    v_xor_b32 v13, 0, v12
    v_lshl_add_u32 v13, v13, 6, v10
    v_lshl_add_u32 v13, v11, 7, v13
    v_add_u32 v16, s44, v13
    v_xor_b32 v13, 1, v12
    v_lshl_add_u32 v13, v13, 6, v10
    v_lshl_add_u32 v13, v11, 7, v13
    v_add_u32 v17, s44, v13
    v_and_b32 v8, 31, v1
    v_bfe_u32 v9, v8, 1, 3
    v_or_b32 v10, 0, v7
    v_xor_b32 v10, v10, v9
    v_lshlrev_b32 v10, 4, v10
    v_lshl_add_u32 v10, v8, 7, v10
    v_add_u32 v18, s44, v10
    v_or_b32 v10, 2, v7
    v_xor_b32 v10, v10, v9
    v_lshlrev_b32 v10, 4, v10
    v_lshl_add_u32 v10, v8, 7, v10
    v_add_u32 v19, s44, v10
    v_or_b32 v10, 4, v7
    v_xor_b32 v10, v10, v9
    v_lshlrev_b32 v10, 4, v10
    v_lshl_add_u32 v10, v8, 7, v10
    v_add_u32 v20, s44, v10
    v_or_b32 v10, 6, v7
    v_xor_b32 v10, v10, v9
    v_lshlrev_b32 v10, 4, v10
    v_lshl_add_u32 v10, v8, 7, v10
    v_add_u32 v21, s44, v10
    v_mul_u32_u24 v48, 272, v8
    v_lshl_add_u32 v48, v7, 5, v48
    v_add_u32 v48, s44, v48
    v_lshrrev_b32 v10, 3, v1
    v_and_b32 v11, 7, v1
    v_mul_u32_u24 v49, 272, v10
    v_lshl_add_u32 v49, v11, 5, v49
    s_mul_i32 s51, s40, 2176
    v_add_u32 v49, s51, v49
    v_add_u32 v50, 81920, v49
    v_lshlrev_b32 v51, 4, v11
    v_lshl_add_u32 v51, v10, 10, v51
    s_lshl_b32 s50, s41, 16
    s_lshl_b32 s51, s40, 13
    s_add_u32 s50, s50, s51
    s_lshl_b32 s51, s42, 7
    s_add_u32 s50, s50, s51
    v_lshlrev_b32 v52, 5, v11
    s_add_u32 s16, s68, 0x600000
    s_addc_u32 s17, s69, 0
    s_mov_b32 s18, 0x200000
    s_mov_b32 s19, 0x00020000
    s_add_u32 s20, s68, 0x400000
    s_addc_u32 s21, s69, 0
    s_mov_b32 s22, 0x200000
    s_mov_b32 s23, 0x00020000
    s_mov_b32 s24, s68
    s_mov_b32 s25, s69
    s_mov_b32 s26, 0xc000
    s_mov_b32 s27, 0x00020000
    s_mov_b32 s28, s62
    s_mov_b32 s29, s63
    s_mov_b32 s30, 0x200000
    s_mov_b32 s31, 0x00020000
    buffer_load_dwordx4 v[24:27], v51, s[16:19], s50 offen
    buffer_load_dwordx4 v[32:35], v51, s[20:23], s50 offen
    s_lshl_b32 s51, s42, 8
    s_add_u32 s51, s51, 10240
    buffer_load_dwordx4 v[40:43], v52, s[24:27], s51 offen offset:0
    buffer_load_dwordx4 v[44:47], v52, s[24:27], s51 offen offset:16
    s_add_u32 s51, s51, 12288
    buffer_load_dwordx4 v[28:31], v52, s[24:27], s51 offen offset:0
    buffer_load_dwordx4 v[36:39], v52, s[24:27], s51 offen offset:16
    s_barrier
    buffer_load_dwordx4 v[192:195], v4, s[8:11], s45 offen offset:0
    buffer_load_dwordx4 v[196:199], v4, s[8:11], s45 offen offset:1024
    buffer_load_dwordx4 v[200:203], v4, s[8:11], s45 offen offset:2048
    buffer_load_dwordx4 v[204:207], v4, s[8:11], s45 offen offset:3072
    s_add_u32 s45, s45, 4096
    buffer_load_dwordx4 v[208:211], v4, s[8:11], s45 offen offset:0
    buffer_load_dwordx4 v[212:215], v4, s[8:11], s45 offen offset:1024
    buffer_load_dwordx4 v[216:219], v4, s[8:11], s45 offen offset:2048
    buffer_load_dwordx4 v[220:223], v4, s[8:11], s45 offen offset:3072
    s_add_u32 s45, s45, 4096
    buffer_load_dwordx4 v[224:227], v4, s[8:11], s45 offen offset:0
    buffer_load_dwordx4 v[228:231], v4, s[8:11], s45 offen offset:1024
    buffer_load_dwordx4 v[232:235], v4, s[8:11], s45 offen offset:2048
    buffer_load_dwordx4 v[236:239], v4, s[8:11], s45 offen offset:3072
    s_add_u32 s45, s45, 4096
    buffer_load_dwordx4 v[240:243], v4, s[8:11], s45 offen offset:0
    buffer_load_dwordx4 v[244:247], v4, s[8:11], s45 offen offset:1024
    buffer_load_dwordx4 v[248:251], v4, s[8:11], s45 offen offset:2048
    buffer_load_dwordx4 v[252:255], v4, s[8:11], s45 offen offset:3072
    s_add_u32 s45, s45, 4096
    ds_read_b64_tr_b16 v[128:129], v16 offset:38912
    ds_read_b64_tr_b16 v[130:131], v16 offset:39424
    ds_read_b64_tr_b16 v[132:133], v17 offset:38912
    ds_read_b64_tr_b16 v[134:135], v17 offset:39424
    ds_read_b64_tr_b16 v[136:137], v16 offset:18432
    ds_read_b64_tr_b16 v[138:139], v16 offset:18944
    ds_read_b64_tr_b16 v[140:141], v17 offset:18432
    ds_read_b64_tr_b16 v[142:143], v17 offset:18944
    s_waitcnt lgkmcnt(4)
    s_waitcnt vmcnt(14)
    v_mfma_f32_32x32x16_bf16 v[64:79], v[128:131], v[192:195], 0
    s_add_u32 m0, s44, 38912
    s_add_u32 s58, s58, 8192
    buffer_load_dwordx4 v6, s[32:35], s58 offen lds
    v_mfma_f32_32x32x16_bf16 v[80:95], v[128:131], v[196:199], 0
    s_add_u32 m0, s44, 39936
    s_add_u32 s58, s58, 8192
    buffer_load_dwordx4 v6, s[32:35], s58 offen lds
    v_mfma_f32_32x32x16_bf16 v[96:111], v[132:135], v[192:195], 0
    ds_read_b64_tr_b16 v[144:145], v16 offset:20480
    ds_read_b64_tr_b16 v[146:147], v16 offset:20992
    v_mfma_f32_32x32x16_bf16 v[112:127], v[132:135], v[196:199], 0
    ds_read_b64_tr_b16 v[148:149], v17 offset:20480
    ds_read_b64_tr_b16 v[150:151], v17 offset:20992
    s_waitcnt lgkmcnt(4)
    s_waitcnt vmcnt(14)
    v_mfma_f32_32x32x16_bf16 v[64:79], v[136:139], v[200:203], v[64:79]
    buffer_load_dwordx4 v[192:195], v4, s[8:11], s45 offen offset:0
    buffer_load_dwordx4 v[196:199], v4, s[8:11], s45 offen offset:1024
    s_add_u32 m0, s44, 18432
    s_add_u32 s58, s58, 8192
    buffer_load_dwordx4 v6, s[32:35], s58 offen lds
    v_mfma_f32_32x32x16_bf16 v[80:95], v[136:139], v[204:207], v[80:95]
    s_add_u32 m0, s44, 19456
    s_add_u32 s58, s58, 8192
    buffer_load_dwordx4 v6, s[32:35], s58 offen lds
    v_mfma_f32_32x32x16_bf16 v[96:111], v[140:143], v[200:203], v[96:111]
    ds_read_b64_tr_b16 v[128:129], v16 offset:22528
    v_mfma_f32_32x32x16_bf16 v[112:127], v[140:143], v[204:207], v[112:127]
    ds_read_b64_tr_b16 v[130:131], v16 offset:23040
    ds_read_b64_tr_b16 v[132:133], v17 offset:22528
    ds_read_b64_tr_b16 v[134:135], v17 offset:23040
    s_waitcnt lgkmcnt(4)
    s_waitcnt vmcnt(16)
    v_mfma_f32_32x32x16_bf16 v[64:79], v[144:147], v[208:211], v[64:79]
    buffer_load_dwordx4 v[200:203], v4, s[8:11], s45 offen offset:2048
    buffer_load_dwordx4 v[204:207], v4, s[8:11], s45 offen offset:3072
    s_add_u32 s45, s45, 4096
    s_add_u32 m0, s44, 20480
    s_add_u32 s58, s58, 8192
    buffer_load_dwordx4 v6, s[32:35], s58 offen lds
    v_mfma_f32_32x32x16_bf16 v[80:95], v[144:147], v[212:215], v[80:95]
    s_add_u32 m0, s44, 21504
    s_add_u32 s58, s58, 8192
    buffer_load_dwordx4 v6, s[32:35], s58 offen lds
    v_mfma_f32_32x32x16_bf16 v[96:111], v[148:151], v[208:211], v[96:111]
    ds_read_b64_tr_b16 v[136:137], v16 offset:24576
    v_mfma_f32_32x32x16_bf16 v[112:127], v[148:151], v[212:215], v[112:127]
    ds_read_b64_tr_b16 v[138:139], v16 offset:25088
    ds_read_b64_tr_b16 v[140:141], v17 offset:24576
    ds_read_b64_tr_b16 v[142:143], v17 offset:25088
    s_waitcnt lgkmcnt(4)
    s_waitcnt vmcnt(18)
    v_mfma_f32_32x32x16_bf16 v[64:79], v[128:131], v[216:219], v[64:79]
    buffer_load_dwordx4 v[208:211], v4, s[8:11], s45 offen offset:0
    buffer_load_dwordx4 v[212:215], v4, s[8:11], s45 offen offset:1024
    s_add_u32 m0, s44, 22528
    s_add_u32 s58, s58, 8192
    buffer_load_dwordx4 v6, s[32:35], s58 offen lds
    v_mfma_f32_32x32x16_bf16 v[80:95], v[128:131], v[220:223], v[80:95]
    s_add_u32 m0, s44, 23552
    s_add_u32 s58, s58, 8192
    buffer_load_dwordx4 v6, s[32:35], s58 offen lds
    v_mfma_f32_32x32x16_bf16 v[96:111], v[132:135], v[216:219], v[96:111]
    ds_read_b64_tr_b16 v[144:145], v16 offset:26624
    v_mfma_f32_32x32x16_bf16 v[112:127], v[132:135], v[220:223], v[112:127]
    ds_read_b64_tr_b16 v[146:147], v16 offset:27136
    ds_read_b64_tr_b16 v[148:149], v17 offset:26624
    ds_read_b64_tr_b16 v[150:151], v17 offset:27136
    s_waitcnt lgkmcnt(4)
    s_waitcnt vmcnt(20)
    v_mfma_f32_32x32x16_bf16 v[64:79], v[136:139], v[224:227], v[64:79]
    buffer_load_dwordx4 v[216:219], v4, s[8:11], s45 offen offset:2048
    buffer_load_dwordx4 v[220:223], v4, s[8:11], s45 offen offset:3072
    s_add_u32 s45, s45, 4096
    s_add_u32 m0, s44, 24576
    s_add_u32 s58, s58, 8192
    buffer_load_dwordx4 v6, s[32:35], s58 offen lds
    v_mfma_f32_32x32x16_bf16 v[80:95], v[136:139], v[228:231], v[80:95]
    s_add_u32 m0, s44, 25600
    s_add_u32 s58, s58, 8192
    buffer_load_dwordx4 v6, s[32:35], s58 offen lds
    v_mfma_f32_32x32x16_bf16 v[96:111], v[140:143], v[224:227], v[96:111]
    ds_read_b64_tr_b16 v[128:129], v16 offset:28672
    v_mfma_f32_32x32x16_bf16 v[112:127], v[140:143], v[228:231], v[112:127]
    ds_read_b64_tr_b16 v[130:131], v16 offset:29184
    ds_read_b64_tr_b16 v[132:133], v17 offset:28672
    ds_read_b64_tr_b16 v[134:135], v17 offset:29184
    s_waitcnt lgkmcnt(4)
    s_waitcnt vmcnt(22)
    v_mfma_f32_32x32x16_bf16 v[64:79], v[144:147], v[232:235], v[64:79]
    buffer_load_dwordx4 v[224:227], v4, s[8:11], s45 offen offset:0
    buffer_load_dwordx4 v[228:231], v4, s[8:11], s45 offen offset:1024
    s_add_u32 m0, s44, 26624
    s_add_u32 s58, s58, 8192
    buffer_load_dwordx4 v6, s[32:35], s58 offen lds
    v_mfma_f32_32x32x16_bf16 v[80:95], v[144:147], v[236:239], v[80:95]
    s_add_u32 m0, s44, 27648
    s_add_u32 s58, s58, 8192
    buffer_load_dwordx4 v6, s[32:35], s58 offen lds
    v_mfma_f32_32x32x16_bf16 v[96:111], v[148:151], v[232:235], v[96:111]
    ds_read_b64_tr_b16 v[136:137], v16 offset:30720
    v_mfma_f32_32x32x16_bf16 v[112:127], v[148:151], v[236:239], v[112:127]
    ds_read_b64_tr_b16 v[138:139], v16 offset:31232
    ds_read_b64_tr_b16 v[140:141], v17 offset:30720
    ds_read_b64_tr_b16 v[142:143], v17 offset:31232
    s_waitcnt lgkmcnt(4)
    s_waitcnt vmcnt(24)
    v_mfma_f32_32x32x16_bf16 v[64:79], v[128:131], v[240:243], v[64:79]
    buffer_load_dwordx4 v[232:235], v4, s[8:11], s45 offen offset:2048
    buffer_load_dwordx4 v[236:239], v4, s[8:11], s45 offen offset:3072
    s_add_u32 s45, s45, 4096
    s_add_u32 m0, s44, 28672
    s_add_u32 s58, s58, 8192
    buffer_load_dwordx4 v6, s[32:35], s58 offen lds
    v_mfma_f32_32x32x16_bf16 v[80:95], v[128:131], v[244:247], v[80:95]
    s_add_u32 m0, s44, 29696
    s_add_u32 s58, s58, 8192
    buffer_load_dwordx4 v6, s[32:35], s58 offen lds
    v_mfma_f32_32x32x16_bf16 v[96:111], v[132:135], v[240:243], v[96:111]
    ds_read_b64_tr_b16 v[144:145], v16 offset:32768
    v_mfma_f32_32x32x16_bf16 v[112:127], v[132:135], v[244:247], v[112:127]
    ds_read_b64_tr_b16 v[146:147], v16 offset:33280
    ds_read_b64_tr_b16 v[148:149], v17 offset:32768
    ds_read_b64_tr_b16 v[150:151], v17 offset:33280
    s_waitcnt lgkmcnt(4)
    s_waitcnt vmcnt(26)
    v_mfma_f32_32x32x16_bf16 v[64:79], v[136:139], v[248:251], v[64:79]
    buffer_load_dwordx4 v[240:243], v4, s[8:11], s45 offen offset:0
    buffer_load_dwordx4 v[244:247], v4, s[8:11], s45 offen offset:1024
    s_add_u32 m0, s44, 30720
    s_add_u32 s58, s58, 8192
    buffer_load_dwordx4 v6, s[32:35], s58 offen lds
    v_mfma_f32_32x32x16_bf16 v[80:95], v[136:139], v[252:255], v[80:95]
    s_add_u32 m0, s44, 31744
    s_add_u32 s58, s58, 8192
    buffer_load_dwordx4 v6, s[32:35], s58 offen lds
    v_mfma_f32_32x32x16_bf16 v[96:111], v[140:143], v[248:251], v[96:111]
    ds_read_b64_tr_b16 v[128:129], v16 offset:34816
    v_mfma_f32_32x32x16_bf16 v[112:127], v[140:143], v[252:255], v[112:127]
    ds_read_b64_tr_b16 v[130:131], v16 offset:35328
    ds_read_b64_tr_b16 v[132:133], v17 offset:34816
    ds_read_b64_tr_b16 v[134:135], v17 offset:35328
    s_waitcnt lgkmcnt(4)
    s_waitcnt vmcnt(26)
    v_mfma_f32_32x32x16_bf16 v[64:79], v[144:147], v[192:195], v[64:79]
    buffer_load_dwordx4 v[248:251], v4, s[8:11], s45 offen offset:2048
    buffer_load_dwordx4 v[252:255], v4, s[8:11], s45 offen offset:3072
    s_add_u32 s45, s45, 4096
    s_add_u32 m0, s44, 32768
    s_add_u32 s58, s58, 8192
    buffer_load_dwordx4 v6, s[32:35], s58 offen lds
    v_mfma_f32_32x32x16_bf16 v[80:95], v[144:147], v[196:199], v[80:95]
    s_add_u32 m0, s44, 33792
    s_add_u32 s58, s58, 8192
    buffer_load_dwordx4 v6, s[32:35], s58 offen lds
    v_mfma_f32_32x32x16_bf16 v[96:111], v[148:151], v[192:195], v[96:111]
    ds_read_b64_tr_b16 v[136:137], v16 offset:36864
    v_mfma_f32_32x32x16_bf16 v[112:127], v[148:151], v[196:199], v[112:127]
    ds_read_b64_tr_b16 v[138:139], v16 offset:37376
    ds_read_b64_tr_b16 v[140:141], v17 offset:36864
    ds_read_b64_tr_b16 v[142:143], v17 offset:37376
    s_waitcnt lgkmcnt(4)
    s_waitcnt vmcnt(26)
    v_mfma_f32_32x32x16_bf16 v[64:79], v[128:131], v[200:203], v[64:79]
    buffer_load_dwordx4 v[192:195], v4, s[8:11], s45 offen offset:0
    buffer_load_dwordx4 v[196:199], v4, s[8:11], s45 offen offset:1024
    v_mfma_f32_32x32x16_bf16 v[80:95], v[128:131], v[204:207], v[80:95]
    ds_read_b64_tr_b16 v[144:145], v16 offset:0
    v_mfma_f32_32x32x16_bf16 v[96:111], v[132:135], v[200:203], v[96:111]
    ds_read_b64_tr_b16 v[146:147], v16 offset:512
    ds_read_b64_tr_b16 v[148:149], v17 offset:0
    v_mfma_f32_32x32x16_bf16 v[112:127], v[132:135], v[204:207], v[112:127]
    ds_read_b64_tr_b16 v[150:151], v17 offset:512
    s_waitcnt lgkmcnt(4)
    s_waitcnt vmcnt(24)
    v_mfma_f32_32x32x16_bf16 v[64:79], v[136:139], v[208:211], v[64:79]
    buffer_load_dwordx4 v[200:203], v4, s[8:11], s45 offen offset:2048
    buffer_load_dwordx4 v[204:207], v4, s[8:11], s45 offen offset:3072
    v_mfma_f32_32x32x16_bf16 v[80:95], v[136:139], v[212:215], v[80:95]
    s_add_u32 s45, s45, 4096
    ds_read_b64_tr_b16 v[128:129], v16 offset:2048
    v_mfma_f32_32x32x16_bf16 v[96:111], v[140:143], v[208:211], v[96:111]
    ds_read_b64_tr_b16 v[130:131], v16 offset:2560
    ds_read_b64_tr_b16 v[132:133], v17 offset:2048
    v_mfma_f32_32x32x16_bf16 v[112:127], v[140:143], v[212:215], v[112:127]
    ds_read_b64_tr_b16 v[134:135], v17 offset:2560
    s_waitcnt lgkmcnt(4)
    s_waitcnt vmcnt(22)
    v_mfma_f32_32x32x16_bf16 v[64:79], v[144:147], v[216:219], v[64:79]
    buffer_load_dwordx4 v[208:211], v4, s[8:11], s45 offen offset:0
    buffer_load_dwordx4 v[212:215], v4, s[8:11], s45 offen offset:1024
    v_mfma_f32_32x32x16_bf16 v[80:95], v[144:147], v[220:223], v[80:95]
    ds_read_b64_tr_b16 v[136:137], v16 offset:4096
    v_mfma_f32_32x32x16_bf16 v[96:111], v[148:151], v[216:219], v[96:111]
    ds_read_b64_tr_b16 v[138:139], v16 offset:4608
    ds_read_b64_tr_b16 v[140:141], v17 offset:4096
    v_mfma_f32_32x32x16_bf16 v[112:127], v[148:151], v[220:223], v[112:127]
    ds_read_b64_tr_b16 v[142:143], v17 offset:4608
    s_waitcnt lgkmcnt(4)
    s_waitcnt vmcnt(20)
    v_mfma_f32_32x32x16_bf16 v[64:79], v[128:131], v[224:227], v[64:79]
    buffer_load_dwordx4 v[216:219], v4, s[8:11], s45 offen offset:2048
    buffer_load_dwordx4 v[220:223], v4, s[8:11], s45 offen offset:3072
    v_mfma_f32_32x32x16_bf16 v[80:95], v[128:131], v[228:231], v[80:95]
    s_add_u32 s45, s45, 4096
    ds_read_b64_tr_b16 v[144:145], v16 offset:6144
    v_mfma_f32_32x32x16_bf16 v[96:111], v[132:135], v[224:227], v[96:111]
    ds_read_b64_tr_b16 v[146:147], v16 offset:6656
    ds_read_b64_tr_b16 v[148:149], v17 offset:6144
    v_mfma_f32_32x32x16_bf16 v[112:127], v[132:135], v[228:231], v[112:127]
    ds_read_b64_tr_b16 v[150:151], v17 offset:6656
    s_waitcnt lgkmcnt(4)
    s_waitcnt vmcnt(18)
    v_mfma_f32_32x32x16_bf16 v[64:79], v[136:139], v[232:235], v[64:79]
    buffer_load_dwordx4 v[224:227], v4, s[8:11], s45 offen offset:0
    buffer_load_dwordx4 v[228:231], v4, s[8:11], s45 offen offset:1024
    v_mfma_f32_32x32x16_bf16 v[80:95], v[136:139], v[236:239], v[80:95]
    ds_read_b64_tr_b16 v[128:129], v16 offset:8192
    v_mfma_f32_32x32x16_bf16 v[96:111], v[140:143], v[232:235], v[96:111]
    ds_read_b64_tr_b16 v[130:131], v16 offset:8704
    ds_read_b64_tr_b16 v[132:133], v17 offset:8192
    v_mfma_f32_32x32x16_bf16 v[112:127], v[140:143], v[236:239], v[112:127]
    ds_read_b64_tr_b16 v[134:135], v17 offset:8704
    s_waitcnt lgkmcnt(4)
    s_waitcnt vmcnt(16)
    v_mfma_f32_32x32x16_bf16 v[64:79], v[144:147], v[240:243], v[64:79]
    buffer_load_dwordx4 v[232:235], v4, s[8:11], s45 offen offset:2048
    buffer_load_dwordx4 v[236:239], v4, s[8:11], s45 offen offset:3072
    v_mfma_f32_32x32x16_bf16 v[80:95], v[144:147], v[244:247], v[80:95]
    s_add_u32 s45, s45, 4096
    ds_read_b64_tr_b16 v[136:137], v16 offset:10240
    v_mfma_f32_32x32x16_bf16 v[96:111], v[148:151], v[240:243], v[96:111]
    ds_read_b64_tr_b16 v[138:139], v16 offset:10752
    ds_read_b64_tr_b16 v[140:141], v17 offset:10240
    v_mfma_f32_32x32x16_bf16 v[112:127], v[148:151], v[244:247], v[112:127]
    ds_read_b64_tr_b16 v[142:143], v17 offset:10752
    s_waitcnt lgkmcnt(4)
    s_waitcnt vmcnt(14)
    v_mfma_f32_32x32x16_bf16 v[64:79], v[128:131], v[248:251], v[64:79]
    buffer_load_dwordx4 v[240:243], v4, s[8:11], s45 offen offset:0
    buffer_load_dwordx4 v[244:247], v4, s[8:11], s45 offen offset:1024
    v_mfma_f32_32x32x16_bf16 v[80:95], v[128:131], v[252:255], v[80:95]
    ds_read_b64_tr_b16 v[144:145], v16 offset:12288
    v_mfma_f32_32x32x16_bf16 v[96:111], v[132:135], v[248:251], v[96:111]
    ds_read_b64_tr_b16 v[146:147], v16 offset:12800
    ds_read_b64_tr_b16 v[148:149], v17 offset:12288
    v_mfma_f32_32x32x16_bf16 v[112:127], v[132:135], v[252:255], v[112:127]
    ds_read_b64_tr_b16 v[150:151], v17 offset:12800
    s_waitcnt lgkmcnt(4)
    s_waitcnt vmcnt(12)
    v_mfma_f32_32x32x16_bf16 v[64:79], v[136:139], v[192:195], v[64:79]
    buffer_load_dwordx4 v[248:251], v4, s[8:11], s45 offen offset:2048
    buffer_load_dwordx4 v[252:255], v4, s[8:11], s45 offen offset:3072
    v_mfma_f32_32x32x16_bf16 v[80:95], v[136:139], v[196:199], v[80:95]
    s_add_u32 s45, s45, 4096
    ds_read_b64_tr_b16 v[128:129], v16 offset:14336
    v_mfma_f32_32x32x16_bf16 v[96:111], v[140:143], v[192:195], v[96:111]
    ds_read_b64_tr_b16 v[130:131], v16 offset:14848
    ds_read_b64_tr_b16 v[132:133], v17 offset:14336
    v_mfma_f32_32x32x16_bf16 v[112:127], v[140:143], v[196:199], v[112:127]
    ds_read_b64_tr_b16 v[134:135], v17 offset:14848
    s_waitcnt lgkmcnt(4)
    s_waitcnt vmcnt(12)
    v_mfma_f32_32x32x16_bf16 v[64:79], v[144:147], v[200:203], v[64:79]
    buffer_load_dwordx4 v[192:195], v4, s[8:11], s45 offen offset:0
    buffer_load_dwordx4 v[196:199], v4, s[8:11], s45 offen offset:1024
    v_mfma_f32_32x32x16_bf16 v[80:95], v[144:147], v[204:207], v[80:95]
    ds_read_b64_tr_b16 v[136:137], v16 offset:38912
    v_mfma_f32_32x32x16_bf16 v[96:111], v[148:151], v[200:203], v[96:111]
    ds_read_b64_tr_b16 v[138:139], v16 offset:39424
    ds_read_b64_tr_b16 v[140:141], v17 offset:38912
    v_mfma_f32_32x32x16_bf16 v[112:127], v[148:151], v[204:207], v[112:127]
    ds_read_b64_tr_b16 v[142:143], v17 offset:39424
    s_waitcnt lgkmcnt(4)
    s_waitcnt vmcnt(12)
    v_mfma_f32_32x32x16_bf16 v[64:79], v[128:131], v[208:211], v[64:79]
    buffer_load_dwordx4 v[200:203], v4, s[8:11], s45 offen offset:2048
    buffer_load_dwordx4 v[204:207], v4, s[8:11], s45 offen offset:3072
    v_mfma_f32_32x32x16_bf16 v[80:95], v[128:131], v[212:215], v[80:95]
    s_add_u32 s45, s45, 4096
    ds_read_b64_tr_b16 v[144:145], v16 offset:18432
    v_mfma_f32_32x32x16_bf16 v[96:111], v[132:135], v[208:211], v[96:111]
    ds_read_b64_tr_b16 v[146:147], v16 offset:18944
    ds_read_b64_tr_b16 v[148:149], v17 offset:18432
    v_mfma_f32_32x32x16_bf16 v[112:127], v[132:135], v[212:215], v[112:127]
    ds_read_b64_tr_b16 v[150:151], v17 offset:18944
    s_waitcnt lgkmcnt(4)
    s_waitcnt vmcnt(12)
    v_mfma_f32_32x32x16_bf16 v[64:79], v[136:139], v[216:219], v[64:79]
    buffer_load_dwordx4 v[208:211], v4, s[8:11], s45 offen offset:0
    buffer_load_dwordx4 v[212:215], v4, s[8:11], s45 offen offset:1024
    v_mfma_f32_32x32x16_bf16 v[80:95], v[136:139], v[220:223], v[80:95]
    ds_read_b64_tr_b16 v[128:129], v16 offset:20480
    v_mfma_f32_32x32x16_bf16 v[96:111], v[140:143], v[216:219], v[96:111]
    ds_read_b64_tr_b16 v[130:131], v16 offset:20992
    ds_read_b64_tr_b16 v[132:133], v17 offset:20480
    v_mfma_f32_32x32x16_bf16 v[112:127], v[140:143], v[220:223], v[112:127]
    ds_read_b64_tr_b16 v[134:135], v17 offset:20992
    s_waitcnt lgkmcnt(4)
    s_waitcnt vmcnt(12)
    v_mfma_f32_32x32x16_bf16 v[64:79], v[144:147], v[224:227], v[64:79]
    buffer_load_dwordx4 v[216:219], v4, s[8:11], s45 offen offset:2048
    buffer_load_dwordx4 v[220:223], v4, s[8:11], s45 offen offset:3072
    v_mfma_f32_32x32x16_bf16 v[80:95], v[144:147], v[228:231], v[80:95]
    s_add_u32 s45, s45, 4096
    ds_read_b64_tr_b16 v[136:137], v16 offset:22528
    v_mfma_f32_32x32x16_bf16 v[96:111], v[148:151], v[224:227], v[96:111]
    ds_read_b64_tr_b16 v[138:139], v16 offset:23040
    ds_read_b64_tr_b16 v[140:141], v17 offset:22528
    v_mfma_f32_32x32x16_bf16 v[112:127], v[148:151], v[228:231], v[112:127]
    ds_read_b64_tr_b16 v[142:143], v17 offset:23040
    s_waitcnt lgkmcnt(4)
    s_waitcnt vmcnt(12)
    v_mfma_f32_32x32x16_bf16 v[64:79], v[128:131], v[232:235], v[64:79]
    ds_read_b64_tr_b16 v[144:145], v16 offset:24576
    v_mfma_f32_32x32x16_bf16 v[80:95], v[128:131], v[236:239], v[80:95]
    ds_read_b64_tr_b16 v[146:147], v16 offset:25088
    v_mfma_f32_32x32x16_bf16 v[96:111], v[132:135], v[232:235], v[96:111]
    ds_read_b64_tr_b16 v[148:149], v17 offset:24576
    v_mfma_f32_32x32x16_bf16 v[112:127], v[132:135], v[236:239], v[112:127]
    ds_read_b64_tr_b16 v[150:151], v17 offset:25088
    s_waitcnt lgkmcnt(4)
    s_waitcnt vmcnt(10)
    v_mfma_f32_32x32x16_bf16 v[64:79], v[136:139], v[240:243], v[64:79]
    ds_read_b64_tr_b16 v[128:129], v16 offset:26624
    v_mfma_f32_32x32x16_bf16 v[80:95], v[136:139], v[244:247], v[80:95]
    ds_read_b64_tr_b16 v[130:131], v16 offset:27136
    v_mfma_f32_32x32x16_bf16 v[96:111], v[140:143], v[240:243], v[96:111]
    ds_read_b64_tr_b16 v[132:133], v17 offset:26624
    v_mfma_f32_32x32x16_bf16 v[112:127], v[140:143], v[244:247], v[112:127]
    ds_read_b64_tr_b16 v[134:135], v17 offset:27136
    s_waitcnt lgkmcnt(4)
    s_waitcnt vmcnt(8)
    v_mfma_f32_32x32x16_bf16 v[64:79], v[144:147], v[248:251], v[64:79]
    ds_read_b64_tr_b16 v[136:137], v16 offset:28672
    v_mfma_f32_32x32x16_bf16 v[80:95], v[144:147], v[252:255], v[80:95]
    ds_read_b64_tr_b16 v[138:139], v16 offset:29184
    v_mfma_f32_32x32x16_bf16 v[96:111], v[148:151], v[248:251], v[96:111]
    ds_read_b64_tr_b16 v[140:141], v17 offset:28672
    v_mfma_f32_32x32x16_bf16 v[112:127], v[148:151], v[252:255], v[112:127]
    ds_read_b64_tr_b16 v[142:143], v17 offset:29184
    s_waitcnt lgkmcnt(4)
    s_waitcnt vmcnt(6)
    v_mfma_f32_32x32x16_bf16 v[64:79], v[128:131], v[192:195], v[64:79]
    ds_read_b64_tr_b16 v[144:145], v16 offset:30720
    v_mfma_f32_32x32x16_bf16 v[80:95], v[128:131], v[196:199], v[80:95]
    ds_read_b64_tr_b16 v[146:147], v16 offset:31232
    v_mfma_f32_32x32x16_bf16 v[96:111], v[132:135], v[192:195], v[96:111]
    ds_read_b64_tr_b16 v[148:149], v17 offset:30720
    v_mfma_f32_32x32x16_bf16 v[112:127], v[132:135], v[196:199], v[112:127]
    ds_read_b64_tr_b16 v[150:151], v17 offset:31232
    s_waitcnt lgkmcnt(4)
    s_waitcnt vmcnt(4)
    v_mfma_f32_32x32x16_bf16 v[64:79], v[136:139], v[200:203], v[64:79]
    ds_read_b64_tr_b16 v[128:129], v16 offset:32768
    v_mfma_f32_32x32x16_bf16 v[80:95], v[136:139], v[204:207], v[80:95]
    ds_read_b64_tr_b16 v[130:131], v16 offset:33280
    v_mfma_f32_32x32x16_bf16 v[96:111], v[140:143], v[200:203], v[96:111]
    ds_read_b64_tr_b16 v[132:133], v17 offset:32768
    v_mfma_f32_32x32x16_bf16 v[112:127], v[140:143], v[204:207], v[112:127]
    ds_read_b64_tr_b16 v[134:135], v17 offset:33280
    s_waitcnt lgkmcnt(4)
    s_waitcnt vmcnt(2)
    v_mfma_f32_32x32x16_bf16 v[64:79], v[144:147], v[208:211], v[64:79]
    v_mfma_f32_32x32x16_bf16 v[80:95], v[144:147], v[212:215], v[80:95]
    v_mfma_f32_32x32x16_bf16 v[96:111], v[148:151], v[208:211], v[96:111]
    v_mfma_f32_32x32x16_bf16 v[112:127], v[148:151], v[212:215], v[112:127]
    s_waitcnt lgkmcnt(0)
    s_waitcnt vmcnt(0)
    v_mfma_f32_32x32x16_bf16 v[64:79], v[128:131], v[216:219], v[64:79]
    v_mfma_f32_32x32x16_bf16 v[80:95], v[128:131], v[220:223], v[80:95]
    v_mfma_f32_32x32x16_bf16 v[96:111], v[132:135], v[216:219], v[96:111]
    v_mfma_f32_32x32x16_bf16 v[112:127], v[132:135], v[220:223], v[112:127]
    s_nop 7
    s_nop 1
    ds_write_b128 v48, v[64:67] offset:0
    ds_write_b128 v48, v[68:71] offset:16
    ds_write_b128 v48, v[72:75] offset:64
    ds_write_b128 v48, v[76:79] offset:80
    ds_write_b128 v48, v[80:83] offset:8704
    ds_write_b128 v48, v[84:87] offset:8720
    ds_write_b128 v48, v[88:91] offset:8768
    ds_write_b128 v48, v[92:95] offset:8784
    s_waitcnt lgkmcnt(0)
    ds_write_b128 v48, v[96:99] offset:128
    ds_write_b128 v48, v[100:103] offset:144
    ds_write_b128 v48, v[104:107] offset:192
    ds_write_b128 v48, v[108:111] offset:208
    ds_write_b128 v48, v[112:115] offset:8832
    ds_write_b128 v48, v[116:119] offset:8848
    ds_write_b128 v48, v[120:123] offset:8896
    ds_write_b128 v48, v[124:127] offset:8912
    s_waitcnt lgkmcnt(0)
    s_branch .Lk6_join
.Lk6_help:
    v_lshrrev_b32 v10, 3, v1
    v_and_b32 v11, 7, v1
    v_mul_u32_u24 v49, 272, v10
    v_lshl_add_u32 v49, v11, 5, v49
    s_mul_i32 s51, s40, 2176
    v_add_u32 v49, s51, v49
    v_add_u32 v50, 81920, v49
    v_lshlrev_b32 v51, 4, v11
    v_lshl_add_u32 v51, v10, 10, v51
    s_lshl_b32 s50, s41, 16
    s_lshl_b32 s51, s40, 13
    s_add_u32 s50, s50, s51
    s_lshl_b32 s51, s42, 7
    s_add_u32 s50, s50, s51
    v_lshlrev_b32 v52, 5, v11
    s_add_u32 s16, s68, 0x600000
    s_addc_u32 s17, s69, 0
    s_mov_b32 s18, 0x200000
    s_mov_b32 s19, 0x00020000
    s_add_u32 s20, s68, 0x400000
    s_addc_u32 s21, s69, 0
    s_mov_b32 s22, 0x200000
    s_mov_b32 s23, 0x00020000
    s_mov_b32 s24, s68
    s_mov_b32 s25, s69
    s_mov_b32 s26, 0xc000
    s_mov_b32 s27, 0x00020000
    s_mov_b32 s28, s62
    s_mov_b32 s29, s63
    s_mov_b32 s30, 0x200000
    s_mov_b32 s31, 0x00020000
    buffer_load_dwordx4 v[24:27], v51, s[16:19], s50 offen
    buffer_load_dwordx4 v[32:35], v51, s[20:23], s50 offen
    s_lshl_b32 s51, s42, 8
    s_add_u32 s51, s51, 10240
    buffer_load_dwordx4 v[40:43], v52, s[24:27], s51 offen offset:0
    buffer_load_dwordx4 v[44:47], v52, s[24:27], s51 offen offset:16
    s_add_u32 s51, s51, 12288
    buffer_load_dwordx4 v[28:31], v52, s[24:27], s51 offen offset:0
    buffer_load_dwordx4 v[36:39], v52, s[24:27], s51 offen offset:16
    s_cmp_lg_u32 s40, 7
    s_cbranch_scc1 .Lpl4_done
    v_and_b32 v3, 7, v1
    v_lshlrev_b32 v3, 3, v3
    v_add_u32 v3, s96, v3
    s_mov_b32 s98, 0
    s_mov_b32 s99, 0
.Lpl4_sp:
    s_buffer_load_dwordx16 s[8:23], s[92:95], s96 glc
    s_add_u32 s99, s99, 1
    s_waitcnt lgkmcnt(0)
    s_xor_b64 s[8:9], s[8:9], s[100:101]
    s_xor_b64 s[10:11], s[10:11], s[100:101]
    s_xor_b64 s[12:13], s[12:13], s[100:101]
    s_xor_b64 s[14:15], s[14:15], s[100:101]
    s_xor_b64 s[16:17], s[16:17], s[100:101]
    s_xor_b64 s[18:19], s[18:19], s[100:101]
    s_xor_b64 s[20:21], s[20:21], s[100:101]
    s_xor_b64 s[22:23], s[22:23], s[100:101]
    s_or_b64 s[8:9], s[8:9], s[10:11]
    s_or_b64 s[8:9], s[8:9], s[12:13]
    s_or_b64 s[8:9], s[8:9], s[14:15]
    s_or_b64 s[8:9], s[8:9], s[16:17]
    s_or_b64 s[8:9], s[8:9], s[18:19]
    s_or_b64 s[8:9], s[8:9], s[20:21]
    s_or_b64 s[8:9], s[8:9], s[22:23]
    s_cbranch_scc0 .Lpl4_sd
    s_and_b32 s98, s99, 3
    s_cbranch_scc1 .Lpl4_sp
    buffer_load_dwordx2 v[248:249], v3, s[92:95], 0 offen sc1
    s_waitcnt vmcnt(0)
    v_xor_b32 v248, s100, v248
    v_xor_b32 v249, s101, v249
    v_or_b32 v248, v248, v249
    v_cmp_ne_u32 vcc, 0, v248
    s_cmp_lt_u32 s99, 0x80000
    s_cbranch_scc0 .Lpl4_sd
    s_cbranch_vccnz .Lpl4_sp
.Lpl4_sd:
.Lpl4_done:
    s_barrier
    s_waitcnt vmcnt(0)
.Lk6_join:
    s_barrier
    ds_read_b128 v[64:67], v49 offset:0
    ds_read_b128 v[68:71], v49 offset:16
    ds_read_b128 v[80:83], v49 offset:40960
    ds_read_b128 v[84:87], v49 offset:40976
    ds_read_b128 v[96:99], v50 offset:0
    ds_read_b128 v[100:103], v50 offset:16
    ds_read_b128 v[112:115], v50 offset:40960
    ds_read_b128 v[116:119], v50 offset:40976
    v_lshlrev_b32 v72, 16, v24
    v_and_b32 v73, s43, v24
    v_lshlrev_b32 v74, 16, v25
    v_and_b32 v75, s43, v25
    v_lshlrev_b32 v76, 16, v26
    v_and_b32 v77, s43, v26
    v_lshlrev_b32 v78, 16, v27
    v_and_b32 v79, s43, v27
    v_lshlrev_b32 v104, 16, v32
    v_and_b32 v105, s43, v32
    v_lshlrev_b32 v106, 16, v33
    v_and_b32 v107, s43, v33
    v_lshlrev_b32 v108, 16, v34
    v_and_b32 v109, s43, v34
    v_lshlrev_b32 v110, 16, v35
    v_and_b32 v111, s43, v35
    v_pk_add_f32 v[40:41], v[40:41], v[28:29]
    v_pk_add_f32 v[42:43], v[42:43], v[30:31]
    v_pk_add_f32 v[44:45], v[44:45], v[36:37]
    v_pk_add_f32 v[46:47], v[46:47], v[38:39]
    v_cvt_pk_bf16_f32 v40, 0, v40
    v_cvt_pk_bf16_f32 v41, 0, v41
    v_cvt_pk_bf16_f32 v42, 0, v42
    v_cvt_pk_bf16_f32 v43, 0, v43
    v_cvt_pk_bf16_f32 v44, 0, v44
    v_cvt_pk_bf16_f32 v45, 0, v45
    v_cvt_pk_bf16_f32 v46, 0, v46
    v_cvt_pk_bf16_f32 v47, 0, v47
    s_waitcnt lgkmcnt(4)
    v_pk_add_f32 v[64:65], v[64:65], v[80:81]
    v_pk_add_f32 v[66:67], v[66:67], v[82:83]
    v_pk_add_f32 v[68:69], v[68:69], v[84:85]
    v_pk_add_f32 v[70:71], v[70:71], v[86:87]
    s_waitcnt lgkmcnt(0)
    v_pk_add_f32 v[96:97], v[96:97], v[112:113]
    v_pk_add_f32 v[98:99], v[98:99], v[114:115]
    v_pk_add_f32 v[100:101], v[100:101], v[116:117]
    v_pk_add_f32 v[102:103], v[102:103], v[118:119]
    v_pk_add_f32 v[64:65], v[64:65], v[96:97]
    v_pk_add_f32 v[66:67], v[66:67], v[98:99]
    v_pk_add_f32 v[68:69], v[68:69], v[100:101]
    v_pk_add_f32 v[70:71], v[70:71], v[102:103]
    v_cvt_pk_bf16_f32 v64, 0, v64
    v_cvt_pk_bf16_f32 v65, 0, v65
    v_cvt_pk_bf16_f32 v66, 0, v66
    v_cvt_pk_bf16_f32 v67, 0, v67
    v_cvt_pk_bf16_f32 v68, 0, v68
    v_cvt_pk_bf16_f32 v69, 0, v69
    v_cvt_pk_bf16_f32 v70, 0, v70
    v_cvt_pk_bf16_f32 v71, 0, v71
    v_pk_add_f32 v[64:65], v[64:65], v[72:73]
    v_pk_add_f32 v[66:67], v[66:67], v[74:75]
    v_pk_add_f32 v[68:69], v[68:69], v[76:77]
    v_pk_add_f32 v[70:71], v[70:71], v[78:79]
    v_cvt_pk_bf16_f32 v64, 0, v64
    v_cvt_pk_bf16_f32 v65, 0, v65
    v_cvt_pk_bf16_f32 v66, 0, v66
    v_cvt_pk_bf16_f32 v67, 0, v67
    v_cvt_pk_bf16_f32 v68, 0, v68
    v_cvt_pk_bf16_f32 v69, 0, v69
    v_cvt_pk_bf16_f32 v70, 0, v70
    v_cvt_pk_bf16_f32 v71, 0, v71
    v_pk_mul_f32 v[64:65], v[64:65], v[40:41]
    v_pk_mul_f32 v[66:67], v[66:67], v[42:43]
    v_pk_mul_f32 v[68:69], v[68:69], v[44:45]
    v_pk_mul_f32 v[70:71], v[70:71], v[46:47]
    v_cvt_pk_bf16_f32 v64, 0, v64
    v_cvt_pk_bf16_f32 v65, 0, v65
    v_cvt_pk_bf16_f32 v66, 0, v66
    v_cvt_pk_bf16_f32 v67, 0, v67
    v_cvt_pk_bf16_f32 v68, 0, v68
    v_cvt_pk_bf16_f32 v69, 0, v69
    v_cvt_pk_bf16_f32 v70, 0, v70
    v_cvt_pk_bf16_f32 v71, 0, v71
    v_pk_add_f32 v[64:65], v[64:65], v[104:105]
    v_pk_add_f32 v[66:67], v[66:67], v[106:107]
    v_pk_add_f32 v[68:69], v[68:69], v[108:109]
    v_pk_add_f32 v[70:71], v[70:71], v[110:111]
    v_cvt_pk_bf16_f32 v56, v64, v65
    v_cvt_pk_bf16_f32 v57, v66, v67
    v_cvt_pk_bf16_f32 v58, v68, v69
    v_cvt_pk_bf16_f32 v59, v70, v71
    buffer_store_dwordx4 v[56:59], v51, s[28:31], s50 offen sc1
    s_endpgm
.section .rodata,"a"
.p2align 6
.amdhsa_kernel adaLN_cond__sliding_block_cached__mixer_s_mlp__prompt_kernel
  .amdhsa_next_free_vgpr 256
  .amdhsa_next_free_sgpr 102
  .amdhsa_accum_offset 256
  .amdhsa_group_segment_fixed_size 0
  .amdhsa_kernarg_size 120
  .amdhsa_user_sgpr_count 2
  .amdhsa_user_sgpr_kernarg_segment_ptr 1
  .amdhsa_system_sgpr_workgroup_id_x 1
  .amdhsa_float_denorm_mode_32 3
.end_amdhsa_kernel
.text

.Lcode_end:
```
